```python
import torch

def _softmax(x, axis=-1):
    return torch.softmax(x, dim=axis)

def _gelu(x):
    return torch.nn.functional.gelu(x, approximate='tanh')

def _silu(x):
    return torch.nn.functional.silu(x)

def _sigmoid(x):
    return torch.sigmoid(x)

def _layernorm(x, axis=-1, eps=1e-05):
    m = x.mean(dim=axis, keepdim=True)
    v = x.var(dim=axis, keepdim=True, unbiased=False)
    return (x - m) / torch.sqrt(v + eps)

def _scatter_add(tgt, idx, src, axis=0):
    return tgt.clone().index_add_(axis, idx, src)

def _segment_sum(src, seg, n):
    out = torch.zeros((n,) + src.shape[1:], dtype=src.dtype)
    return out.index_add_(0, seg, src)

def _pad(x, pw):
    flat = tuple((v for pair in reversed(pw) for v in pair))
    return torch.nn.functional.pad(x, flat)
kernel_name = 'adaLN_cond__ssm_conv_s4d__glu_gated_geglu__prompt'

def setup_inputs():

    _w = lambda a: (lambda t: t.to(torch.bfloat16) if t.is_floating_point() else t)(torch.as_tensor(a))

    def _A_setup():
        Bsz, L, D, N = (1, 2048, 640, 128)
        return {'u': _w((lambda *s: torch.randn(*s, dtype=torch.bfloat16) * 0.05)(Bsz, L, D)), 'log_A_real': _w((lambda *s: torch.randn(*s, dtype=torch.bfloat16) * 3.2)(D, N) * 0.5), 'A_imag': _w((lambda *s: torch.randn(*s, dtype=torch.bfloat16) * 0.05)(D, N) * 3.14), 'C_real': _w((lambda *s: torch.randn(*s, dtype=torch.bfloat16) * 0.4)(D, N) / N ** 0.5), 'C_imag': _w((lambda *s: torch.randn(*s, dtype=torch.bfloat16) * 0.4)(D, N) / N ** 0.5), 'log_dt': _w((lambda *s: torch.randn(*s, dtype=torch.bfloat16) * 0.05)(D) * 0.5 - 4.0), 'D_skip': _w((lambda *s: torch.randn(*s, dtype=torch.bfloat16) * 0.05)(D))}
    _A_in = _A_setup()

    def _B_setup():
        B, S, Dm, Df = (1, 2048, 640, 1728)
        return {'x': _w((lambda *s: torch.randn(*s, dtype=torch.bfloat16) * 0.05)(B, S, Dm)), 'w_gate': _w((lambda *s: torch.randn(*s, dtype=torch.bfloat16) * 0.8)(Dm, Df) * Dm ** (-0.5)), 'w_up': _w((lambda *s: torch.randn(*s, dtype=torch.bfloat16) * 0.8)(Dm, Df) * Dm ** (-0.5)), 'w_down': _w((lambda *s: torch.randn(*s, dtype=torch.bfloat16) * 0.8)(Df, Dm) * Df ** (-0.5))}
    _B_in = _B_setup()
    return {'A_u': _A_in['u'], 'A_log_A_real': _A_in['log_A_real'], 'A_A_imag': _A_in['A_imag'], 'A_C_real': _A_in['C_real'], 'A_C_imag': _A_in['C_imag'], 'A_log_dt': _A_in['log_dt'], 'A_D_skip': _A_in['D_skip'], 'B_x': _B_in['x'], 'B_w_gate': _B_in['w_gate'], 'B_w_up': _B_in['w_up'], 'B_w_down': _B_in['w_down'], 'c': _w((lambda *s: torch.randn(*s, dtype=torch.bfloat16) * 0.2)(1, 640) * 8.0), 'w_mod': _w((lambda *s: torch.randn(*s, dtype=torch.bfloat16) * 0.2)(640, 6 * 640) * 640 ** (-0.5) * 8.0)}

def reference(A_u, A_log_A_real, A_A_imag, A_C_real, A_C_imag, A_log_dt, A_D_skip, B_x, B_w_gate, B_w_up, B_w_down, c, w_mod):

    def _A_ref(u, log_A_real, A_imag, C_real, C_imag, log_dt, D_skip):
        L = u.shape[1]
        dt = torch.exp(log_dt)
        A = -torch.exp(log_A_real) + 1j * A_imag
        C = (C_real + 1j * C_imag) * dt[:, None]
        pos = (lambda x, dt: x.to(dt))(torch.arange(L), log_dt.dtype)
        P = torch.exp((A * dt[:, None])[:, :, None] * pos[None, None, :])
        K = 2.0 * torch.einsum('dn,dnl->dl', C, P).real
        L2 = 2 * L
        u_t = (lambda x, *d: x.permute(*d))(u, 0, 2, 1)
        Kf = (lambda x, *a, **k: torch.fft.rfft(x.float(), *a, **k))(K, L2)
        Uf = (lambda x, *a, **k: torch.fft.rfft(x.float(), *a, **k))(u_t, L2)
        y = (lambda x, *a, **k: torch.fft.irfft(x, *a, **k).to(torch.bfloat16))(Uf * Kf[None, :, :], L2)[:, :, :L]
        y = (lambda x, *d: x.permute(*d))(y, 0, 2, 1)
        return y + u * D_skip[None, None, :]

    def _B_ref(x, w_gate, w_up, w_down):
        g = torch.einsum('bsd,df->bsf', x, w_gate)
        u = torch.einsum('bsd,df->bsf', x, w_up)
        h = _gelu(g) * u
        return torch.einsum('bsf,fd->bsd', h, w_down)
    x = A_u
    mod = (_silu(c) @ w_mod).reshape(c.shape[0], 6, 1, -1)
    sa, ca, ga, sb, cb, gb = (mod[:, 0].clone(), mod[:, 1].clone(), mod[:, 2].clone(), mod[:, 3].clone(), mod[:, 4].clone(), mod[:, 5].clone())
    h = _layernorm(x, axis=-1) * (1 + ca) + sa
    x = x + ga * _A_ref(h, A_log_A_real, A_A_imag, A_C_real, A_C_imag, A_log_dt, A_D_skip)
    h = _layernorm(x, axis=-1) * (1 + cb) + sb
    x = x + gb * _B_ref(h, B_w_gate, B_w_up, B_w_down)
    return x
```

```asm
; @launch kernel=k1_kernel grid=(512,1,1) block=(256,1,1) lds=62464
; @launch kernel=k2_kernel grid=(244,1,1) block=(256,1,1) lds=94720
; @launch kernel=k3_kernel grid=(256,1,1) block=(256,1,1) lds=104448
.amdgcn_target "amdgcn-amd-amdhsa--gfx950"
.text
.globl k1_kernel
.p2align 8
.type k1_kernel,@function
k1_kernel:
  s_cmp_ge_u32 s2, 512
  s_cbranch_scc1 k1_kernel_exit
  s_load_dwordx2 s[4:5], s[0:1], 120
  v_lshrrev_b32 v1, 6, v0
  s_nop 0
  v_readfirstlane_b32 s19, v1
  s_cmp_ge_u32 s2, 504
  s_cbranch_scc1 k1_kernel_pf
  s_cmp_ge_u32 s2, 440
  s_cbranch_scc1 k1_kernel_ln
  s_cmp_ge_u32 s2, 320
  s_cbranch_scc1 k1_kernel_gv
  s_mov_b32 s20, s2
  s_load_dwordx4 s[8:11], s[0:1], 8
  s_load_dwordx4 s[12:15], s[0:1], 24
  s_load_dwordx2 s[16:17], s[0:1], 40
  v_and_b32 v1, 63, v0
  s_lshl_b32 s21, s20, 1
  s_lshr_b32 s22, s19, 1
  s_add_u32 s21, s21, s22
  s_and_b32 s46, s19, 1
  s_lshl_b32 s22, s21, 8
  s_lshl_b32 s23, s46, 7
  s_add_u32 s22, s22, s23
  v_lshlrev_b32 v11, 1, v1
  s_lshl_b32 s23, s21, 1
  v_mov_b32 v12, s23
  s_waitcnt lgkmcnt(0)
  s_mov_b32 s24, s8
  s_mov_b32 s25, s9
  s_mov_b32 s26, 163840
  s_mov_b32 s27, 0x20000
  s_mov_b32 s28, s10
  s_mov_b32 s29, s11
  s_mov_b32 s30, 163840
  s_mov_b32 s31, 0x20000
  s_mov_b32 s32, s12
  s_mov_b32 s33, s13
  s_mov_b32 s34, 163840
  s_mov_b32 s35, 0x20000
  s_mov_b32 s36, s14
  s_mov_b32 s37, s15
  s_mov_b32 s38, 163840
  s_mov_b32 s39, 0x20000
  s_mov_b32 s40, s16
  s_mov_b32 s41, s17
  s_mov_b32 s42, 1280
  s_mov_b32 s43, 0x20000
  buffer_load_ushort v10, v12, s[40:43], 0 offen
  buffer_load_ushort v2, v11, s[24:27], s22 offen
  buffer_load_ushort v3, v11, s[28:31], s22 offen
  buffer_load_ushort v4, v11, s[32:35], s22 offen
  buffer_load_ushort v5, v11, s[36:39], s22 offen
  s_add_u32 s48, s4, 7340032
  s_addc_u32 s49, s5, 0
  s_mov_b32 s50, 2662400
  s_mov_b32 s51, 0x20000
  s_mul_i32 s44, s19, 15616
  v_lshl_add_u32 v88, v1, 2, s44
  v_and_b32 v89, 15, v1
  v_mul_u32_u24 v90, 272, v89
  v_lshrrev_b32 v91, 4, v1
  v_lshl_add_u32 v90, v91, 4, v90
  v_add_u32 v90, s44, v90
  v_mov_b32 v76, 0
  v_mov_b32 v77, 0
  v_mov_b32 v78, 0
  v_mov_b32 v79, 0
  v_mov_b32 v80, 0
  v_mov_b32 v81, 0
  v_mov_b32 v82, 0
  v_mov_b32 v83, 0
  v_mov_b32 v84, 0
  v_mov_b32 v85, 0
  v_mov_b32 v86, 0
  v_mov_b32 v87, 0
  s_waitcnt vmcnt(4)
  v_lshlrev_b32 v10, 16, v10
  v_mul_f32 v10, 0x3fb8aa3b, v10
  v_exp_f32 v10, v10
  s_nop 0
  v_cvt_pk_bf16_f32 v10, v10, v10
  v_and_b32 v10, 0xffff0000, v10
  s_waitcnt vmcnt(0)
  v_lshlrev_b32 v2, 16, v2
  v_lshlrev_b32 v3, 16, v3
  v_lshlrev_b32 v4, 16, v4
  v_lshlrev_b32 v5, 16, v5
  v_mul_f32 v55, 0x3fb8aa3b, v2
  v_exp_f32 v55, v55
  s_nop 0
  v_cvt_pk_bf16_f32 v55, v55, v55
  v_and_b32 v55, 0xffff0000, v55
  v_mul_f32 v55, v55, v10
  v_mul_f32 v55, 0xbfb8aa3b, v55
  v_mul_f32 v56, v3, v10
  v_mul_f32 v56, 0x3e22f983, v56
  v_mul_f32 v18, v4, v10
  v_mul_f32 v19, v5, v10
  v_add_f32 v18, v18, v18
  v_add_f32 v19, v19, v19
  v_mul_f32 v64, 1.0, v55
  v_mul_f32 v65, 1.0, v56
  v_exp_f32 v64, v64
  v_fract_f32 v65, v65
  v_mul_f32 v68, 0x41000000, v55
  v_mul_f32 v69, 0x41000000, v56
  v_exp_f32 v68, v68
  v_fract_f32 v69, v69
  v_mul_f32 v72, 0x43000000, v55
  v_mul_f32 v73, 0x43000000, v56
  v_exp_f32 v72, v72
  v_fract_f32 v73, v73
  v_cos_f32 v66, v65
  v_sin_f32 v67, v65
  v_cos_f32 v70, v69
  v_sin_f32 v71, v69
  v_cos_f32 v74, v73
  v_sin_f32 v75, v73
  v_mul_f32 v12, v64, v66
  v_mul_f32 v13, v64, v67
  v_mul_f32 v14, v68, v70
  v_mul_f32 v15, v68, v71
  v_mul_f32 v16, v72, v74
  v_mul_f32 v17, v72, v75
  v_pk_mul_f32 v[20:21], v[12:13], v[12:13] op_sel:[0,0] op_sel_hi:[0,1]
  v_mov_b32 v54, 0x00003f80
  v_pk_fma_f32 v[20:21], v[12:13], v[12:13], v[20:21] op_sel:[1,1,0] op_sel_hi:[1,0,1] neg_lo:[0,1,0]
  v_pk_mul_f32 v[22:23], v[20:21], v[12:13] op_sel:[0,0] op_sel_hi:[0,1]
  ds_write_b32 v88, v54 offset:11152
  v_pk_fma_f32 v[22:23], v[20:21], v[12:13], v[22:23] op_sel:[1,1,0] op_sel_hi:[1,0,1] neg_lo:[0,1,0]
  v_pk_mul_f32 v[24:25], v[20:21], v[20:21] op_sel:[0,0] op_sel_hi:[0,1]
  v_cvt_pk_bf16_f32 v54, v14, v15
  v_pk_fma_f32 v[24:25], v[20:21], v[20:21], v[24:25] op_sel:[1,1,0] op_sel_hi:[1,0,1] neg_lo:[0,1,0]
  v_pk_mul_f32 v[26:27], v[24:25], v[12:13] op_sel:[0,0] op_sel_hi:[0,1]
  ds_write_b32 v88, v54 offset:11424
  v_pk_fma_f32 v[26:27], v[24:25], v[12:13], v[26:27] op_sel:[1,1,0] op_sel_hi:[1,0,1] neg_lo:[0,1,0]
  v_pk_mul_f32 v[28:29], v[24:25], v[20:21] op_sel:[0,0] op_sel_hi:[0,1]
  v_pk_mul_f32 v[32:33], v[14:15], v[14:15] op_sel:[0,0] op_sel_hi:[0,1]
  v_pk_fma_f32 v[28:29], v[24:25], v[20:21], v[28:29] op_sel:[1,1,0] op_sel_hi:[1,0,1] neg_lo:[0,1,0]
  v_pk_mul_f32 v[30:31], v[24:25], v[22:23] op_sel:[0,0] op_sel_hi:[0,1]
  v_pk_fma_f32 v[32:33], v[14:15], v[14:15], v[32:33] op_sel:[1,1,0] op_sel_hi:[1,0,1] neg_lo:[0,1,0]
  v_pk_fma_f32 v[30:31], v[24:25], v[22:23], v[30:31] op_sel:[1,1,0] op_sel_hi:[1,0,1] neg_lo:[0,1,0]
  v_pk_mul_f32 v[48:49], v[18:19], v[16:17] op_sel:[0,0] op_sel_hi:[0,1]
  v_cvt_pk_bf16_f32 v54, v32, v33
  v_pk_fma_f32 v[48:49], v[18:19], v[16:17], v[48:49] op_sel:[1,1,0] op_sel_hi:[1,0,1] neg_lo:[0,1,0]
  v_cvt_pk_bf16_f32 v61, v18, -v19
  ds_write_b32 v88, v54 offset:11696
  ds_write_b32 v88, v61 offset:0
  v_pk_mul_f32 v[52:53], v[18:19], v[12:13] op_sel:[0,0] op_sel_hi:[0,1]
  v_pk_mul_f32 v[34:35], v[32:33], v[14:15] op_sel:[0,0] op_sel_hi:[0,1]
  v_pk_fma_f32 v[52:53], v[18:19], v[12:13], v[52:53] op_sel:[1,1,0] op_sel_hi:[1,0,1] neg_lo:[0,1,0]
  v_cvt_pk_bf16_f32 v62, v52, -v53
  v_pk_fma_f32 v[34:35], v[32:33], v[14:15], v[34:35] op_sel:[1,1,0] op_sel_hi:[1,0,1] neg_lo:[0,1,0]
  ds_write_b32 v88, v62 offset:272
  v_pk_mul_f32 v[52:53], v[18:19], v[20:21] op_sel:[0,0] op_sel_hi:[0,1]
  v_cvt_pk_bf16_f32 v54, v34, v35
  v_pk_fma_f32 v[52:53], v[18:19], v[20:21], v[52:53] op_sel:[1,1,0] op_sel_hi:[1,0,1] neg_lo:[0,1,0]
  v_cvt_pk_bf16_f32 v62, v52, -v53
  ds_write_b32 v88, v54 offset:11968
  ds_write_b32 v88, v62 offset:544
  v_pk_mul_f32 v[52:53], v[18:19], v[22:23] op_sel:[0,0] op_sel_hi:[0,1]
  v_pk_mul_f32 v[36:37], v[32:33], v[32:33] op_sel:[0,0] op_sel_hi:[0,1]
  v_pk_fma_f32 v[52:53], v[18:19], v[22:23], v[52:53] op_sel:[1,1,0] op_sel_hi:[1,0,1] neg_lo:[0,1,0]
  v_cvt_pk_bf16_f32 v62, v52, -v53
  v_pk_fma_f32 v[36:37], v[32:33], v[32:33], v[36:37] op_sel:[1,1,0] op_sel_hi:[1,0,1] neg_lo:[0,1,0]
  ds_write_b32 v88, v62 offset:816
  v_pk_mul_f32 v[52:53], v[18:19], v[24:25] op_sel:[0,0] op_sel_hi:[0,1]
  v_cvt_pk_bf16_f32 v54, v36, v37
  v_pk_fma_f32 v[52:53], v[18:19], v[24:25], v[52:53] op_sel:[1,1,0] op_sel_hi:[1,0,1] neg_lo:[0,1,0]
  v_cvt_pk_bf16_f32 v62, v52, -v53
  ds_write_b32 v88, v54 offset:12240
  ds_write_b32 v88, v62 offset:1088
  v_pk_mul_f32 v[52:53], v[18:19], v[26:27] op_sel:[0,0] op_sel_hi:[0,1]
  v_pk_mul_f32 v[38:39], v[36:37], v[14:15] op_sel:[0,0] op_sel_hi:[0,1]
  v_pk_fma_f32 v[52:53], v[18:19], v[26:27], v[52:53] op_sel:[1,1,0] op_sel_hi:[1,0,1] neg_lo:[0,1,0]
  v_cvt_pk_bf16_f32 v62, v52, -v53
  v_pk_fma_f32 v[38:39], v[36:37], v[14:15], v[38:39] op_sel:[1,1,0] op_sel_hi:[1,0,1] neg_lo:[0,1,0]
  ds_write_b32 v88, v62 offset:1360
  v_pk_mul_f32 v[52:53], v[18:19], v[28:29] op_sel:[0,0] op_sel_hi:[0,1]
  v_cvt_pk_bf16_f32 v54, v38, v39
  v_pk_fma_f32 v[52:53], v[18:19], v[28:29], v[52:53] op_sel:[1,1,0] op_sel_hi:[1,0,1] neg_lo:[0,1,0]
  v_cvt_pk_bf16_f32 v62, v52, -v53
  ds_write_b32 v88, v54 offset:12512
  ds_write_b32 v88, v62 offset:1632
  v_pk_mul_f32 v[52:53], v[18:19], v[30:31] op_sel:[0,0] op_sel_hi:[0,1]
  v_pk_mul_f32 v[40:41], v[36:37], v[32:33] op_sel:[0,0] op_sel_hi:[0,1]
  v_pk_fma_f32 v[52:53], v[18:19], v[30:31], v[52:53] op_sel:[1,1,0] op_sel_hi:[1,0,1] neg_lo:[0,1,0]
  v_cvt_pk_bf16_f32 v62, v52, -v53
  v_pk_fma_f32 v[40:41], v[36:37], v[32:33], v[40:41] op_sel:[1,1,0] op_sel_hi:[1,0,1] neg_lo:[0,1,0]
  ds_write_b32 v88, v62 offset:1904
  v_pk_mul_f32 v[50:51], v[48:49], v[16:17] op_sel:[0,0] op_sel_hi:[0,1]
  v_cvt_pk_bf16_f32 v54, v40, v41
  v_pk_fma_f32 v[50:51], v[48:49], v[16:17], v[50:51] op_sel:[1,1,0] op_sel_hi:[1,0,1] neg_lo:[0,1,0]
  v_cvt_pk_bf16_f32 v61, v48, -v49
  ds_write_b32 v88, v54 offset:12784
  ds_write_b32 v88, v61 offset:2176
  v_pk_mul_f32 v[52:53], v[48:49], v[12:13] op_sel:[0,0] op_sel_hi:[0,1]
  v_pk_mul_f32 v[42:43], v[36:37], v[34:35] op_sel:[0,0] op_sel_hi:[0,1]
  v_pk_fma_f32 v[52:53], v[48:49], v[12:13], v[52:53] op_sel:[1,1,0] op_sel_hi:[1,0,1] neg_lo:[0,1,0]
  v_cvt_pk_bf16_f32 v62, v52, -v53
  v_pk_fma_f32 v[42:43], v[36:37], v[34:35], v[42:43] op_sel:[1,1,0] op_sel_hi:[1,0,1] neg_lo:[0,1,0]
  ds_write_b32 v88, v62 offset:2448
  v_pk_mul_f32 v[52:53], v[48:49], v[20:21] op_sel:[0,0] op_sel_hi:[0,1]
  v_cvt_pk_bf16_f32 v54, v42, v43
  v_pk_fma_f32 v[52:53], v[48:49], v[20:21], v[52:53] op_sel:[1,1,0] op_sel_hi:[1,0,1] neg_lo:[0,1,0]
  v_cvt_pk_bf16_f32 v62, v52, -v53
  ds_write_b32 v88, v54 offset:13056
  ds_write_b32 v88, v62 offset:2720
  v_pk_mul_f32 v[52:53], v[48:49], v[22:23] op_sel:[0,0] op_sel_hi:[0,1]
  v_pk_mul_f32 v[44:45], v[36:37], v[36:37] op_sel:[0,0] op_sel_hi:[0,1]
  v_pk_fma_f32 v[52:53], v[48:49], v[22:23], v[52:53] op_sel:[1,1,0] op_sel_hi:[1,0,1] neg_lo:[0,1,0]
  v_cvt_pk_bf16_f32 v62, v52, -v53
  v_pk_fma_f32 v[44:45], v[36:37], v[36:37], v[44:45] op_sel:[1,1,0] op_sel_hi:[1,0,1] neg_lo:[0,1,0]
  ds_write_b32 v88, v62 offset:2992
  v_pk_mul_f32 v[52:53], v[48:49], v[24:25] op_sel:[0,0] op_sel_hi:[0,1]
  v_cvt_pk_bf16_f32 v54, v44, v45
  v_pk_fma_f32 v[52:53], v[48:49], v[24:25], v[52:53] op_sel:[1,1,0] op_sel_hi:[1,0,1] neg_lo:[0,1,0]
  v_cvt_pk_bf16_f32 v62, v52, -v53
  ds_write_b32 v88, v54 offset:13328
  ds_write_b32 v88, v62 offset:3264
  v_pk_mul_f32 v[52:53], v[48:49], v[26:27] op_sel:[0,0] op_sel_hi:[0,1]
  v_pk_mul_f32 v[46:47], v[44:45], v[14:15] op_sel:[0,0] op_sel_hi:[0,1]
  v_pk_fma_f32 v[52:53], v[48:49], v[26:27], v[52:53] op_sel:[1,1,0] op_sel_hi:[1,0,1] neg_lo:[0,1,0]
  v_cvt_pk_bf16_f32 v62, v52, -v53
  v_pk_fma_f32 v[46:47], v[44:45], v[14:15], v[46:47] op_sel:[1,1,0] op_sel_hi:[1,0,1] neg_lo:[0,1,0]
  ds_write_b32 v88, v62 offset:3536
  v_pk_mul_f32 v[52:53], v[48:49], v[28:29] op_sel:[0,0] op_sel_hi:[0,1]
  v_cvt_pk_bf16_f32 v54, v46, v47
  v_pk_fma_f32 v[52:53], v[48:49], v[28:29], v[52:53] op_sel:[1,1,0] op_sel_hi:[1,0,1] neg_lo:[0,1,0]
  v_cvt_pk_bf16_f32 v62, v52, -v53
  ds_write_b32 v88, v54 offset:13600
  ds_write_b32 v88, v62 offset:3808
  v_pk_mul_f32 v[52:53], v[48:49], v[30:31] op_sel:[0,0] op_sel_hi:[0,1]
  v_pk_mul_f32 v[46:47], v[44:45], v[32:33] op_sel:[0,0] op_sel_hi:[0,1]
  v_pk_fma_f32 v[52:53], v[48:49], v[30:31], v[52:53] op_sel:[1,1,0] op_sel_hi:[1,0,1] neg_lo:[0,1,0]
  v_cvt_pk_bf16_f32 v62, v52, -v53
  v_pk_fma_f32 v[46:47], v[44:45], v[32:33], v[46:47] op_sel:[1,1,0] op_sel_hi:[1,0,1] neg_lo:[0,1,0]
  ds_write_b32 v88, v62 offset:4080
  v_pk_mul_f32 v[48:49], v[50:51], v[16:17] op_sel:[0,0] op_sel_hi:[0,1]
  v_cvt_pk_bf16_f32 v54, v46, v47
  v_pk_fma_f32 v[48:49], v[50:51], v[16:17], v[48:49] op_sel:[1,1,0] op_sel_hi:[1,0,1] neg_lo:[0,1,0]
  v_cvt_pk_bf16_f32 v61, v50, -v51
  ds_write_b32 v88, v54 offset:13872
  ds_write_b32 v88, v61 offset:4352
  v_pk_mul_f32 v[52:53], v[50:51], v[20:21] op_sel:[0,0] op_sel_hi:[0,1]
  v_pk_mul_f32 v[46:47], v[44:45], v[34:35] op_sel:[0,0] op_sel_hi:[0,1]
  v_pk_fma_f32 v[52:53], v[50:51], v[20:21], v[52:53] op_sel:[1,1,0] op_sel_hi:[1,0,1] neg_lo:[0,1,0]
  v_cvt_pk_bf16_f32 v62, v52, -v53
  v_pk_fma_f32 v[46:47], v[44:45], v[34:35], v[46:47] op_sel:[1,1,0] op_sel_hi:[1,0,1] neg_lo:[0,1,0]
  ds_write_b32 v88, v62 offset:4624
  v_pk_mul_f32 v[52:53], v[50:51], v[24:25] op_sel:[0,0] op_sel_hi:[0,1]
  v_cvt_pk_bf16_f32 v54, v46, v47
  v_pk_fma_f32 v[52:53], v[50:51], v[24:25], v[52:53] op_sel:[1,1,0] op_sel_hi:[1,0,1] neg_lo:[0,1,0]
  v_cvt_pk_bf16_f32 v62, v52, -v53
  ds_write_b32 v88, v54 offset:14144
  ds_write_b32 v88, v62 offset:4896
  v_pk_mul_f32 v[52:53], v[50:51], v[28:29] op_sel:[0,0] op_sel_hi:[0,1]
  v_pk_mul_f32 v[46:47], v[44:45], v[36:37] op_sel:[0,0] op_sel_hi:[0,1]
  v_pk_fma_f32 v[52:53], v[50:51], v[28:29], v[52:53] op_sel:[1,1,0] op_sel_hi:[1,0,1] neg_lo:[0,1,0]
  v_cvt_pk_bf16_f32 v62, v52, -v53
  v_pk_fma_f32 v[46:47], v[44:45], v[36:37], v[46:47] op_sel:[1,1,0] op_sel_hi:[1,0,1] neg_lo:[0,1,0]
  ds_write_b32 v88, v62 offset:5168
  v_pk_mul_f32 v[50:51], v[48:49], v[16:17] op_sel:[0,0] op_sel_hi:[0,1]
  v_cvt_pk_bf16_f32 v54, v46, v47
  v_pk_fma_f32 v[50:51], v[48:49], v[16:17], v[50:51] op_sel:[1,1,0] op_sel_hi:[1,0,1] neg_lo:[0,1,0]
  v_cvt_pk_bf16_f32 v61, v48, -v49
  ds_write_b32 v88, v54 offset:14416
  ds_write_b32 v88, v61 offset:5440
  v_pk_mul_f32 v[52:53], v[48:49], v[20:21] op_sel:[0,0] op_sel_hi:[0,1]
  v_pk_mul_f32 v[46:47], v[44:45], v[38:39] op_sel:[0,0] op_sel_hi:[0,1]
  v_pk_fma_f32 v[52:53], v[48:49], v[20:21], v[52:53] op_sel:[1,1,0] op_sel_hi:[1,0,1] neg_lo:[0,1,0]
  v_cvt_pk_bf16_f32 v62, v52, -v53
  v_pk_fma_f32 v[46:47], v[44:45], v[38:39], v[46:47] op_sel:[1,1,0] op_sel_hi:[1,0,1] neg_lo:[0,1,0]
  ds_write_b32 v88, v62 offset:5712
  v_pk_mul_f32 v[52:53], v[48:49], v[24:25] op_sel:[0,0] op_sel_hi:[0,1]
  v_cvt_pk_bf16_f32 v54, v46, v47
  v_pk_fma_f32 v[52:53], v[48:49], v[24:25], v[52:53] op_sel:[1,1,0] op_sel_hi:[1,0,1] neg_lo:[0,1,0]
  v_cvt_pk_bf16_f32 v62, v52, -v53
  ds_write_b32 v88, v54 offset:14688
  ds_write_b32 v88, v62 offset:5984
  v_pk_mul_f32 v[52:53], v[48:49], v[28:29] op_sel:[0,0] op_sel_hi:[0,1]
  v_pk_mul_f32 v[46:47], v[44:45], v[40:41] op_sel:[0,0] op_sel_hi:[0,1]
  v_pk_fma_f32 v[52:53], v[48:49], v[28:29], v[52:53] op_sel:[1,1,0] op_sel_hi:[1,0,1] neg_lo:[0,1,0]
  v_cvt_pk_bf16_f32 v62, v52, -v53
  v_pk_fma_f32 v[46:47], v[44:45], v[40:41], v[46:47] op_sel:[1,1,0] op_sel_hi:[1,0,1] neg_lo:[0,1,0]
  ds_write_b32 v88, v62 offset:6256
  v_pk_mul_f32 v[48:49], v[50:51], v[16:17] op_sel:[0,0] op_sel_hi:[0,1]
  v_cvt_pk_bf16_f32 v54, v46, v47
  v_pk_fma_f32 v[48:49], v[50:51], v[16:17], v[48:49] op_sel:[1,1,0] op_sel_hi:[1,0,1] neg_lo:[0,1,0]
  v_cvt_pk_bf16_f32 v61, v50, -v51
  ds_write_b32 v88, v54 offset:14960
  ds_write_b32 v88, v61 offset:6528
  v_pk_mul_f32 v[52:53], v[50:51], v[24:25] op_sel:[0,0] op_sel_hi:[0,1]
  v_pk_mul_f32 v[46:47], v[44:45], v[42:43] op_sel:[0,0] op_sel_hi:[0,1]
  v_pk_fma_f32 v[52:53], v[50:51], v[24:25], v[52:53] op_sel:[1,1,0] op_sel_hi:[1,0,1] neg_lo:[0,1,0]
  v_cvt_pk_bf16_f32 v62, v52, -v53
  v_pk_fma_f32 v[46:47], v[44:45], v[42:43], v[46:47] op_sel:[1,1,0] op_sel_hi:[1,0,1] neg_lo:[0,1,0]
  ds_write_b32 v88, v62 offset:6800
  v_pk_mul_f32 v[50:51], v[48:49], v[16:17] op_sel:[0,0] op_sel_hi:[0,1]
  v_cvt_pk_bf16_f32 v54, v46, v47
  v_pk_fma_f32 v[50:51], v[48:49], v[16:17], v[50:51] op_sel:[1,1,0] op_sel_hi:[1,0,1] neg_lo:[0,1,0]
  v_cvt_pk_bf16_f32 v61, v48, -v49
  ds_write_b32 v88, v54 offset:15232
  ds_write_b32 v88, v61 offset:7072
  v_pk_mul_f32 v[52:53], v[48:49], v[24:25] op_sel:[0,0] op_sel_hi:[0,1]
  v_pk_fma_f32 v[52:53], v[48:49], v[24:25], v[52:53] op_sel:[1,1,0] op_sel_hi:[1,0,1] neg_lo:[0,1,0]
  v_cvt_pk_bf16_f32 v62, v52, -v53
  ds_write_b32 v88, v62 offset:7344
  v_pk_mul_f32 v[48:49], v[50:51], v[16:17] op_sel:[0,0] op_sel_hi:[0,1]
  v_pk_fma_f32 v[48:49], v[50:51], v[16:17], v[48:49] op_sel:[1,1,0] op_sel_hi:[1,0,1] neg_lo:[0,1,0]
  v_cvt_pk_bf16_f32 v61, v50, -v51
  ds_write_b32 v88, v61 offset:7616
  v_pk_mul_f32 v[52:53], v[50:51], v[24:25] op_sel:[0,0] op_sel_hi:[0,1]
  v_pk_fma_f32 v[52:53], v[50:51], v[24:25], v[52:53] op_sel:[1,1,0] op_sel_hi:[1,0,1] neg_lo:[0,1,0]
  v_cvt_pk_bf16_f32 v62, v52, -v53
  ds_write_b32 v88, v62 offset:7888
  v_pk_mul_f32 v[50:51], v[48:49], v[16:17] op_sel:[0,0] op_sel_hi:[0,1]
  v_pk_fma_f32 v[50:51], v[48:49], v[16:17], v[50:51] op_sel:[1,1,0] op_sel_hi:[1,0,1] neg_lo:[0,1,0]
  v_cvt_pk_bf16_f32 v61, v48, -v49
  ds_write_b32 v88, v61 offset:8160
  v_pk_mul_f32 v[52:53], v[48:49], v[24:25] op_sel:[0,0] op_sel_hi:[0,1]
  v_pk_fma_f32 v[52:53], v[48:49], v[24:25], v[52:53] op_sel:[1,1,0] op_sel_hi:[1,0,1] neg_lo:[0,1,0]
  v_cvt_pk_bf16_f32 v62, v52, -v53
  ds_write_b32 v88, v62 offset:8432
  v_pk_mul_f32 v[48:49], v[50:51], v[16:17] op_sel:[0,0] op_sel_hi:[0,1]
  v_pk_fma_f32 v[48:49], v[50:51], v[16:17], v[48:49] op_sel:[1,1,0] op_sel_hi:[1,0,1] neg_lo:[0,1,0]
  v_cvt_pk_bf16_f32 v61, v50, -v51
  ds_write_b32 v88, v61 offset:8704
  v_pk_mul_f32 v[50:51], v[48:49], v[16:17] op_sel:[0,0] op_sel_hi:[0,1]
  v_pk_fma_f32 v[50:51], v[48:49], v[16:17], v[50:51] op_sel:[1,1,0] op_sel_hi:[1,0,1] neg_lo:[0,1,0]
  v_cvt_pk_bf16_f32 v61, v48, -v49
  ds_write_b32 v88, v61 offset:8976
  v_pk_mul_f32 v[48:49], v[50:51], v[16:17] op_sel:[0,0] op_sel_hi:[0,1]
  v_pk_fma_f32 v[48:49], v[50:51], v[16:17], v[48:49] op_sel:[1,1,0] op_sel_hi:[1,0,1] neg_lo:[0,1,0]
  v_cvt_pk_bf16_f32 v61, v50, -v51
  ds_write_b32 v88, v61 offset:9248
  v_pk_mul_f32 v[50:51], v[48:49], v[16:17] op_sel:[0,0] op_sel_hi:[0,1]
  v_pk_fma_f32 v[50:51], v[48:49], v[16:17], v[50:51] op_sel:[1,1,0] op_sel_hi:[1,0,1] neg_lo:[0,1,0]
  v_cvt_pk_bf16_f32 v61, v48, -v49
  ds_write_b32 v88, v61 offset:9520
  v_pk_mul_f32 v[48:49], v[50:51], v[16:17] op_sel:[0,0] op_sel_hi:[0,1]
  v_pk_fma_f32 v[48:49], v[50:51], v[16:17], v[48:49] op_sel:[1,1,0] op_sel_hi:[1,0,1] neg_lo:[0,1,0]
  v_cvt_pk_bf16_f32 v61, v50, -v51
  ds_write_b32 v88, v61 offset:9792
  v_pk_mul_f32 v[50:51], v[48:49], v[16:17] op_sel:[0,0] op_sel_hi:[0,1]
  v_pk_fma_f32 v[50:51], v[48:49], v[16:17], v[50:51] op_sel:[1,1,0] op_sel_hi:[1,0,1] neg_lo:[0,1,0]
  v_cvt_pk_bf16_f32 v61, v48, -v49
  ds_write_b32 v88, v61 offset:10064
  v_pk_mul_f32 v[48:49], v[50:51], v[16:17] op_sel:[0,0] op_sel_hi:[0,1]
  v_pk_fma_f32 v[48:49], v[50:51], v[16:17], v[48:49] op_sel:[1,1,0] op_sel_hi:[1,0,1] neg_lo:[0,1,0]
  v_cvt_pk_bf16_f32 v61, v50, -v51
  ds_write_b32 v88, v61 offset:10336
  v_pk_mul_f32 v[50:51], v[48:49], v[16:17] op_sel:[0,0] op_sel_hi:[0,1]
  v_pk_fma_f32 v[50:51], v[48:49], v[16:17], v[50:51] op_sel:[1,1,0] op_sel_hi:[1,0,1] neg_lo:[0,1,0]
  v_cvt_pk_bf16_f32 v61, v48, -v49
  ds_write_b32 v88, v61 offset:10608
  v_cvt_pk_bf16_f32 v61, v50, -v51
  ds_write_b32 v88, v61 offset:10880
  s_waitcnt lgkmcnt(0)
  ds_read_b128 v[12:15], v90 offset:11152
  ds_read_b128 v[16:19], v90 offset:0
  ds_read_b128 v[20:23], v90 offset:4352
  ds_read_b128 v[24:27], v90 offset:8704
  ds_read_b128 v[28:31], v90 offset:11216
  ds_read_b128 v[32:35], v90 offset:64
  ds_read_b128 v[36:39], v90 offset:4416
  ds_read_b128 v[40:43], v90 offset:8768
  ds_read_b128 v[44:47], v90 offset:11280
  ds_read_b128 v[48:51], v90 offset:128
  ds_read_b128 v[52:55], v90 offset:4480
  ds_read_b128 v[56:59], v90 offset:8832
  s_waitcnt lgkmcnt(8)
  ds_read_b128 v[60:63], v90 offset:11344
  ds_read_b128 v[64:67], v90 offset:192
  ds_read_b128 v[68:71], v90 offset:4544
  ds_read_b128 v[72:75], v90 offset:8896
  s_waitcnt lgkmcnt(8)
  v_mfma_f32_16x16x32_bf16 v[76:79], v[16:19], v[12:15], v[76:79]
  v_mfma_f32_16x16x32_bf16 v[80:83], v[20:23], v[12:15], v[80:83]
  v_mfma_f32_16x16x32_bf16 v[84:87], v[24:27], v[12:15], v[84:87]
  s_waitcnt lgkmcnt(8)
  v_mfma_f32_16x16x32_bf16 v[76:79], v[32:35], v[28:31], v[76:79]
  v_mfma_f32_16x16x32_bf16 v[80:83], v[36:39], v[28:31], v[80:83]
  v_mfma_f32_16x16x32_bf16 v[84:87], v[40:43], v[28:31], v[84:87]
  s_waitcnt lgkmcnt(4)
  v_mfma_f32_16x16x32_bf16 v[76:79], v[48:51], v[44:47], v[76:79]
  v_mfma_f32_16x16x32_bf16 v[80:83], v[52:55], v[44:47], v[80:83]
  v_mfma_f32_16x16x32_bf16 v[84:87], v[56:59], v[44:47], v[84:87]
  s_waitcnt lgkmcnt(0)
  v_mfma_f32_16x16x32_bf16 v[76:79], v[64:67], v[60:63], v[76:79]
  v_mfma_f32_16x16x32_bf16 v[80:83], v[68:71], v[60:63], v[80:83]
  v_mfma_f32_16x16x32_bf16 v[84:87], v[72:75], v[60:63], v[84:87]
  v_mul_u32_u24 v12, 208, v89
  v_lshl_add_u32 v12, v91, 4, v12
  v_add_u32 v12, s44, v12
  s_and_b32 s47, s19, 2
  s_mul_i32 s47, s47, 15616
  s_nop 0
  ds_write_b128 v12, v[76:79] offset:0
  ds_write_b128 v12, v[80:83] offset:64
  ds_write_b128 v12, v[84:87] offset:128
  v_add_u32 v13, 1, v1
  v_and_b32 v14, 15, v13
  v_lshrrev_b32 v13, 4, v13
  v_mul_u32_u24 v15, 208, v89
  v_add_u32 v15, s47, v15
  v_mul_u32_u24 v14, 208, v14
  v_add_u32 v14, s47, v14
  v_sub_u32 v42, 255, v1
  v_lshlrev_b32 v42, 4, v42
  s_mul_i32 s45, s21, 4160
  s_waitcnt lgkmcnt(0)
  s_barrier
  s_cmp_eq_u32 s46, 1
  s_cbranch_scc1 L_k1_kernel_h1_1
  v_lshlrev_b32 v16, 3, v91
  v_lshlrev_b32 v17, 2, v91
  v_add_u32 v17, 8, v17
  v_cmp_gt_u32 vcc, 2, v91
  s_nop 1
  v_cndmask_b32 v16, v17, v16, vcc
  v_lshl_add_u32 v16, v16, 2, v15
  v_lshlrev_b32 v17, 2, v13
  v_add_u32 v17, 8, v17
  v_lshl_add_u32 v17, v17, 2, v14
  ds_read_b128 v[24:27], v16
  ds_read_b128 v[28:31], v16 offset:16
  ds_read_b32 v32, v17
  ds_read_b128 v[64:67], v16 offset:15616
  ds_read_b128 v[68:71], v16 offset:15632
  ds_read_b32 v72, v17 offset:15616
  v_cmp_gt_u32 vcc, 32, v1
  s_waitcnt lgkmcnt(0)
  v_pk_add_f32 v[24:25], v[24:25], v[64:65]
  v_pk_add_f32 v[26:27], v[26:27], v[66:67]
  v_pk_add_f32 v[28:29], v[28:29], v[68:69]
  v_pk_add_f32 v[30:31], v[30:31], v[70:71]
  v_add_f32 v32, v32, v72
  v_cndmask_b32 v44, v24, v25, vcc
  v_cndmask_b32 v45, v25, v26, vcc
  v_cndmask_b32 v46, v26, v27, vcc
  v_cndmask_b32 v47, v26, v28, vcc
  v_cndmask_b32 v48, v26, v29, vcc
  v_cndmask_b32 v49, v27, v30, vcc
  v_cndmask_b32 v50, v32, v31, vcc
  v_cvt_pk_bf16_f32 v52, v50, v49
  v_cvt_pk_bf16_f32 v53, v48, v47
  v_cvt_pk_bf16_f32 v54, v46, v45
  v_cvt_pk_bf16_f32 v55, v44, v24
  buffer_store_dwordx4 v[52:55], v42, s[48:51], s45 offen sc1
  v_mov_b32 v72, 0
  v_mov_b32 v73, 0
  v_mov_b32 v74, 0
  v_mov_b32 v75, 0
  v_lshlrev_b32 v43, 4, v1
  v_add_u32 v43, 4096, v43
  v_cmp_gt_u32 vcc, 4, v1
  s_nop 2
  s_and_saveexec_b64 s[52:53], vcc
  buffer_store_dwordx4 v[72:75], v43, s[48:51], s45 offen sc1
  s_mov_b64 exec, s[52:53]
  s_branch k1_kernel_end
L_k1_kernel_h1_1:
  v_lshl_add_u32 v18, v91, 3, v15
  v_lshl_add_u32 v19, v13, 3, v14
  v_lshl_add_u32 v20, v91, 2, v15
  v_lshl_add_u32 v21, v13, 2, v14
  ds_read_b64 v[34:35], v18 offset:96
  ds_read_b32 v36, v19 offset:96
  ds_read_b32 v38, v20 offset:128
  ds_read_b32 v39, v21 offset:128
  ds_read_b32 v40, v20 offset:144
  ds_read_b32 v41, v21 offset:144
  ds_read_b64 v[64:65], v18 offset:15712
  ds_read_b32 v66, v19 offset:15712
  ds_read_b32 v68, v20 offset:15744
  ds_read_b32 v69, v21 offset:15744
  ds_read_b32 v70, v20 offset:15760
  ds_read_b32 v71, v21 offset:15760
  v_and_b32 v60, 1, v1
  v_cmp_eq_u32 vcc, 0, v60
  s_waitcnt lgkmcnt(0)
  v_pk_add_f32 v[34:35], v[34:35], v[64:65]
  v_add_f32 v36, v36, v66
  v_pk_add_f32 v[38:39], v[38:39], v[68:69]
  v_pk_add_f32 v[40:41], v[40:41], v[70:71]
  v_cvt_pk_bf16_f32 v56, v36, v36
  v_cvt_pk_bf16_f32 v57, v35, v35
  v_cvt_pk_bf16_f32 v58, v35, v34
  v_cvt_pk_bf16_f32 v59, v34, v34
  v_subrev_u32 v43, 1024, v42
  buffer_store_dwordx4 v[56:59], v43, s[48:51], s45 offen sc1
  v_cndmask_b32 v61, v39, v38, vcc
  v_cvt_pk_bf16_f32 v64, v39, v39
  v_cvt_pk_bf16_f32 v65, v39, v61
  v_cvt_pk_bf16_f32 v66, v38, v38
  v_cvt_pk_bf16_f32 v67, v38, v38
  v_subrev_u32 v43, 2048, v42
  buffer_store_dwordx4 v[64:67], v43, s[48:51], s45 offen sc1
  v_cndmask_b32 v61, v41, v40, vcc
  v_cvt_pk_bf16_f32 v68, v41, v41
  v_cvt_pk_bf16_f32 v69, v41, v61
  v_cvt_pk_bf16_f32 v70, v40, v40
  v_cvt_pk_bf16_f32 v71, v40, v40
  v_subrev_u32 v43, 3072, v42
  buffer_store_dwordx4 v[68:71], v43, s[48:51], s45 offen sc1
  s_branch k1_kernel_end
k1_kernel_gv:
  s_sub_u32 s20, s2, 320
  s_load_dwordx2 s[6:7], s[0:1], 96
  s_load_dwordx2 s[16:17], s[0:1], 88
  s_and_b32 s26, s20, 1
  s_lshr_b32 s20, s20, 1
  v_lshrrev_b32 v2, 3, v0
  v_and_b32 v3, 7, v0
  v_mul_u32_u24 v1, 7680, v2
  v_lshl_add_u32 v1, v3, 4, v1
  s_lshl_b32 s21, s20, 7
  s_mul_i32 s27, s26, 2457600
  s_add_u32 s21, s21, s27
  v_add_u32 v1, s21, v1
  v_lshlrev_b32 v4, 1, v0
  s_mul_i32 s27, s26, 640
  s_waitcnt lgkmcnt(0)
  s_mov_b32 s8, s6
  s_mov_b32 s9, s7
  s_mov_b32 s10, 4915200
  s_mov_b32 s11, 0x20000
  s_mov_b32 s12, s16
  s_mov_b32 s13, s17
  s_mov_b32 s14, 1280
  s_mov_b32 s15, 0x20000
  buffer_load_ushort v5, v4, s[12:15], s27 offen offset:0
  buffer_load_ushort v6, v4, s[12:15], s27 offen offset:512
  s_mov_b32 s22, 0
  buffer_load_dwordx4 v[16:19], v1, s[8:11], s22 offen nt
  s_mov_b32 s22, 245760
  buffer_load_dwordx4 v[20:23], v1, s[8:11], s22 offen nt
  s_mov_b32 s22, 491520
  buffer_load_dwordx4 v[24:27], v1, s[8:11], s22 offen nt
  s_mov_b32 s22, 737280
  buffer_load_dwordx4 v[28:31], v1, s[8:11], s22 offen nt
  s_mov_b32 s22, 983040
  buffer_load_dwordx4 v[32:35], v1, s[8:11], s22 offen nt
  s_mov_b32 s22, 1228800
  buffer_load_dwordx4 v[36:39], v1, s[8:11], s22 offen nt
  s_mov_b32 s22, 1474560
  buffer_load_dwordx4 v[40:43], v1, s[8:11], s22 offen nt
  s_mov_b32 s22, 1720320
  buffer_load_dwordx4 v[44:47], v1, s[8:11], s22 offen nt
  s_mov_b32 s22, 1966080
  buffer_load_dwordx4 v[48:51], v1, s[8:11], s22 offen nt
  s_mov_b32 s22, 2211840
  buffer_load_dwordx4 v[52:55], v1, s[8:11], s22 offen nt
  v_lshlrev_b32 v8, 2, v0
  s_waitcnt vmcnt(10)
  v_lshlrev_b32 v5, 16, v5
  v_mul_f32 v9, 0xbfb8aa3b, v5
  v_exp_f32 v9, v9
  s_nop 0
  v_add_f32 v9, 1.0, v9
  v_rcp_f32 v9, v9
  s_nop 0
  v_mul_f32 v9, v5, v9
  v_cvt_pk_bf16_f32 v9, v9, v9
  v_and_b32 v9, 0xffff0000, v9
  ds_write_b32 v8, v9 offset:0
  v_lshlrev_b32 v6, 16, v6
  v_mul_f32 v9, 0xbfb8aa3b, v6
  v_exp_f32 v9, v9
  s_nop 0
  v_add_f32 v9, 1.0, v9
  v_rcp_f32 v9, v9
  s_nop 0
  v_mul_f32 v9, v6, v9
  v_cvt_pk_bf16_f32 v9, v9, v9
  v_and_b32 v9, 0xffff0000, v9
  ds_write_b32 v8, v9 offset:1024
  s_waitcnt lgkmcnt(0)
  s_barrier
  v_lshlrev_b32 v9, 2, v2
  ds_read_b32 v96, v9 offset:0
  ds_read_b32 v97, v9 offset:128
  ds_read_b32 v98, v9 offset:256
  ds_read_b32 v99, v9 offset:384
  ds_read_b32 v100, v9 offset:512
  ds_read_b32 v101, v9 offset:640
  ds_read_b32 v102, v9 offset:768
  ds_read_b32 v103, v9 offset:896
  ds_read_b32 v104, v9 offset:1024
  ds_read_b32 v105, v9 offset:1152
  v_mov_b32 v116, 0
  v_mov_b32 v117, 0
  v_mov_b32 v118, 0
  v_mov_b32 v119, 0
  v_mov_b32 v120, 0
  v_mov_b32 v121, 0
  v_mov_b32 v122, 0
  v_mov_b32 v123, 0
  s_waitcnt lgkmcnt(0)
  s_waitcnt vmcnt(9)
  v_lshlrev_b32 v124, 16, v16
  v_and_b32 v125, 0xffff0000, v16
  v_pk_fma_f32 v[116:117], v[124:125], v[96:97], v[116:117] op_sel:[0,0,0] op_sel_hi:[1,0,1]
  v_lshlrev_b32 v126, 16, v17
  v_and_b32 v127, 0xffff0000, v17
  v_pk_fma_f32 v[118:119], v[126:127], v[96:97], v[118:119] op_sel:[0,0,0] op_sel_hi:[1,0,1]
  v_lshlrev_b32 v124, 16, v18
  v_and_b32 v125, 0xffff0000, v18
  v_pk_fma_f32 v[120:121], v[124:125], v[96:97], v[120:121] op_sel:[0,0,0] op_sel_hi:[1,0,1]
  v_lshlrev_b32 v126, 16, v19
  v_and_b32 v127, 0xffff0000, v19
  v_pk_fma_f32 v[122:123], v[126:127], v[96:97], v[122:123] op_sel:[0,0,0] op_sel_hi:[1,0,1]
  s_waitcnt vmcnt(8)
  v_lshlrev_b32 v124, 16, v20
  v_and_b32 v125, 0xffff0000, v20
  v_pk_fma_f32 v[116:117], v[124:125], v[96:97], v[116:117] op_sel:[0,1,0] op_sel_hi:[1,1,1]
  v_lshlrev_b32 v126, 16, v21
  v_and_b32 v127, 0xffff0000, v21
  v_pk_fma_f32 v[118:119], v[126:127], v[96:97], v[118:119] op_sel:[0,1,0] op_sel_hi:[1,1,1]
  v_lshlrev_b32 v124, 16, v22
  v_and_b32 v125, 0xffff0000, v22
  v_pk_fma_f32 v[120:121], v[124:125], v[96:97], v[120:121] op_sel:[0,1,0] op_sel_hi:[1,1,1]
  v_lshlrev_b32 v126, 16, v23
  v_and_b32 v127, 0xffff0000, v23
  v_pk_fma_f32 v[122:123], v[126:127], v[96:97], v[122:123] op_sel:[0,1,0] op_sel_hi:[1,1,1]
  s_waitcnt vmcnt(7)
  v_lshlrev_b32 v124, 16, v24
  v_and_b32 v125, 0xffff0000, v24
  v_pk_fma_f32 v[116:117], v[124:125], v[98:99], v[116:117] op_sel:[0,0,0] op_sel_hi:[1,0,1]
  v_lshlrev_b32 v126, 16, v25
  v_and_b32 v127, 0xffff0000, v25
  v_pk_fma_f32 v[118:119], v[126:127], v[98:99], v[118:119] op_sel:[0,0,0] op_sel_hi:[1,0,1]
  v_lshlrev_b32 v124, 16, v26
  v_and_b32 v125, 0xffff0000, v26
  v_pk_fma_f32 v[120:121], v[124:125], v[98:99], v[120:121] op_sel:[0,0,0] op_sel_hi:[1,0,1]
  v_lshlrev_b32 v126, 16, v27
  v_and_b32 v127, 0xffff0000, v27
  v_pk_fma_f32 v[122:123], v[126:127], v[98:99], v[122:123] op_sel:[0,0,0] op_sel_hi:[1,0,1]
  s_waitcnt vmcnt(6)
  v_lshlrev_b32 v124, 16, v28
  v_and_b32 v125, 0xffff0000, v28
  v_pk_fma_f32 v[116:117], v[124:125], v[98:99], v[116:117] op_sel:[0,1,0] op_sel_hi:[1,1,1]
  v_lshlrev_b32 v126, 16, v29
  v_and_b32 v127, 0xffff0000, v29
  v_pk_fma_f32 v[118:119], v[126:127], v[98:99], v[118:119] op_sel:[0,1,0] op_sel_hi:[1,1,1]
  v_lshlrev_b32 v124, 16, v30
  v_and_b32 v125, 0xffff0000, v30
  v_pk_fma_f32 v[120:121], v[124:125], v[98:99], v[120:121] op_sel:[0,1,0] op_sel_hi:[1,1,1]
  v_lshlrev_b32 v126, 16, v31
  v_and_b32 v127, 0xffff0000, v31
  v_pk_fma_f32 v[122:123], v[126:127], v[98:99], v[122:123] op_sel:[0,1,0] op_sel_hi:[1,1,1]
  s_waitcnt vmcnt(5)
  v_lshlrev_b32 v124, 16, v32
  v_and_b32 v125, 0xffff0000, v32
  v_pk_fma_f32 v[116:117], v[124:125], v[100:101], v[116:117] op_sel:[0,0,0] op_sel_hi:[1,0,1]
  v_lshlrev_b32 v126, 16, v33
  v_and_b32 v127, 0xffff0000, v33
  v_pk_fma_f32 v[118:119], v[126:127], v[100:101], v[118:119] op_sel:[0,0,0] op_sel_hi:[1,0,1]
  v_lshlrev_b32 v124, 16, v34
  v_and_b32 v125, 0xffff0000, v34
  v_pk_fma_f32 v[120:121], v[124:125], v[100:101], v[120:121] op_sel:[0,0,0] op_sel_hi:[1,0,1]
  v_lshlrev_b32 v126, 16, v35
  v_and_b32 v127, 0xffff0000, v35
  v_pk_fma_f32 v[122:123], v[126:127], v[100:101], v[122:123] op_sel:[0,0,0] op_sel_hi:[1,0,1]
  s_waitcnt vmcnt(4)
  v_lshlrev_b32 v124, 16, v36
  v_and_b32 v125, 0xffff0000, v36
  v_pk_fma_f32 v[116:117], v[124:125], v[100:101], v[116:117] op_sel:[0,1,0] op_sel_hi:[1,1,1]
  v_lshlrev_b32 v126, 16, v37
  v_and_b32 v127, 0xffff0000, v37
  v_pk_fma_f32 v[118:119], v[126:127], v[100:101], v[118:119] op_sel:[0,1,0] op_sel_hi:[1,1,1]
  v_lshlrev_b32 v124, 16, v38
  v_and_b32 v125, 0xffff0000, v38
  v_pk_fma_f32 v[120:121], v[124:125], v[100:101], v[120:121] op_sel:[0,1,0] op_sel_hi:[1,1,1]
  v_lshlrev_b32 v126, 16, v39
  v_and_b32 v127, 0xffff0000, v39
  v_pk_fma_f32 v[122:123], v[126:127], v[100:101], v[122:123] op_sel:[0,1,0] op_sel_hi:[1,1,1]
  s_waitcnt vmcnt(3)
  v_lshlrev_b32 v124, 16, v40
  v_and_b32 v125, 0xffff0000, v40
  v_pk_fma_f32 v[116:117], v[124:125], v[102:103], v[116:117] op_sel:[0,0,0] op_sel_hi:[1,0,1]
  v_lshlrev_b32 v126, 16, v41
  v_and_b32 v127, 0xffff0000, v41
  v_pk_fma_f32 v[118:119], v[126:127], v[102:103], v[118:119] op_sel:[0,0,0] op_sel_hi:[1,0,1]
  v_lshlrev_b32 v124, 16, v42
  v_and_b32 v125, 0xffff0000, v42
  v_pk_fma_f32 v[120:121], v[124:125], v[102:103], v[120:121] op_sel:[0,0,0] op_sel_hi:[1,0,1]
  v_lshlrev_b32 v126, 16, v43
  v_and_b32 v127, 0xffff0000, v43
  v_pk_fma_f32 v[122:123], v[126:127], v[102:103], v[122:123] op_sel:[0,0,0] op_sel_hi:[1,0,1]
  s_waitcnt vmcnt(2)
  v_lshlrev_b32 v124, 16, v44
  v_and_b32 v125, 0xffff0000, v44
  v_pk_fma_f32 v[116:117], v[124:125], v[102:103], v[116:117] op_sel:[0,1,0] op_sel_hi:[1,1,1]
  v_lshlrev_b32 v126, 16, v45
  v_and_b32 v127, 0xffff0000, v45
  v_pk_fma_f32 v[118:119], v[126:127], v[102:103], v[118:119] op_sel:[0,1,0] op_sel_hi:[1,1,1]
  v_lshlrev_b32 v124, 16, v46
  v_and_b32 v125, 0xffff0000, v46
  v_pk_fma_f32 v[120:121], v[124:125], v[102:103], v[120:121] op_sel:[0,1,0] op_sel_hi:[1,1,1]
  v_lshlrev_b32 v126, 16, v47
  v_and_b32 v127, 0xffff0000, v47
  v_pk_fma_f32 v[122:123], v[126:127], v[102:103], v[122:123] op_sel:[0,1,0] op_sel_hi:[1,1,1]
  s_waitcnt vmcnt(1)
  v_lshlrev_b32 v124, 16, v48
  v_and_b32 v125, 0xffff0000, v48
  v_pk_fma_f32 v[116:117], v[124:125], v[104:105], v[116:117] op_sel:[0,0,0] op_sel_hi:[1,0,1]
  v_lshlrev_b32 v126, 16, v49
  v_and_b32 v127, 0xffff0000, v49
  v_pk_fma_f32 v[118:119], v[126:127], v[104:105], v[118:119] op_sel:[0,0,0] op_sel_hi:[1,0,1]
  v_lshlrev_b32 v124, 16, v50
  v_and_b32 v125, 0xffff0000, v50
  v_pk_fma_f32 v[120:121], v[124:125], v[104:105], v[120:121] op_sel:[0,0,0] op_sel_hi:[1,0,1]
  v_lshlrev_b32 v126, 16, v51
  v_and_b32 v127, 0xffff0000, v51
  v_pk_fma_f32 v[122:123], v[126:127], v[104:105], v[122:123] op_sel:[0,0,0] op_sel_hi:[1,0,1]
  s_waitcnt vmcnt(0)
  v_lshlrev_b32 v124, 16, v52
  v_and_b32 v125, 0xffff0000, v52
  v_pk_fma_f32 v[116:117], v[124:125], v[104:105], v[116:117] op_sel:[0,1,0] op_sel_hi:[1,1,1]
  v_lshlrev_b32 v126, 16, v53
  v_and_b32 v127, 0xffff0000, v53
  v_pk_fma_f32 v[118:119], v[126:127], v[104:105], v[118:119] op_sel:[0,1,0] op_sel_hi:[1,1,1]
  v_lshlrev_b32 v124, 16, v54
  v_and_b32 v125, 0xffff0000, v54
  v_pk_fma_f32 v[120:121], v[124:125], v[104:105], v[120:121] op_sel:[0,1,0] op_sel_hi:[1,1,1]
  v_lshlrev_b32 v126, 16, v55
  v_and_b32 v127, 0xffff0000, v55
  v_pk_fma_f32 v[122:123], v[126:127], v[104:105], v[122:123] op_sel:[0,1,0] op_sel_hi:[1,1,1]
  v_add_f32_dpp v116, v116, v116 row_ror:8 row_mask:0xf bank_mask:0xf
  v_add_f32_dpp v117, v117, v117 row_ror:8 row_mask:0xf bank_mask:0xf
  v_add_f32_dpp v118, v118, v118 row_ror:8 row_mask:0xf bank_mask:0xf
  v_add_f32_dpp v119, v119, v119 row_ror:8 row_mask:0xf bank_mask:0xf
  v_add_f32_dpp v120, v120, v120 row_ror:8 row_mask:0xf bank_mask:0xf
  v_add_f32_dpp v121, v121, v121 row_ror:8 row_mask:0xf bank_mask:0xf
  v_add_f32_dpp v122, v122, v122 row_ror:8 row_mask:0xf bank_mask:0xf
  v_add_f32_dpp v123, v123, v123 row_ror:8 row_mask:0xf bank_mask:0xf
  v_lshrrev_b32 v9, 4, v0
  v_lshlrev_b32 v9, 8, v9
  v_lshl_add_u32 v9, v3, 5, v9
  ds_write_b128 v9, v[116:119] offset:4096
  ds_write_b128 v9, v[120:123] offset:4112
  s_waitcnt lgkmcnt(0)
  s_barrier
  v_cmp_gt_u32 vcc, 64, v0
  s_nop 2
  s_and_saveexec_b64 s[24:25], vcc
  s_cbranch_execz k1_kernel_end
  v_lshlrev_b32 v9, 2, v0
  ds_read_b32 v16, v9 offset:4096
  ds_read_b32 v17, v9 offset:4352
  ds_read_b32 v18, v9 offset:4608
  ds_read_b32 v19, v9 offset:4864
  ds_read_b32 v20, v9 offset:5120
  ds_read_b32 v21, v9 offset:5376
  ds_read_b32 v22, v9 offset:5632
  ds_read_b32 v23, v9 offset:5888
  ds_read_b32 v24, v9 offset:6144
  ds_read_b32 v25, v9 offset:6400
  ds_read_b32 v26, v9 offset:6656
  ds_read_b32 v27, v9 offset:6912
  ds_read_b32 v28, v9 offset:7168
  ds_read_b32 v29, v9 offset:7424
  ds_read_b32 v30, v9 offset:7680
  ds_read_b32 v31, v9 offset:7936
  s_waitcnt lgkmcnt(0)
  v_add_f32 v16, v16, v24
  v_add_f32 v17, v17, v25
  v_add_f32 v18, v18, v26
  v_add_f32 v19, v19, v27
  v_add_f32 v20, v20, v28
  v_add_f32 v21, v21, v29
  v_add_f32 v22, v22, v30
  v_add_f32 v23, v23, v31
  v_add_f32 v16, v16, v20
  v_add_f32 v17, v17, v21
  v_add_f32 v18, v18, v22
  v_add_f32 v19, v19, v23
  v_add_f32 v16, v16, v18
  v_add_f32 v17, v17, v19
  v_add_f32 v16, v16, v17
  s_add_u32 s12, s4, 0
  s_addc_u32 s13, s5, 0
  s_mov_b32 s14, 31744
  s_mov_b32 s15, 0x20000
  s_lshl_b32 s21, s20, 8
  s_mul_i32 s27, s26, 16384
  s_add_u32 s21, s21, s27
  buffer_store_dword v16, v9, s[12:15], s21 offen sc1
  s_branch k1_kernel_end
k1_kernel_ln:
  s_sub_u32 s20, s2, 440
  s_load_dwordx2 s[6:7], s[0:1], 0
  v_and_b32 v2, 15, v0
  v_bfe_u32 v3, v0, 4, 2
  s_lshl_b32 s21, s20, 5
  s_lshl_b32 s22, s19, 3
  s_add_u32 s22, s22, s21
  v_add_u32 v4, s22, v3
  v_mul_u32_u24 v1, 1280, v4
  v_lshl_add_u32 v1, v2, 4, v1
  s_waitcnt lgkmcnt(0)
  s_mov_b32 s8, s6
  s_mov_b32 s9, s7
  s_mov_b32 s10, 2621440
  s_mov_b32 s11, 0x20000
  s_mov_b32 s23, 5120
  buffer_load_dwordx4 v[16:19], v1, s[8:11], 0 offen offset:0 nt
  buffer_load_dwordx4 v[20:23], v1, s[8:11], 0 offen offset:256 nt
  buffer_load_dwordx4 v[24:27], v1, s[8:11], 0 offen offset:512 nt
  buffer_load_dwordx4 v[28:31], v1, s[8:11], 0 offen offset:768 nt
  buffer_load_dwordx4 v[32:35], v1, s[8:11], 0 offen offset:1024 nt
  buffer_load_dwordx4 v[36:39], v1, s[8:11], s23 offen offset:0 nt
  buffer_load_dwordx4 v[40:43], v1, s[8:11], s23 offen offset:256 nt
  buffer_load_dwordx4 v[44:47], v1, s[8:11], s23 offen offset:512 nt
  buffer_load_dwordx4 v[48:51], v1, s[8:11], s23 offen offset:768 nt
  buffer_load_dwordx4 v[52:55], v1, s[8:11], s23 offen offset:1024 nt
  s_add_u32 s12, s4, 1048576
  s_addc_u32 s13, s5, 0
  s_mov_b32 s14, 2662400
  s_mov_b32 s15, 0x20000
  s_add_u32 s40, s4, 131072
  s_addc_u32 s41, s5, 0
  s_mov_b32 s42, 16384
  s_mov_b32 s43, 0x20000
  s_mov_b32 s24, 0x3f803f80
  v_mov_b32 v8, 0
  v_mov_b32 v9, 0
  v_mov_b32 v10, 0
  v_mov_b32 v11, 0
  v_mul_u32_u24 v12, 272, v2
  v_lshl_add_u32 v12, v3, 3, v12
  s_lshl_b32 s25, s19, 6
  v_add_u32 v12, s25, v12
  v_lshrrev_b32 v13, 4, v0
  v_mul_u32_u24 v14, 272, v13
  v_and_b32 v15, 15, v0
  v_lshl_add_u32 v14, v15, 4, v14
  v_mul_u32_u24 v13, 33280, v13
  v_lshl_add_u32 v13, v15, 4, v13
  s_lshl_b32 s26, s21, 3
  v_add_u32 v13, s26, v13
  s_waitcnt vmcnt(9)
  v_dot2_f32_bf16 v8, v16, s24, v8
  v_dot2_f32_bf16 v9, v16, v16, v9
  v_dot2_f32_bf16 v8, v17, s24, v8
  v_dot2_f32_bf16 v9, v17, v17, v9
  v_dot2_f32_bf16 v8, v18, s24, v8
  v_dot2_f32_bf16 v9, v18, v18, v9
  v_dot2_f32_bf16 v8, v19, s24, v8
  v_dot2_f32_bf16 v9, v19, v19, v9
  ds_write_b64 v12, v[16:17] offset:0
  ds_write_b64 v12, v[18:19] offset:21760
  s_waitcnt vmcnt(8)
  v_dot2_f32_bf16 v8, v20, s24, v8
  v_dot2_f32_bf16 v9, v20, v20, v9
  v_dot2_f32_bf16 v8, v21, s24, v8
  v_dot2_f32_bf16 v9, v21, v21, v9
  v_dot2_f32_bf16 v8, v22, s24, v8
  v_dot2_f32_bf16 v9, v22, v22, v9
  v_dot2_f32_bf16 v8, v23, s24, v8
  v_dot2_f32_bf16 v9, v23, v23, v9
  ds_write_b64 v12, v[20:21] offset:4352
  ds_write_b64 v12, v[22:23] offset:26112
  s_waitcnt vmcnt(7)
  v_dot2_f32_bf16 v8, v24, s24, v8
  v_dot2_f32_bf16 v9, v24, v24, v9
  v_dot2_f32_bf16 v8, v25, s24, v8
  v_dot2_f32_bf16 v9, v25, v25, v9
  v_dot2_f32_bf16 v8, v26, s24, v8
  v_dot2_f32_bf16 v9, v26, v26, v9
  v_dot2_f32_bf16 v8, v27, s24, v8
  v_dot2_f32_bf16 v9, v27, v27, v9
  ds_write_b64 v12, v[24:25] offset:8704
  ds_write_b64 v12, v[26:27] offset:30464
  s_waitcnt vmcnt(6)
  v_dot2_f32_bf16 v8, v28, s24, v8
  v_dot2_f32_bf16 v9, v28, v28, v9
  v_dot2_f32_bf16 v8, v29, s24, v8
  v_dot2_f32_bf16 v9, v29, v29, v9
  v_dot2_f32_bf16 v8, v30, s24, v8
  v_dot2_f32_bf16 v9, v30, v30, v9
  v_dot2_f32_bf16 v8, v31, s24, v8
  v_dot2_f32_bf16 v9, v31, v31, v9
  ds_write_b64 v12, v[28:29] offset:13056
  ds_write_b64 v12, v[30:31] offset:34816
  s_waitcnt vmcnt(5)
  v_dot2_f32_bf16 v8, v32, s24, v8
  v_dot2_f32_bf16 v9, v32, v32, v9
  v_dot2_f32_bf16 v8, v33, s24, v8
  v_dot2_f32_bf16 v9, v33, v33, v9
  v_dot2_f32_bf16 v8, v34, s24, v8
  v_dot2_f32_bf16 v9, v34, v34, v9
  v_dot2_f32_bf16 v8, v35, s24, v8
  v_dot2_f32_bf16 v9, v35, v35, v9
  ds_write_b64 v12, v[32:33] offset:17408
  ds_write_b64 v12, v[34:35] offset:39168
  s_waitcnt vmcnt(4)
  v_dot2_f32_bf16 v10, v36, s24, v10
  v_dot2_f32_bf16 v11, v36, v36, v11
  v_dot2_f32_bf16 v10, v37, s24, v10
  v_dot2_f32_bf16 v11, v37, v37, v11
  v_dot2_f32_bf16 v10, v38, s24, v10
  v_dot2_f32_bf16 v11, v38, v38, v11
  v_dot2_f32_bf16 v10, v39, s24, v10
  v_dot2_f32_bf16 v11, v39, v39, v11
  ds_write_b64 v12, v[36:37] offset:32
  ds_write_b64 v12, v[38:39] offset:21792
  s_waitcnt vmcnt(3)
  v_dot2_f32_bf16 v10, v40, s24, v10
  v_dot2_f32_bf16 v11, v40, v40, v11
  v_dot2_f32_bf16 v10, v41, s24, v10
  v_dot2_f32_bf16 v11, v41, v41, v11
  v_dot2_f32_bf16 v10, v42, s24, v10
  v_dot2_f32_bf16 v11, v42, v42, v11
  v_dot2_f32_bf16 v10, v43, s24, v10
  v_dot2_f32_bf16 v11, v43, v43, v11
  ds_write_b64 v12, v[40:41] offset:4384
  ds_write_b64 v12, v[42:43] offset:26144
  s_waitcnt vmcnt(2)
  v_dot2_f32_bf16 v10, v44, s24, v10
  v_dot2_f32_bf16 v11, v44, v44, v11
  v_dot2_f32_bf16 v10, v45, s24, v10
  v_dot2_f32_bf16 v11, v45, v45, v11
  v_dot2_f32_bf16 v10, v46, s24, v10
  v_dot2_f32_bf16 v11, v46, v46, v11
  v_dot2_f32_bf16 v10, v47, s24, v10
  v_dot2_f32_bf16 v11, v47, v47, v11
  ds_write_b64 v12, v[44:45] offset:8736
  ds_write_b64 v12, v[46:47] offset:30496
  s_waitcnt vmcnt(1)
  v_dot2_f32_bf16 v10, v48, s24, v10
  v_dot2_f32_bf16 v11, v48, v48, v11
  v_dot2_f32_bf16 v10, v49, s24, v10
  v_dot2_f32_bf16 v11, v49, v49, v11
  v_dot2_f32_bf16 v10, v50, s24, v10
  v_dot2_f32_bf16 v11, v50, v50, v11
  v_dot2_f32_bf16 v10, v51, s24, v10
  v_dot2_f32_bf16 v11, v51, v51, v11
  ds_write_b64 v12, v[48:49] offset:13088
  ds_write_b64 v12, v[50:51] offset:34848
  s_waitcnt vmcnt(0)
  v_dot2_f32_bf16 v10, v52, s24, v10
  v_dot2_f32_bf16 v11, v52, v52, v11
  v_dot2_f32_bf16 v10, v53, s24, v10
  v_dot2_f32_bf16 v11, v53, v53, v11
  v_dot2_f32_bf16 v10, v54, s24, v10
  v_dot2_f32_bf16 v11, v54, v54, v11
  v_dot2_f32_bf16 v10, v55, s24, v10
  v_dot2_f32_bf16 v11, v55, v55, v11
  ds_write_b64 v12, v[52:53] offset:17440
  ds_write_b64 v12, v[54:55] offset:39200
  v_add_f32_dpp v8, v8, v8 row_ror:8 row_mask:0xf bank_mask:0xf
  v_add_f32_dpp v9, v9, v9 row_ror:8 row_mask:0xf bank_mask:0xf
  v_add_f32_dpp v10, v10, v10 row_ror:8 row_mask:0xf bank_mask:0xf
  v_add_f32_dpp v11, v11, v11 row_ror:8 row_mask:0xf bank_mask:0xf
  v_add_f32_dpp v8, v8, v8 row_ror:4 row_mask:0xf bank_mask:0xf
  v_add_f32_dpp v9, v9, v9 row_ror:4 row_mask:0xf bank_mask:0xf
  v_add_f32_dpp v10, v10, v10 row_ror:4 row_mask:0xf bank_mask:0xf
  v_add_f32_dpp v11, v11, v11 row_ror:4 row_mask:0xf bank_mask:0xf
  v_add_f32_dpp v8, v8, v8 row_ror:2 row_mask:0xf bank_mask:0xf
  v_add_f32_dpp v9, v9, v9 row_ror:2 row_mask:0xf bank_mask:0xf
  v_add_f32_dpp v10, v10, v10 row_ror:2 row_mask:0xf bank_mask:0xf
  v_add_f32_dpp v11, v11, v11 row_ror:2 row_mask:0xf bank_mask:0xf
  v_add_f32_dpp v8, v8, v8 row_ror:1 row_mask:0xf bank_mask:0xf
  v_add_f32_dpp v9, v9, v9 row_ror:1 row_mask:0xf bank_mask:0xf
  v_add_f32_dpp v10, v10, v10 row_ror:1 row_mask:0xf bank_mask:0xf
  v_add_f32_dpp v11, v11, v11 row_ror:1 row_mask:0xf bank_mask:0xf
  v_mul_f32 v8, 0x3acccccd, v8
  v_mul_f32 v9, 0x3acccccd, v9
  v_fma_f32 v9, -v8, v8, v9
  v_max_f32 v9, 0, v9
  v_cvt_pk_bf16_f32 v9, v9, v9
  v_and_b32 v9, 0xffff0000, v9
  v_add_f32 v9, 0x3727c5ac, v9
  v_cvt_pk_bf16_f32 v9, v9, v9
  v_and_b32 v9, 0xffff0000, v9
  v_sqrt_f32 v9, v9
  s_nop 0
  v_cvt_pk_bf16_f32 v9, v9, v9
  v_and_b32 v9, 0xffff0000, v9
  v_cvt_pk_bf16_f32 v8, v8, v8
  v_and_b32 v8, 0xffff0000, v8
  v_rcp_f32 v9, v9
  s_nop 0
  v_mul_f32 v57, v8, v9
  v_mov_b32 v56, v9
  v_sub_f32 v57, 0, v57
  v_mul_f32 v10, 0x3acccccd, v10
  v_mul_f32 v11, 0x3acccccd, v11
  v_fma_f32 v11, -v10, v10, v11
  v_max_f32 v11, 0, v11
  v_cvt_pk_bf16_f32 v11, v11, v11
  v_and_b32 v11, 0xffff0000, v11
  v_add_f32 v11, 0x3727c5ac, v11
  v_cvt_pk_bf16_f32 v11, v11, v11
  v_and_b32 v11, 0xffff0000, v11
  v_sqrt_f32 v11, v11
  s_nop 0
  v_cvt_pk_bf16_f32 v11, v11, v11
  v_and_b32 v11, 0xffff0000, v11
  v_cvt_pk_bf16_f32 v10, v10, v10
  v_and_b32 v10, 0xffff0000, v10
  v_rcp_f32 v11, v11
  s_nop 0
  v_mul_f32 v59, v10, v11
  v_mov_b32 v58, v11
  v_sub_f32 v59, 0, v59
  v_lshlrev_b32 v5, 3, v4
  v_cmp_eq_u32 vcc, 0, v2
  s_nop 2
  s_and_saveexec_b64 s[28:29], vcc
  buffer_store_dwordx2 v[56:57], v5, s[40:43], 0 offen sc1
  buffer_store_dwordx2 v[58:59], v5, s[40:43], 0 offen offset:32 sc1
  s_mov_b64 exec, s[28:29]
  s_waitcnt lgkmcnt(0)
  s_barrier
  ds_read_b128 v[64:67], v14 offset:0
  ds_read_b128 v[68:71], v14 offset:4352
  ds_read_b128 v[72:75], v14 offset:8704
  ds_read_b128 v[76:79], v14 offset:13056
  ds_read_b128 v[80:83], v14 offset:17408
  ds_read_b128 v[84:87], v14 offset:21760
  ds_read_b128 v[88:91], v14 offset:26112
  ds_read_b128 v[92:95], v14 offset:30464
  ds_read_b128 v[96:99], v14 offset:34816
  ds_read_b128 v[100:103], v14 offset:39168
  s_mov_b32 s23, 0
  s_waitcnt lgkmcnt(9)
  buffer_store_dwordx4 v[64:67], v13, s[12:15], s23 offen sc1
  s_mov_b32 s23, 532480
  s_waitcnt lgkmcnt(8)
  buffer_store_dwordx4 v[68:71], v13, s[12:15], s23 offen sc1
  s_mov_b32 s23, 1064960
  s_waitcnt lgkmcnt(7)
  buffer_store_dwordx4 v[72:75], v13, s[12:15], s23 offen sc1
  s_mov_b32 s23, 1597440
  s_waitcnt lgkmcnt(6)
  buffer_store_dwordx4 v[76:79], v13, s[12:15], s23 offen sc1
  s_mov_b32 s23, 2129920
  s_waitcnt lgkmcnt(5)
  buffer_store_dwordx4 v[80:83], v13, s[12:15], s23 offen sc1
  s_mov_b32 s23, 16640
  s_waitcnt lgkmcnt(4)
  buffer_store_dwordx4 v[84:87], v13, s[12:15], s23 offen sc1
  s_mov_b32 s23, 549120
  s_waitcnt lgkmcnt(3)
  buffer_store_dwordx4 v[88:91], v13, s[12:15], s23 offen sc1
  s_mov_b32 s23, 1081600
  s_waitcnt lgkmcnt(2)
  buffer_store_dwordx4 v[92:95], v13, s[12:15], s23 offen sc1
  s_mov_b32 s23, 1614080
  s_waitcnt lgkmcnt(1)
  buffer_store_dwordx4 v[96:99], v13, s[12:15], s23 offen sc1
  s_mov_b32 s23, 2146560
  s_waitcnt lgkmcnt(0)
  buffer_store_dwordx4 v[100:103], v13, s[12:15], s23 offen sc1
  s_branch k1_kernel_end
k1_kernel_pf:
  s_getpc_b64 s[6:7]
L_k1_kernel_pc_2:
  s_add_u32 s8, s6, k2_kernel-L_k1_kernel_pc_2
  s_addc_u32 s9, s7, 0
  s_mov_b32 s10, code_end-k2_kernel
  s_mov_b32 s11, 0x20000
  v_lshlrev_b32 v1, 4, v0
  s_mov_b32 s12, 0
  buffer_load_dwordx4 v[8:11], v1, s[8:11], s12 offen
  s_mov_b32 s12, 4096
  buffer_load_dwordx4 v[12:15], v1, s[8:11], s12 offen
  s_mov_b32 s12, 8192
  buffer_load_dwordx4 v[16:19], v1, s[8:11], s12 offen
  s_mov_b32 s12, 12288
  buffer_load_dwordx4 v[20:23], v1, s[8:11], s12 offen
  s_mov_b32 s12, 16384
  buffer_load_dwordx4 v[24:27], v1, s[8:11], s12 offen
  s_mov_b32 s12, 20480
  buffer_load_dwordx4 v[28:31], v1, s[8:11], s12 offen
  s_mov_b32 s12, 24576
  buffer_load_dwordx4 v[32:35], v1, s[8:11], s12 offen
  s_mov_b32 s12, 28672
  buffer_load_dwordx4 v[36:39], v1, s[8:11], s12 offen
  s_mov_b32 s12, 32768
  buffer_load_dwordx4 v[40:43], v1, s[8:11], s12 offen
  s_mov_b32 s12, 36864
  buffer_load_dwordx4 v[44:47], v1, s[8:11], s12 offen
  s_mov_b32 s12, 40960
  buffer_load_dwordx4 v[48:51], v1, s[8:11], s12 offen
  s_mov_b32 s12, 45056
  buffer_load_dwordx4 v[52:55], v1, s[8:11], s12 offen
  s_mov_b32 s12, 49152
  buffer_load_dwordx4 v[56:59], v1, s[8:11], s12 offen
  s_mov_b32 s12, 53248
  buffer_load_dwordx4 v[60:63], v1, s[8:11], s12 offen
  s_mov_b32 s12, 57344
  buffer_load_dwordx4 v[64:67], v1, s[8:11], s12 offen
  s_mov_b32 s12, 61440
  buffer_load_dwordx4 v[68:71], v1, s[8:11], s12 offen
  s_waitcnt vmcnt(0)
  s_branch k1_kernel_end
k1_kernel_end:
k1_kernel_exit:
  s_endpgm
.globl k2_kernel
.p2align 8
.type k2_kernel,@function
k2_kernel:
  s_cmp_ge_u32 s2, 244
  s_cbranch_scc1 k2_kernel_exit
  s_load_dwordx2 s[4:5], s[0:1], 120
  v_lshrrev_b32 v1, 6, v0
  s_nop 0
  v_readfirstlane_b32 s19, v1
  s_waitcnt lgkmcnt(0)
  s_cmp_ge_u32 s2, 214
  s_cbranch_scc1 k2_kernel_wd
  s_cmp_ge_u32 s2, 160
  s_cbranch_scc1 k2_kernel_w1
  s_mov_b32 s20, s2
  s_lshl_b32 s21, s20, 4
  s_add_u32 s22, s21, 0
  s_add_u32 s6, s4, s22
  s_addc_u32 s7, s5, 0
  s_load_dwordx4 s[24:27], s[6:7], 0
  s_load_dwordx4 s[28:31], s[6:7], 2560
  s_load_dwordx4 s[32:35], s[6:7], 5120
  s_load_dwordx4 s[56:59], s[6:7], 16384
  s_load_dwordx4 s[60:63], s[6:7], 18944
  s_load_dwordx4 s[64:67], s[6:7], 21504
  s_load_dwordx2 s[16:17], s[0:1], 48
  v_and_b32 v1, 63, v0
  v_lshlrev_b32 v3, 4, v1
  s_mul_i32 s21, s20, 16640
  s_lshl_b32 s22, s19, 12
  s_add_u32 s21, s21, s22
  s_lshl_b32 s23, s20, 2
  s_add_u32 s23, s23, s19
  s_mul_i32 s23, s23, 4160
  s_add_u32 s8, s4, 1048576
  s_addc_u32 s9, s5, 0
  s_mov_b32 s10, 2662400
  s_mov_b32 s11, 0x20000
  s_add_u32 s44, s4, 131072
  s_addc_u32 s45, s5, 0
  s_mov_b32 s46, 16384
  s_mov_b32 s47, 0x20000
  s_add_u32 s12, s4, 7340032
  s_addc_u32 s13, s5, 0
  s_mov_b32 s14, 2662400
  s_mov_b32 s15, 0x20000
  buffer_load_dwordx4 v[16:19], v3, s[8:11], s21 offen offset:0
  buffer_load_dwordx4 v[32:35], v3, s[44:47], s22 offen offset:0
  buffer_load_dwordx4 v[20:23], v3, s[8:11], s21 offen offset:1024
  buffer_load_dwordx4 v[36:39], v3, s[44:47], s22 offen offset:1024
  buffer_load_dwordx4 v[24:27], v3, s[8:11], s21 offen offset:2048
  buffer_load_dwordx4 v[40:43], v3, s[44:47], s22 offen offset:2048
  buffer_load_dwordx4 v[28:31], v3, s[8:11], s21 offen offset:3072
  buffer_load_dwordx4 v[44:47], v3, s[44:47], s22 offen offset:3072
  buffer_load_dwordx4 v[48:51], v3, s[12:15], s23 offen offset:0
  buffer_load_dwordx2 v[52:53], v3, s[12:15], s23 offen offset:16
  buffer_load_dwordx4 v[56:59], v3, s[12:15], s23 offen offset:1024
  buffer_load_dwordx2 v[60:61], v3, s[12:15], s23 offen offset:1040
  buffer_load_dwordx4 v[64:67], v3, s[12:15], s23 offen offset:2048
  buffer_load_dwordx2 v[68:69], v3, s[12:15], s23 offen offset:2064
  buffer_load_dwordx4 v[72:75], v3, s[12:15], s23 offen offset:3072
  buffer_load_dwordx2 v[76:77], v3, s[12:15], s23 offen offset:3088
  s_add_u32 s40, s4, 10485760
  s_addc_u32 s41, s5, 0
  s_mov_b32 s42, 2662400
  s_mov_b32 s43, 0x20000
  s_waitcnt lgkmcnt(0)
  s_lshl_b32 s36, s20, 3
  s_add_u32 s16, s16, s36
  s_addc_u32 s17, s17, 0
  s_load_dwordx2 s[36:37], s[16:17], 0
  v_mov_b32 v4, s28
  v_mov_b32 v8, s24
  v_mov_b32 v84, s32
  v_add_f32 v4, s60, v4
  v_add_f32 v8, s56, v8
  v_add_f32 v84, s64, v84
  v_cvt_pk_bf16_f32 v4, v4, v4
  v_and_b32 v4, 0xffff0000, v4
  v_cvt_pk_bf16_f32 v8, v8, v8
  v_and_b32 v8, 0xffff0000, v8
  v_cvt_pk_bf16_f32 v84, v84, v84
  v_and_b32 v84, 0xffff0000, v84
  v_add_f32 v4, 1.0, v4
  v_cvt_pk_bf16_f32 v4, v4, v4
  v_and_b32 v4, 0xffff0000, v4
  v_mov_b32 v5, s29
  v_mov_b32 v9, s25
  v_mov_b32 v85, s33
  v_add_f32 v5, s61, v5
  v_add_f32 v9, s57, v9
  v_add_f32 v85, s65, v85
  v_cvt_pk_bf16_f32 v5, v5, v5
  v_and_b32 v5, 0xffff0000, v5
  v_cvt_pk_bf16_f32 v9, v9, v9
  v_and_b32 v9, 0xffff0000, v9
  v_cvt_pk_bf16_f32 v85, v85, v85
  v_and_b32 v85, 0xffff0000, v85
  v_add_f32 v5, 1.0, v5
  v_cvt_pk_bf16_f32 v5, v5, v5
  v_and_b32 v5, 0xffff0000, v5
  v_mov_b32 v6, s30
  v_mov_b32 v10, s26
  v_mov_b32 v86, s34
  v_add_f32 v6, s62, v6
  v_add_f32 v10, s58, v10
  v_add_f32 v86, s66, v86
  v_cvt_pk_bf16_f32 v6, v6, v6
  v_and_b32 v6, 0xffff0000, v6
  v_cvt_pk_bf16_f32 v10, v10, v10
  v_and_b32 v10, 0xffff0000, v10
  v_cvt_pk_bf16_f32 v86, v86, v86
  v_and_b32 v86, 0xffff0000, v86
  v_add_f32 v6, 1.0, v6
  v_cvt_pk_bf16_f32 v6, v6, v6
  v_and_b32 v6, 0xffff0000, v6
  v_mov_b32 v7, s31
  v_mov_b32 v11, s27
  v_mov_b32 v87, s35
  v_add_f32 v7, s63, v7
  v_add_f32 v11, s59, v11
  v_add_f32 v87, s67, v87
  v_cvt_pk_bf16_f32 v7, v7, v7
  v_and_b32 v7, 0xffff0000, v7
  v_cvt_pk_bf16_f32 v11, v11, v11
  v_and_b32 v11, 0xffff0000, v11
  v_cvt_pk_bf16_f32 v87, v87, v87
  v_and_b32 v87, 0xffff0000, v87
  v_add_f32 v7, 1.0, v7
  v_cvt_pk_bf16_f32 v7, v7, v7
  v_and_b32 v7, 0xffff0000, v7
  s_mul_i32 s38, s19, 21248
  v_lshlrev_b32 v12, 2, v1
  s_lshl_b32 s39, s19, 10
  v_add_u32 v12, s39, v12
  v_add_u32 v12, 17152, v12
  v_add_u32 v13, s38, v3
  v_mov_b32 v112, 0
  v_mov_b32 v113, 0
  v_mov_b32 v114, 0
  v_mov_b32 v115, 0
  v_lshlrev_b32 v14, 3, v1
  v_add_u32 v14, s38, v14
  ds_write_b64 v14, v[112:113] offset:16640
  v_lshrrev_b32 v14, 1, v1
  v_mul_u32_u24 v14, 4160, v14
  v_and_b32 v15, 1, v1
  v_lshl_add_u32 v14, v15, 4, v14
  v_add_u32 v14, s38, v14
  v_cmp_gt_u32 vcc, 8, v1
  s_nop 2
  s_and_saveexec_b64 s[48:49], vcc
  ds_write_b128 v14, v[112:115] offset:4096
  s_mov_b64 exec, s[48:49]
  v_and_b32 v14, 15, v1
  v_lshrrev_b32 v15, 4, v1
  v_and_b32 v112, 3, v14
  v_sub_u32 v112, 3, v112
  v_mul_u32_u24 v112, 4160, v112
  v_lshrrev_b32 v113, 2, v14
  v_lshlrev_b32 v113, 3, v113
  v_sub_u32 v112, v112, v113
  v_lshrrev_b32 v114, 1, v15
  v_lshlrev_b32 v114, 5, v114
  v_and_b32 v115, 1, v15
  v_lshlrev_b32 v115, 4, v115
  v_sub_u32 v115, v115, v114
  v_add_u32 v112, v112, v115
  v_add_u32 v112, 56, v112
  v_add_u32 v2, s38, v112
  v_lshlrev_b32 v112, 5, v14
  v_add_u32 v112, v112, v115
  v_add_u32 v112, 16704, v112
  v_add_u32 v80, s38, v112
  s_waitcnt vmcnt(14)
  v_lshlrev_b32 v112, 16, v16
  v_and_b32 v113, 0xffff0000, v16
  v_lshlrev_b32 v114, 16, v17
  v_and_b32 v115, 0xffff0000, v17
  v_pk_fma_f32 v[112:113], v[112:113], v[32:33], v[32:33] op_sel:[0,0,1] op_sel_hi:[1,0,1]
  v_pk_fma_f32 v[114:115], v[114:115], v[32:33], v[32:33] op_sel:[0,0,1] op_sel_hi:[1,0,1]
  v_pk_fma_f32 v[112:113], v[112:113], v[4:5], v[8:9]
  v_pk_fma_f32 v[114:115], v[114:115], v[6:7], v[10:11]
  v_lshlrev_b32 v116, 16, v18
  v_and_b32 v117, 0xffff0000, v18
  v_lshlrev_b32 v118, 16, v19
  v_and_b32 v119, 0xffff0000, v19
  v_pk_fma_f32 v[116:117], v[116:117], v[34:35], v[34:35] op_sel:[0,0,1] op_sel_hi:[1,0,1]
  v_pk_fma_f32 v[118:119], v[118:119], v[34:35], v[34:35] op_sel:[0,0,1] op_sel_hi:[1,0,1]
  v_pk_fma_f32 v[116:117], v[116:117], v[4:5], v[8:9]
  v_pk_fma_f32 v[118:119], v[118:119], v[6:7], v[10:11]
  v_cvt_pk_bf16_f32 v96, v112, v116
  ds_write_b32 v12, v96 offset:0
  v_cvt_pk_bf16_f32 v97, v113, v117
  ds_write_b32 v12, v97 offset:21248
  v_cvt_pk_bf16_f32 v98, v114, v118
  ds_write_b32 v12, v98 offset:42496
  v_cvt_pk_bf16_f32 v99, v115, v119
  ds_write_b32 v12, v99 offset:63744
  s_waitcnt vmcnt(12)
  v_lshlrev_b32 v112, 16, v20
  v_and_b32 v113, 0xffff0000, v20
  v_lshlrev_b32 v114, 16, v21
  v_and_b32 v115, 0xffff0000, v21
  v_pk_fma_f32 v[112:113], v[112:113], v[36:37], v[36:37] op_sel:[0,0,1] op_sel_hi:[1,0,1]
  v_pk_fma_f32 v[114:115], v[114:115], v[36:37], v[36:37] op_sel:[0,0,1] op_sel_hi:[1,0,1]
  v_pk_fma_f32 v[112:113], v[112:113], v[4:5], v[8:9]
  v_pk_fma_f32 v[114:115], v[114:115], v[6:7], v[10:11]
  v_lshlrev_b32 v116, 16, v22
  v_and_b32 v117, 0xffff0000, v22
  v_lshlrev_b32 v118, 16, v23
  v_and_b32 v119, 0xffff0000, v23
  v_pk_fma_f32 v[116:117], v[116:117], v[38:39], v[38:39] op_sel:[0,0,1] op_sel_hi:[1,0,1]
  v_pk_fma_f32 v[118:119], v[118:119], v[38:39], v[38:39] op_sel:[0,0,1] op_sel_hi:[1,0,1]
  v_pk_fma_f32 v[116:117], v[116:117], v[4:5], v[8:9]
  v_pk_fma_f32 v[118:119], v[118:119], v[6:7], v[10:11]
  v_cvt_pk_bf16_f32 v100, v112, v116
  ds_write_b32 v12, v100 offset:256
  v_cvt_pk_bf16_f32 v101, v113, v117
  ds_write_b32 v12, v101 offset:21504
  v_cvt_pk_bf16_f32 v102, v114, v118
  ds_write_b32 v12, v102 offset:42752
  v_cvt_pk_bf16_f32 v103, v115, v119
  ds_write_b32 v12, v103 offset:64000
  s_waitcnt vmcnt(10)
  v_lshlrev_b32 v112, 16, v24
  v_and_b32 v113, 0xffff0000, v24
  v_lshlrev_b32 v114, 16, v25
  v_and_b32 v115, 0xffff0000, v25
  v_pk_fma_f32 v[112:113], v[112:113], v[40:41], v[40:41] op_sel:[0,0,1] op_sel_hi:[1,0,1]
  v_pk_fma_f32 v[114:115], v[114:115], v[40:41], v[40:41] op_sel:[0,0,1] op_sel_hi:[1,0,1]
  v_pk_fma_f32 v[112:113], v[112:113], v[4:5], v[8:9]
  v_pk_fma_f32 v[114:115], v[114:115], v[6:7], v[10:11]
  v_lshlrev_b32 v116, 16, v26
  v_and_b32 v117, 0xffff0000, v26
  v_lshlrev_b32 v118, 16, v27
  v_and_b32 v119, 0xffff0000, v27
  v_pk_fma_f32 v[116:117], v[116:117], v[42:43], v[42:43] op_sel:[0,0,1] op_sel_hi:[1,0,1]
  v_pk_fma_f32 v[118:119], v[118:119], v[42:43], v[42:43] op_sel:[0,0,1] op_sel_hi:[1,0,1]
  v_pk_fma_f32 v[116:117], v[116:117], v[4:5], v[8:9]
  v_pk_fma_f32 v[118:119], v[118:119], v[6:7], v[10:11]
  v_cvt_pk_bf16_f32 v104, v112, v116
  ds_write_b32 v12, v104 offset:512
  v_cvt_pk_bf16_f32 v105, v113, v117
  ds_write_b32 v12, v105 offset:21760
  v_cvt_pk_bf16_f32 v106, v114, v118
  ds_write_b32 v12, v106 offset:43008
  v_cvt_pk_bf16_f32 v107, v115, v119
  ds_write_b32 v12, v107 offset:64256
  s_waitcnt vmcnt(8)
  v_lshlrev_b32 v112, 16, v28
  v_and_b32 v113, 0xffff0000, v28
  v_lshlrev_b32 v114, 16, v29
  v_and_b32 v115, 0xffff0000, v29
  v_pk_fma_f32 v[112:113], v[112:113], v[44:45], v[44:45] op_sel:[0,0,1] op_sel_hi:[1,0,1]
  v_pk_fma_f32 v[114:115], v[114:115], v[44:45], v[44:45] op_sel:[0,0,1] op_sel_hi:[1,0,1]
  v_pk_fma_f32 v[112:113], v[112:113], v[4:5], v[8:9]
  v_pk_fma_f32 v[114:115], v[114:115], v[6:7], v[10:11]
  v_lshlrev_b32 v116, 16, v30
  v_and_b32 v117, 0xffff0000, v30
  v_lshlrev_b32 v118, 16, v31
  v_and_b32 v119, 0xffff0000, v31
  v_pk_fma_f32 v[116:117], v[116:117], v[46:47], v[46:47] op_sel:[0,0,1] op_sel_hi:[1,0,1]
  v_pk_fma_f32 v[118:119], v[118:119], v[46:47], v[46:47] op_sel:[0,0,1] op_sel_hi:[1,0,1]
  v_pk_fma_f32 v[116:117], v[116:117], v[4:5], v[8:9]
  v_pk_fma_f32 v[118:119], v[118:119], v[6:7], v[10:11]
  v_cvt_pk_bf16_f32 v108, v112, v116
  ds_write_b32 v12, v108 offset:768
  v_cvt_pk_bf16_f32 v109, v113, v117
  ds_write_b32 v12, v109 offset:22016
  v_cvt_pk_bf16_f32 v110, v114, v118
  ds_write_b32 v12, v110 offset:43264
  v_cvt_pk_bf16_f32 v111, v115, v119
  ds_write_b32 v12, v111 offset:64512
  s_waitcnt vmcnt(6)
  v_alignbit_b32 v112, v49, v48, 16
  v_alignbit_b32 v113, v50, v49, 16
  v_alignbit_b32 v114, v51, v50, 16
  v_alignbit_b32 v115, v52, v51, 16
  ds_write_b128 v13, v[48:51] offset:0
  v_alignbit_b32 v116, v50, v49, 16
  v_alignbit_b32 v117, v51, v50, 16
  v_alignbit_b32 v118, v52, v51, 16
  v_alignbit_b32 v119, v53, v52, 16
  ds_write_b128 v13, v[112:115] offset:4160
  v_mov_b32 v120, v49
  v_mov_b32 v121, v50
  v_mov_b32 v122, v51
  v_mov_b32 v123, v52
  ds_write_b128 v13, v[116:119] offset:12480
  ds_write_b128 v13, v[120:123] offset:8320
  s_waitcnt vmcnt(4)
  v_alignbit_b32 v112, v57, v56, 16
  v_alignbit_b32 v113, v58, v57, 16
  v_alignbit_b32 v114, v59, v58, 16
  v_alignbit_b32 v115, v60, v59, 16
  ds_write_b128 v13, v[56:59] offset:1024
  v_alignbit_b32 v116, v58, v57, 16
  v_alignbit_b32 v117, v59, v58, 16
  v_alignbit_b32 v118, v60, v59, 16
  v_alignbit_b32 v119, v61, v60, 16
  ds_write_b128 v13, v[112:115] offset:5184
  v_mov_b32 v120, v57
  v_mov_b32 v121, v58
  v_mov_b32 v122, v59
  v_mov_b32 v123, v60
  ds_write_b128 v13, v[116:119] offset:13504
  ds_write_b128 v13, v[120:123] offset:9344
  s_waitcnt vmcnt(2)
  v_alignbit_b32 v112, v65, v64, 16
  v_alignbit_b32 v113, v66, v65, 16
  v_alignbit_b32 v114, v67, v66, 16
  v_alignbit_b32 v115, v68, v67, 16
  ds_write_b128 v13, v[64:67] offset:2048
  v_alignbit_b32 v116, v66, v65, 16
  v_alignbit_b32 v117, v67, v66, 16
  v_alignbit_b32 v118, v68, v67, 16
  v_alignbit_b32 v119, v69, v68, 16
  ds_write_b128 v13, v[112:115] offset:6208
  v_mov_b32 v120, v65
  v_mov_b32 v121, v66
  v_mov_b32 v122, v67
  v_mov_b32 v123, v68
  ds_write_b128 v13, v[116:119] offset:14528
  ds_write_b128 v13, v[120:123] offset:10368
  s_waitcnt vmcnt(0)
  v_alignbit_b32 v112, v73, v72, 16
  v_alignbit_b32 v113, v74, v73, 16
  v_alignbit_b32 v114, v75, v74, 16
  v_alignbit_b32 v115, v76, v75, 16
  ds_write_b128 v13, v[72:75] offset:3072
  v_alignbit_b32 v116, v74, v73, 16
  v_alignbit_b32 v117, v75, v74, 16
  v_alignbit_b32 v118, v76, v75, 16
  v_alignbit_b32 v119, v77, v76, 16
  ds_write_b128 v13, v[112:115] offset:7232
  v_mov_b32 v120, v73
  v_mov_b32 v121, v74
  v_mov_b32 v122, v75
  v_mov_b32 v123, v76
  ds_write_b128 v13, v[116:119] offset:15552
  ds_write_b128 v13, v[120:123] offset:11392
  v_mov_b32 v3, v80
  s_waitcnt lgkmcnt(0)
  s_barrier
  ds_read_b64 v[144:145], v2 offset:4032
  ds_read_b64 v[146:147], v2 offset:4040
  ds_read_b64 v[148:149], v2 offset:3520
  ds_read_b64 v[150:151], v2 offset:3528
  ds_read_b128 v[176:179], v3 offset:448
  ds_read_b128 v[180:183], v3 offset:960
  ds_read_b128 v[184:187], v3 offset:1472
  ds_read_b128 v[188:191], v3 offset:1984
  ds_read_b128 v[192:195], v3 offset:2496
  ds_read_b128 v[196:199], v3 offset:3008
  ds_read_b128 v[200:203], v3 offset:3520
  ds_read_b128 v[204:207], v3 offset:4032
  ds_read_b64 v[152:153], v2 offset:3008
  ds_read_b64 v[154:155], v2 offset:3016
  ds_read_b64 v[156:157], v2 offset:2496
  ds_read_b64 v[158:159], v2 offset:2504
  ds_read_b64 v[160:161], v2 offset:1984
  ds_read_b64 v[162:163], v2 offset:1992
  ds_read_b64 v[164:165], v2 offset:1472
  ds_read_b64 v[166:167], v2 offset:1480
  ds_read_b64 v[168:169], v2 offset:960
  ds_read_b64 v[170:171], v2 offset:968
  ds_read_b64 v[172:173], v2 offset:448
  ds_read_b64 v[174:175], v2 offset:456
  v_mov_b32 v112, 0
  v_mov_b32 v113, 0
  v_mov_b32 v114, 0
  v_mov_b32 v115, 0
  v_mov_b32 v116, 0
  v_mov_b32 v117, 0
  v_mov_b32 v118, 0
  v_mov_b32 v119, 0
  v_mov_b32 v120, 0
  v_mov_b32 v121, 0
  v_mov_b32 v122, 0
  v_mov_b32 v123, 0
  v_mov_b32 v124, 0
  v_mov_b32 v125, 0
  v_mov_b32 v126, 0
  v_mov_b32 v127, 0
  v_mov_b32 v128, 0
  v_mov_b32 v129, 0
  v_mov_b32 v130, 0
  v_mov_b32 v131, 0
  v_mov_b32 v132, 0
  v_mov_b32 v133, 0
  v_mov_b32 v134, 0
  v_mov_b32 v135, 0
  v_mov_b32 v136, 0
  v_mov_b32 v137, 0
  v_mov_b32 v138, 0
  v_mov_b32 v139, 0
  v_mov_b32 v140, 0
  v_mov_b32 v141, 0
  v_mov_b32 v142, 0
  v_mov_b32 v143, 0
  s_waitcnt lgkmcnt(0)
  v_mfma_f32_16x16x32_bf16 v[112:115], v[144:147], v[176:179], v[112:115]
  ds_read_b128 v[48:51], v3 offset:384
  v_mfma_f32_16x16x32_bf16 v[116:119], v[144:147], v[180:183], v[116:119]
  ds_read_b128 v[52:55], v3 offset:896
  v_mfma_f32_16x16x32_bf16 v[120:123], v[144:147], v[184:187], v[120:123]
  ds_read_b128 v[56:59], v3 offset:1408
  v_mfma_f32_16x16x32_bf16 v[124:127], v[144:147], v[188:191], v[124:127]
  ds_read_b128 v[60:63], v3 offset:1920
  v_mfma_f32_16x16x32_bf16 v[128:131], v[144:147], v[192:195], v[128:131]
  ds_read_b128 v[64:67], v3 offset:2432
  v_mfma_f32_16x16x32_bf16 v[132:135], v[144:147], v[196:199], v[132:135]
  ds_read_b128 v[68:71], v3 offset:2944
  v_mfma_f32_16x16x32_bf16 v[136:139], v[144:147], v[200:203], v[136:139]
  ds_read_b128 v[72:75], v3 offset:3456
  v_mfma_f32_16x16x32_bf16 v[140:143], v[144:147], v[204:207], v[140:143]
  ds_read_b128 v[76:79], v3 offset:3968
  v_mfma_f32_16x16x32_bf16 v[116:119], v[148:151], v[176:179], v[116:119]
  ds_read_b64 v[208:209], v2 offset:3968
  v_mfma_f32_16x16x32_bf16 v[120:123], v[148:151], v[180:183], v[120:123]
  ds_read_b64 v[210:211], v2 offset:3976
  v_mfma_f32_16x16x32_bf16 v[124:127], v[148:151], v[184:187], v[124:127]
  ds_read_b64 v[212:213], v2 offset:3456
  v_mfma_f32_16x16x32_bf16 v[128:131], v[148:151], v[188:191], v[128:131]
  ds_read_b64 v[214:215], v2 offset:3464
  v_mfma_f32_16x16x32_bf16 v[132:135], v[148:151], v[192:195], v[132:135]
  ds_read_b64 v[216:217], v2 offset:2944
  v_mfma_f32_16x16x32_bf16 v[136:139], v[148:151], v[196:199], v[136:139]
  ds_read_b64 v[218:219], v2 offset:2952
  v_mfma_f32_16x16x32_bf16 v[140:143], v[148:151], v[200:203], v[140:143]
  ds_read_b64 v[220:221], v2 offset:2432
  v_mfma_f32_16x16x32_bf16 v[120:123], v[152:155], v[176:179], v[120:123]
  ds_read_b64 v[222:223], v2 offset:2440
  v_mfma_f32_16x16x32_bf16 v[124:127], v[152:155], v[180:183], v[124:127]
  ds_read_b64 v[224:225], v2 offset:1920
  v_mfma_f32_16x16x32_bf16 v[128:131], v[152:155], v[184:187], v[128:131]
  ds_read_b64 v[226:227], v2 offset:1928
  v_mfma_f32_16x16x32_bf16 v[132:135], v[152:155], v[188:191], v[132:135]
  ds_read_b64 v[228:229], v2 offset:1408
  v_mfma_f32_16x16x32_bf16 v[136:139], v[152:155], v[192:195], v[136:139]
  ds_read_b64 v[230:231], v2 offset:1416
  v_mfma_f32_16x16x32_bf16 v[140:143], v[152:155], v[196:199], v[140:143]
  ds_read_b64 v[232:233], v2 offset:896
  v_mfma_f32_16x16x32_bf16 v[124:127], v[156:159], v[176:179], v[124:127]
  ds_read_b64 v[234:235], v2 offset:904
  v_mfma_f32_16x16x32_bf16 v[128:131], v[156:159], v[180:183], v[128:131]
  ds_read_b64 v[236:237], v2 offset:384
  v_mfma_f32_16x16x32_bf16 v[132:135], v[156:159], v[184:187], v[132:135]
  ds_read_b64 v[238:239], v2 offset:392
  v_mfma_f32_16x16x32_bf16 v[136:139], v[156:159], v[188:191], v[136:139]
  v_mfma_f32_16x16x32_bf16 v[140:143], v[156:159], v[192:195], v[140:143]
  v_mfma_f32_16x16x32_bf16 v[128:131], v[160:163], v[176:179], v[128:131]
  v_mfma_f32_16x16x32_bf16 v[132:135], v[160:163], v[180:183], v[132:135]
  v_mfma_f32_16x16x32_bf16 v[136:139], v[160:163], v[184:187], v[136:139]
  v_mfma_f32_16x16x32_bf16 v[140:143], v[160:163], v[188:191], v[140:143]
  v_mfma_f32_16x16x32_bf16 v[132:135], v[164:167], v[176:179], v[132:135]
  v_mfma_f32_16x16x32_bf16 v[136:139], v[164:167], v[180:183], v[136:139]
  v_mfma_f32_16x16x32_bf16 v[140:143], v[164:167], v[184:187], v[140:143]
  v_mfma_f32_16x16x32_bf16 v[136:139], v[168:171], v[176:179], v[136:139]
  v_mfma_f32_16x16x32_bf16 v[140:143], v[168:171], v[180:183], v[140:143]
  v_mfma_f32_16x16x32_bf16 v[140:143], v[172:175], v[176:179], v[140:143]
  s_waitcnt lgkmcnt(0)
  v_mfma_f32_16x16x32_bf16 v[112:115], v[208:211], v[48:51], v[112:115]
  ds_read_b128 v[176:179], v3 offset:320
  v_mfma_f32_16x16x32_bf16 v[116:119], v[208:211], v[52:55], v[116:119]
  ds_read_b128 v[180:183], v3 offset:832
  v_mfma_f32_16x16x32_bf16 v[120:123], v[208:211], v[56:59], v[120:123]
  ds_read_b128 v[184:187], v3 offset:1344
  v_mfma_f32_16x16x32_bf16 v[124:127], v[208:211], v[60:63], v[124:127]
  ds_read_b128 v[188:191], v3 offset:1856
  v_mfma_f32_16x16x32_bf16 v[128:131], v[208:211], v[64:67], v[128:131]
  ds_read_b128 v[192:195], v3 offset:2368
  v_mfma_f32_16x16x32_bf16 v[132:135], v[208:211], v[68:71], v[132:135]
  ds_read_b128 v[196:199], v3 offset:2880
  v_mfma_f32_16x16x32_bf16 v[136:139], v[208:211], v[72:75], v[136:139]
  ds_read_b128 v[200:203], v3 offset:3392
  v_mfma_f32_16x16x32_bf16 v[140:143], v[208:211], v[76:79], v[140:143]
  ds_read_b128 v[204:207], v3 offset:3904
  v_mfma_f32_16x16x32_bf16 v[116:119], v[212:215], v[48:51], v[116:119]
  ds_read_b64 v[144:145], v2 offset:3904
  v_mfma_f32_16x16x32_bf16 v[120:123], v[212:215], v[52:55], v[120:123]
  ds_read_b64 v[146:147], v2 offset:3912
  v_mfma_f32_16x16x32_bf16 v[124:127], v[212:215], v[56:59], v[124:127]
  ds_read_b64 v[148:149], v2 offset:3392
  v_mfma_f32_16x16x32_bf16 v[128:131], v[212:215], v[60:63], v[128:131]
  ds_read_b64 v[150:151], v2 offset:3400
  v_mfma_f32_16x16x32_bf16 v[132:135], v[212:215], v[64:67], v[132:135]
  ds_read_b64 v[152:153], v2 offset:2880
  v_mfma_f32_16x16x32_bf16 v[136:139], v[212:215], v[68:71], v[136:139]
  ds_read_b64 v[154:155], v2 offset:2888
  v_mfma_f32_16x16x32_bf16 v[140:143], v[212:215], v[72:75], v[140:143]
  ds_read_b64 v[156:157], v2 offset:2368
  v_mfma_f32_16x16x32_bf16 v[120:123], v[216:219], v[48:51], v[120:123]
  ds_read_b64 v[158:159], v2 offset:2376
  v_mfma_f32_16x16x32_bf16 v[124:127], v[216:219], v[52:55], v[124:127]
  ds_read_b64 v[160:161], v2 offset:1856
  v_mfma_f32_16x16x32_bf16 v[128:131], v[216:219], v[56:59], v[128:131]
  ds_read_b64 v[162:163], v2 offset:1864
  v_mfma_f32_16x16x32_bf16 v[132:135], v[216:219], v[60:63], v[132:135]
  ds_read_b64 v[164:165], v2 offset:1344
  v_mfma_f32_16x16x32_bf16 v[136:139], v[216:219], v[64:67], v[136:139]
  ds_read_b64 v[166:167], v2 offset:1352
  v_mfma_f32_16x16x32_bf16 v[140:143], v[216:219], v[68:71], v[140:143]
  ds_read_b64 v[168:169], v2 offset:832
  v_mfma_f32_16x16x32_bf16 v[124:127], v[220:223], v[48:51], v[124:127]
  ds_read_b64 v[170:171], v2 offset:840
  v_mfma_f32_16x16x32_bf16 v[128:131], v[220:223], v[52:55], v[128:131]
  ds_read_b64 v[172:173], v2 offset:320
  v_mfma_f32_16x16x32_bf16 v[132:135], v[220:223], v[56:59], v[132:135]
  ds_read_b64 v[174:175], v2 offset:328
  v_mfma_f32_16x16x32_bf16 v[136:139], v[220:223], v[60:63], v[136:139]
  v_mfma_f32_16x16x32_bf16 v[140:143], v[220:223], v[64:67], v[140:143]
  v_mfma_f32_16x16x32_bf16 v[128:131], v[224:227], v[48:51], v[128:131]
  v_mfma_f32_16x16x32_bf16 v[132:135], v[224:227], v[52:55], v[132:135]
  v_mfma_f32_16x16x32_bf16 v[136:139], v[224:227], v[56:59], v[136:139]
  v_mfma_f32_16x16x32_bf16 v[140:143], v[224:227], v[60:63], v[140:143]
  v_mfma_f32_16x16x32_bf16 v[132:135], v[228:231], v[48:51], v[132:135]
  v_mfma_f32_16x16x32_bf16 v[136:139], v[228:231], v[52:55], v[136:139]
  v_mfma_f32_16x16x32_bf16 v[140:143], v[228:231], v[56:59], v[140:143]
  v_mfma_f32_16x16x32_bf16 v[136:139], v[232:235], v[48:51], v[136:139]
  v_mfma_f32_16x16x32_bf16 v[140:143], v[232:235], v[52:55], v[140:143]
  v_mfma_f32_16x16x32_bf16 v[140:143], v[236:239], v[48:51], v[140:143]
  s_waitcnt lgkmcnt(0)
  v_mfma_f32_16x16x32_bf16 v[112:115], v[144:147], v[176:179], v[112:115]
  ds_read_b128 v[48:51], v3 offset:256
  v_mfma_f32_16x16x32_bf16 v[116:119], v[144:147], v[180:183], v[116:119]
  ds_read_b128 v[52:55], v3 offset:768
  v_mfma_f32_16x16x32_bf16 v[120:123], v[144:147], v[184:187], v[120:123]
  ds_read_b128 v[56:59], v3 offset:1280
  v_mfma_f32_16x16x32_bf16 v[124:127], v[144:147], v[188:191], v[124:127]
  ds_read_b128 v[60:63], v3 offset:1792
  v_mfma_f32_16x16x32_bf16 v[128:131], v[144:147], v[192:195], v[128:131]
  ds_read_b128 v[64:67], v3 offset:2304
  v_mfma_f32_16x16x32_bf16 v[132:135], v[144:147], v[196:199], v[132:135]
  ds_read_b128 v[68:71], v3 offset:2816
  v_mfma_f32_16x16x32_bf16 v[136:139], v[144:147], v[200:203], v[136:139]
  ds_read_b128 v[72:75], v3 offset:3328
  v_mfma_f32_16x16x32_bf16 v[140:143], v[144:147], v[204:207], v[140:143]
  ds_read_b128 v[76:79], v3 offset:3840
  v_mfma_f32_16x16x32_bf16 v[116:119], v[148:151], v[176:179], v[116:119]
  ds_read_b64 v[208:209], v2 offset:3840
  v_mfma_f32_16x16x32_bf16 v[120:123], v[148:151], v[180:183], v[120:123]
  ds_read_b64 v[210:211], v2 offset:3848
  v_mfma_f32_16x16x32_bf16 v[124:127], v[148:151], v[184:187], v[124:127]
  ds_read_b64 v[212:213], v2 offset:3328
  v_mfma_f32_16x16x32_bf16 v[128:131], v[148:151], v[188:191], v[128:131]
  ds_read_b64 v[214:215], v2 offset:3336
  v_mfma_f32_16x16x32_bf16 v[132:135], v[148:151], v[192:195], v[132:135]
  ds_read_b64 v[216:217], v2 offset:2816
  v_mfma_f32_16x16x32_bf16 v[136:139], v[148:151], v[196:199], v[136:139]
  ds_read_b64 v[218:219], v2 offset:2824
  v_mfma_f32_16x16x32_bf16 v[140:143], v[148:151], v[200:203], v[140:143]
  ds_read_b64 v[220:221], v2 offset:2304
  v_mfma_f32_16x16x32_bf16 v[120:123], v[152:155], v[176:179], v[120:123]
  ds_read_b64 v[222:223], v2 offset:2312
  v_mfma_f32_16x16x32_bf16 v[124:127], v[152:155], v[180:183], v[124:127]
  ds_read_b64 v[224:225], v2 offset:1792
  v_mfma_f32_16x16x32_bf16 v[128:131], v[152:155], v[184:187], v[128:131]
  ds_read_b64 v[226:227], v2 offset:1800
  v_mfma_f32_16x16x32_bf16 v[132:135], v[152:155], v[188:191], v[132:135]
  ds_read_b64 v[228:229], v2 offset:1280
  v_mfma_f32_16x16x32_bf16 v[136:139], v[152:155], v[192:195], v[136:139]
  ds_read_b64 v[230:231], v2 offset:1288
  v_mfma_f32_16x16x32_bf16 v[140:143], v[152:155], v[196:199], v[140:143]
  ds_read_b64 v[232:233], v2 offset:768
  v_mfma_f32_16x16x32_bf16 v[124:127], v[156:159], v[176:179], v[124:127]
  ds_read_b64 v[234:235], v2 offset:776
  v_mfma_f32_16x16x32_bf16 v[128:131], v[156:159], v[180:183], v[128:131]
  ds_read_b64 v[236:237], v2 offset:256
  v_mfma_f32_16x16x32_bf16 v[132:135], v[156:159], v[184:187], v[132:135]
  ds_read_b64 v[238:239], v2 offset:264
  v_mfma_f32_16x16x32_bf16 v[136:139], v[156:159], v[188:191], v[136:139]
  v_mfma_f32_16x16x32_bf16 v[140:143], v[156:159], v[192:195], v[140:143]
  v_mfma_f32_16x16x32_bf16 v[128:131], v[160:163], v[176:179], v[128:131]
  v_mfma_f32_16x16x32_bf16 v[132:135], v[160:163], v[180:183], v[132:135]
  v_mfma_f32_16x16x32_bf16 v[136:139], v[160:163], v[184:187], v[136:139]
  v_mfma_f32_16x16x32_bf16 v[140:143], v[160:163], v[188:191], v[140:143]
  v_mfma_f32_16x16x32_bf16 v[132:135], v[164:167], v[176:179], v[132:135]
  v_mfma_f32_16x16x32_bf16 v[136:139], v[164:167], v[180:183], v[136:139]
  v_mfma_f32_16x16x32_bf16 v[140:143], v[164:167], v[184:187], v[140:143]
  v_mfma_f32_16x16x32_bf16 v[136:139], v[168:171], v[176:179], v[136:139]
  v_mfma_f32_16x16x32_bf16 v[140:143], v[168:171], v[180:183], v[140:143]
  v_mfma_f32_16x16x32_bf16 v[140:143], v[172:175], v[176:179], v[140:143]
  s_waitcnt lgkmcnt(0)
  v_mfma_f32_16x16x32_bf16 v[112:115], v[208:211], v[48:51], v[112:115]
  ds_read_b128 v[176:179], v3 offset:192
  v_mfma_f32_16x16x32_bf16 v[116:119], v[208:211], v[52:55], v[116:119]
  ds_read_b128 v[180:183], v3 offset:704
  v_mfma_f32_16x16x32_bf16 v[120:123], v[208:211], v[56:59], v[120:123]
  ds_read_b128 v[184:187], v3 offset:1216
  v_mfma_f32_16x16x32_bf16 v[124:127], v[208:211], v[60:63], v[124:127]
  ds_read_b128 v[188:191], v3 offset:1728
  v_mfma_f32_16x16x32_bf16 v[128:131], v[208:211], v[64:67], v[128:131]
  ds_read_b128 v[192:195], v3 offset:2240
  v_mfma_f32_16x16x32_bf16 v[132:135], v[208:211], v[68:71], v[132:135]
  ds_read_b128 v[196:199], v3 offset:2752
  v_mfma_f32_16x16x32_bf16 v[136:139], v[208:211], v[72:75], v[136:139]
  ds_read_b128 v[200:203], v3 offset:3264
  v_mfma_f32_16x16x32_bf16 v[140:143], v[208:211], v[76:79], v[140:143]
  ds_read_b128 v[204:207], v3 offset:3776
  v_mfma_f32_16x16x32_bf16 v[116:119], v[212:215], v[48:51], v[116:119]
  ds_read_b64 v[144:145], v2 offset:3776
  v_mfma_f32_16x16x32_bf16 v[120:123], v[212:215], v[52:55], v[120:123]
  ds_read_b64 v[146:147], v2 offset:3784
  v_mfma_f32_16x16x32_bf16 v[124:127], v[212:215], v[56:59], v[124:127]
  ds_read_b64 v[148:149], v2 offset:3264
  v_mfma_f32_16x16x32_bf16 v[128:131], v[212:215], v[60:63], v[128:131]
  ds_read_b64 v[150:151], v2 offset:3272
  v_mfma_f32_16x16x32_bf16 v[132:135], v[212:215], v[64:67], v[132:135]
  ds_read_b64 v[152:153], v2 offset:2752
  v_mfma_f32_16x16x32_bf16 v[136:139], v[212:215], v[68:71], v[136:139]
  ds_read_b64 v[154:155], v2 offset:2760
  v_mfma_f32_16x16x32_bf16 v[140:143], v[212:215], v[72:75], v[140:143]
  ds_read_b64 v[156:157], v2 offset:2240
  v_mfma_f32_16x16x32_bf16 v[120:123], v[216:219], v[48:51], v[120:123]
  ds_read_b64 v[158:159], v2 offset:2248
  v_mfma_f32_16x16x32_bf16 v[124:127], v[216:219], v[52:55], v[124:127]
  ds_read_b64 v[160:161], v2 offset:1728
  v_mfma_f32_16x16x32_bf16 v[128:131], v[216:219], v[56:59], v[128:131]
  ds_read_b64 v[162:163], v2 offset:1736
  v_mfma_f32_16x16x32_bf16 v[132:135], v[216:219], v[60:63], v[132:135]
  ds_read_b64 v[164:165], v2 offset:1216
  v_mfma_f32_16x16x32_bf16 v[136:139], v[216:219], v[64:67], v[136:139]
  ds_read_b64 v[166:167], v2 offset:1224
  v_mfma_f32_16x16x32_bf16 v[140:143], v[216:219], v[68:71], v[140:143]
  ds_read_b64 v[168:169], v2 offset:704
  v_mfma_f32_16x16x32_bf16 v[124:127], v[220:223], v[48:51], v[124:127]
  ds_read_b64 v[170:171], v2 offset:712
  v_mfma_f32_16x16x32_bf16 v[128:131], v[220:223], v[52:55], v[128:131]
  ds_read_b64 v[172:173], v2 offset:192
  v_mfma_f32_16x16x32_bf16 v[132:135], v[220:223], v[56:59], v[132:135]
  ds_read_b64 v[174:175], v2 offset:200
  v_mfma_f32_16x16x32_bf16 v[136:139], v[220:223], v[60:63], v[136:139]
  v_mfma_f32_16x16x32_bf16 v[140:143], v[220:223], v[64:67], v[140:143]
  v_mfma_f32_16x16x32_bf16 v[128:131], v[224:227], v[48:51], v[128:131]
  v_mfma_f32_16x16x32_bf16 v[132:135], v[224:227], v[52:55], v[132:135]
  v_mfma_f32_16x16x32_bf16 v[136:139], v[224:227], v[56:59], v[136:139]
  v_mfma_f32_16x16x32_bf16 v[140:143], v[224:227], v[60:63], v[140:143]
  v_mfma_f32_16x16x32_bf16 v[132:135], v[228:231], v[48:51], v[132:135]
  v_mfma_f32_16x16x32_bf16 v[136:139], v[228:231], v[52:55], v[136:139]
  v_mfma_f32_16x16x32_bf16 v[140:143], v[228:231], v[56:59], v[140:143]
  v_mfma_f32_16x16x32_bf16 v[136:139], v[232:235], v[48:51], v[136:139]
  v_mfma_f32_16x16x32_bf16 v[140:143], v[232:235], v[52:55], v[140:143]
  v_mfma_f32_16x16x32_bf16 v[140:143], v[236:239], v[48:51], v[140:143]
  s_waitcnt lgkmcnt(0)
  v_mfma_f32_16x16x32_bf16 v[112:115], v[144:147], v[176:179], v[112:115]
  ds_read_b128 v[48:51], v3 offset:128
  v_mfma_f32_16x16x32_bf16 v[116:119], v[144:147], v[180:183], v[116:119]
  ds_read_b128 v[52:55], v3 offset:640
  v_mfma_f32_16x16x32_bf16 v[120:123], v[144:147], v[184:187], v[120:123]
  ds_read_b128 v[56:59], v3 offset:1152
  v_mfma_f32_16x16x32_bf16 v[124:127], v[144:147], v[188:191], v[124:127]
  ds_read_b128 v[60:63], v3 offset:1664
  v_mfma_f32_16x16x32_bf16 v[128:131], v[144:147], v[192:195], v[128:131]
  ds_read_b128 v[64:67], v3 offset:2176
  v_mfma_f32_16x16x32_bf16 v[132:135], v[144:147], v[196:199], v[132:135]
  ds_read_b128 v[68:71], v3 offset:2688
  v_mfma_f32_16x16x32_bf16 v[136:139], v[144:147], v[200:203], v[136:139]
  ds_read_b128 v[72:75], v3 offset:3200
  v_mfma_f32_16x16x32_bf16 v[140:143], v[144:147], v[204:207], v[140:143]
  ds_read_b128 v[76:79], v3 offset:3712
  v_mfma_f32_16x16x32_bf16 v[116:119], v[148:151], v[176:179], v[116:119]
  ds_read_b64 v[208:209], v2 offset:3712
  v_mfma_f32_16x16x32_bf16 v[120:123], v[148:151], v[180:183], v[120:123]
  ds_read_b64 v[210:211], v2 offset:3720
  v_mfma_f32_16x16x32_bf16 v[124:127], v[148:151], v[184:187], v[124:127]
  ds_read_b64 v[212:213], v2 offset:3200
  v_mfma_f32_16x16x32_bf16 v[128:131], v[148:151], v[188:191], v[128:131]
  ds_read_b64 v[214:215], v2 offset:3208
  v_mfma_f32_16x16x32_bf16 v[132:135], v[148:151], v[192:195], v[132:135]
  ds_read_b64 v[216:217], v2 offset:2688
  v_mfma_f32_16x16x32_bf16 v[136:139], v[148:151], v[196:199], v[136:139]
  ds_read_b64 v[218:219], v2 offset:2696
  v_mfma_f32_16x16x32_bf16 v[140:143], v[148:151], v[200:203], v[140:143]
  ds_read_b64 v[220:221], v2 offset:2176
  v_mfma_f32_16x16x32_bf16 v[120:123], v[152:155], v[176:179], v[120:123]
  ds_read_b64 v[222:223], v2 offset:2184
  v_mfma_f32_16x16x32_bf16 v[124:127], v[152:155], v[180:183], v[124:127]
  ds_read_b64 v[224:225], v2 offset:1664
  v_mfma_f32_16x16x32_bf16 v[128:131], v[152:155], v[184:187], v[128:131]
  ds_read_b64 v[226:227], v2 offset:1672
  v_mfma_f32_16x16x32_bf16 v[132:135], v[152:155], v[188:191], v[132:135]
  ds_read_b64 v[228:229], v2 offset:1152
  v_mfma_f32_16x16x32_bf16 v[136:139], v[152:155], v[192:195], v[136:139]
  ds_read_b64 v[230:231], v2 offset:1160
  v_mfma_f32_16x16x32_bf16 v[140:143], v[152:155], v[196:199], v[140:143]
  ds_read_b64 v[232:233], v2 offset:640
  v_mfma_f32_16x16x32_bf16 v[124:127], v[156:159], v[176:179], v[124:127]
  ds_read_b64 v[234:235], v2 offset:648
  v_mfma_f32_16x16x32_bf16 v[128:131], v[156:159], v[180:183], v[128:131]
  ds_read_b64 v[236:237], v2 offset:128
  v_mfma_f32_16x16x32_bf16 v[132:135], v[156:159], v[184:187], v[132:135]
  ds_read_b64 v[238:239], v2 offset:136
  v_mfma_f32_16x16x32_bf16 v[136:139], v[156:159], v[188:191], v[136:139]
  v_mfma_f32_16x16x32_bf16 v[140:143], v[156:159], v[192:195], v[140:143]
  v_mfma_f32_16x16x32_bf16 v[128:131], v[160:163], v[176:179], v[128:131]
  v_mfma_f32_16x16x32_bf16 v[132:135], v[160:163], v[180:183], v[132:135]
  v_mfma_f32_16x16x32_bf16 v[136:139], v[160:163], v[184:187], v[136:139]
  v_mfma_f32_16x16x32_bf16 v[140:143], v[160:163], v[188:191], v[140:143]
  v_mfma_f32_16x16x32_bf16 v[132:135], v[164:167], v[176:179], v[132:135]
  v_mfma_f32_16x16x32_bf16 v[136:139], v[164:167], v[180:183], v[136:139]
  v_mfma_f32_16x16x32_bf16 v[140:143], v[164:167], v[184:187], v[140:143]
  v_mfma_f32_16x16x32_bf16 v[136:139], v[168:171], v[176:179], v[136:139]
  v_mfma_f32_16x16x32_bf16 v[140:143], v[168:171], v[180:183], v[140:143]
  v_mfma_f32_16x16x32_bf16 v[140:143], v[172:175], v[176:179], v[140:143]
  s_waitcnt lgkmcnt(0)
  v_mfma_f32_16x16x32_bf16 v[112:115], v[208:211], v[48:51], v[112:115]
  ds_read_b128 v[176:179], v3 offset:64
  v_mfma_f32_16x16x32_bf16 v[116:119], v[208:211], v[52:55], v[116:119]
  ds_read_b128 v[180:183], v3 offset:576
  v_mfma_f32_16x16x32_bf16 v[120:123], v[208:211], v[56:59], v[120:123]
  ds_read_b128 v[184:187], v3 offset:1088
  v_mfma_f32_16x16x32_bf16 v[124:127], v[208:211], v[60:63], v[124:127]
  ds_read_b128 v[188:191], v3 offset:1600
  v_mfma_f32_16x16x32_bf16 v[128:131], v[208:211], v[64:67], v[128:131]
  ds_read_b128 v[192:195], v3 offset:2112
  v_mfma_f32_16x16x32_bf16 v[132:135], v[208:211], v[68:71], v[132:135]
  ds_read_b128 v[196:199], v3 offset:2624
  v_mfma_f32_16x16x32_bf16 v[136:139], v[208:211], v[72:75], v[136:139]
  ds_read_b128 v[200:203], v3 offset:3136
  v_mfma_f32_16x16x32_bf16 v[140:143], v[208:211], v[76:79], v[140:143]
  ds_read_b128 v[204:207], v3 offset:3648
  v_mfma_f32_16x16x32_bf16 v[116:119], v[212:215], v[48:51], v[116:119]
  ds_read_b64 v[144:145], v2 offset:3648
  v_mfma_f32_16x16x32_bf16 v[120:123], v[212:215], v[52:55], v[120:123]
  ds_read_b64 v[146:147], v2 offset:3656
  v_mfma_f32_16x16x32_bf16 v[124:127], v[212:215], v[56:59], v[124:127]
  ds_read_b64 v[148:149], v2 offset:3136
  v_mfma_f32_16x16x32_bf16 v[128:131], v[212:215], v[60:63], v[128:131]
  ds_read_b64 v[150:151], v2 offset:3144
  v_mfma_f32_16x16x32_bf16 v[132:135], v[212:215], v[64:67], v[132:135]
  ds_read_b64 v[152:153], v2 offset:2624
  v_mfma_f32_16x16x32_bf16 v[136:139], v[212:215], v[68:71], v[136:139]
  ds_read_b64 v[154:155], v2 offset:2632
  v_mfma_f32_16x16x32_bf16 v[140:143], v[212:215], v[72:75], v[140:143]
  ds_read_b64 v[156:157], v2 offset:2112
  v_mfma_f32_16x16x32_bf16 v[120:123], v[216:219], v[48:51], v[120:123]
  ds_read_b64 v[158:159], v2 offset:2120
  v_mfma_f32_16x16x32_bf16 v[124:127], v[216:219], v[52:55], v[124:127]
  ds_read_b64 v[160:161], v2 offset:1600
  v_mfma_f32_16x16x32_bf16 v[128:131], v[216:219], v[56:59], v[128:131]
  ds_read_b64 v[162:163], v2 offset:1608
  v_mfma_f32_16x16x32_bf16 v[132:135], v[216:219], v[60:63], v[132:135]
  ds_read_b64 v[164:165], v2 offset:1088
  v_mfma_f32_16x16x32_bf16 v[136:139], v[216:219], v[64:67], v[136:139]
  ds_read_b64 v[166:167], v2 offset:1096
  v_mfma_f32_16x16x32_bf16 v[140:143], v[216:219], v[68:71], v[140:143]
  ds_read_b64 v[168:169], v2 offset:576
  v_mfma_f32_16x16x32_bf16 v[124:127], v[220:223], v[48:51], v[124:127]
  ds_read_b64 v[170:171], v2 offset:584
  v_mfma_f32_16x16x32_bf16 v[128:131], v[220:223], v[52:55], v[128:131]
  ds_read_b64 v[172:173], v2 offset:64
  v_mfma_f32_16x16x32_bf16 v[132:135], v[220:223], v[56:59], v[132:135]
  ds_read_b64 v[174:175], v2 offset:72
  v_mfma_f32_16x16x32_bf16 v[136:139], v[220:223], v[60:63], v[136:139]
  v_mfma_f32_16x16x32_bf16 v[140:143], v[220:223], v[64:67], v[140:143]
  v_mfma_f32_16x16x32_bf16 v[128:131], v[224:227], v[48:51], v[128:131]
  v_mfma_f32_16x16x32_bf16 v[132:135], v[224:227], v[52:55], v[132:135]
  v_mfma_f32_16x16x32_bf16 v[136:139], v[224:227], v[56:59], v[136:139]
  v_mfma_f32_16x16x32_bf16 v[140:143], v[224:227], v[60:63], v[140:143]
  v_mfma_f32_16x16x32_bf16 v[132:135], v[228:231], v[48:51], v[132:135]
  v_mfma_f32_16x16x32_bf16 v[136:139], v[228:231], v[52:55], v[136:139]
  v_mfma_f32_16x16x32_bf16 v[140:143], v[228:231], v[56:59], v[140:143]
  v_mfma_f32_16x16x32_bf16 v[136:139], v[232:235], v[48:51], v[136:139]
  v_mfma_f32_16x16x32_bf16 v[140:143], v[232:235], v[52:55], v[140:143]
  v_mfma_f32_16x16x32_bf16 v[140:143], v[236:239], v[48:51], v[140:143]
  s_waitcnt lgkmcnt(0)
  v_mfma_f32_16x16x32_bf16 v[112:115], v[144:147], v[176:179], v[112:115]
  ds_read_b128 v[48:51], v3 offset:0
  v_mfma_f32_16x16x32_bf16 v[116:119], v[144:147], v[180:183], v[116:119]
  ds_read_b128 v[52:55], v3 offset:512
  v_mfma_f32_16x16x32_bf16 v[120:123], v[144:147], v[184:187], v[120:123]
  ds_read_b128 v[56:59], v3 offset:1024
  v_mfma_f32_16x16x32_bf16 v[124:127], v[144:147], v[188:191], v[124:127]
  ds_read_b128 v[60:63], v3 offset:1536
  v_mfma_f32_16x16x32_bf16 v[128:131], v[144:147], v[192:195], v[128:131]
  ds_read_b128 v[64:67], v3 offset:2048
  v_mfma_f32_16x16x32_bf16 v[132:135], v[144:147], v[196:199], v[132:135]
  ds_read_b128 v[68:71], v3 offset:2560
  v_mfma_f32_16x16x32_bf16 v[136:139], v[144:147], v[200:203], v[136:139]
  ds_read_b128 v[72:75], v3 offset:3072
  v_mfma_f32_16x16x32_bf16 v[140:143], v[144:147], v[204:207], v[140:143]
  ds_read_b128 v[76:79], v3 offset:3584
  v_mfma_f32_16x16x32_bf16 v[116:119], v[148:151], v[176:179], v[116:119]
  ds_read_b64 v[208:209], v2 offset:3584
  v_mfma_f32_16x16x32_bf16 v[120:123], v[148:151], v[180:183], v[120:123]
  ds_read_b64 v[210:211], v2 offset:3592
  v_mfma_f32_16x16x32_bf16 v[124:127], v[148:151], v[184:187], v[124:127]
  ds_read_b64 v[212:213], v2 offset:3072
  v_mfma_f32_16x16x32_bf16 v[128:131], v[148:151], v[188:191], v[128:131]
  ds_read_b64 v[214:215], v2 offset:3080
  v_mfma_f32_16x16x32_bf16 v[132:135], v[148:151], v[192:195], v[132:135]
  ds_read_b64 v[216:217], v2 offset:2560
  v_mfma_f32_16x16x32_bf16 v[136:139], v[148:151], v[196:199], v[136:139]
  ds_read_b64 v[218:219], v2 offset:2568
  v_mfma_f32_16x16x32_bf16 v[140:143], v[148:151], v[200:203], v[140:143]
  ds_read_b64 v[220:221], v2 offset:2048
  v_mfma_f32_16x16x32_bf16 v[120:123], v[152:155], v[176:179], v[120:123]
  ds_read_b64 v[222:223], v2 offset:2056
  v_mfma_f32_16x16x32_bf16 v[124:127], v[152:155], v[180:183], v[124:127]
  ds_read_b64 v[224:225], v2 offset:1536
  v_mfma_f32_16x16x32_bf16 v[128:131], v[152:155], v[184:187], v[128:131]
  ds_read_b64 v[226:227], v2 offset:1544
  v_mfma_f32_16x16x32_bf16 v[132:135], v[152:155], v[188:191], v[132:135]
  ds_read_b64 v[228:229], v2 offset:1024
  v_mfma_f32_16x16x32_bf16 v[136:139], v[152:155], v[192:195], v[136:139]
  ds_read_b64 v[230:231], v2 offset:1032
  v_mfma_f32_16x16x32_bf16 v[140:143], v[152:155], v[196:199], v[140:143]
  ds_read_b64 v[232:233], v2 offset:512
  v_mfma_f32_16x16x32_bf16 v[124:127], v[156:159], v[176:179], v[124:127]
  ds_read_b64 v[234:235], v2 offset:520
  v_mfma_f32_16x16x32_bf16 v[128:131], v[156:159], v[180:183], v[128:131]
  ds_read_b64 v[236:237], v2 offset:0
  v_mfma_f32_16x16x32_bf16 v[132:135], v[156:159], v[184:187], v[132:135]
  ds_read_b64 v[238:239], v2 offset:8
  v_mfma_f32_16x16x32_bf16 v[136:139], v[156:159], v[188:191], v[136:139]
  v_mfma_f32_16x16x32_bf16 v[140:143], v[156:159], v[192:195], v[140:143]
  v_mfma_f32_16x16x32_bf16 v[128:131], v[160:163], v[176:179], v[128:131]
  v_mfma_f32_16x16x32_bf16 v[132:135], v[160:163], v[180:183], v[132:135]
  v_mfma_f32_16x16x32_bf16 v[136:139], v[160:163], v[184:187], v[136:139]
  v_mfma_f32_16x16x32_bf16 v[140:143], v[160:163], v[188:191], v[140:143]
  v_mfma_f32_16x16x32_bf16 v[132:135], v[164:167], v[176:179], v[132:135]
  v_mfma_f32_16x16x32_bf16 v[136:139], v[164:167], v[180:183], v[136:139]
  v_mfma_f32_16x16x32_bf16 v[140:143], v[164:167], v[184:187], v[140:143]
  v_mfma_f32_16x16x32_bf16 v[136:139], v[168:171], v[176:179], v[136:139]
  v_mfma_f32_16x16x32_bf16 v[140:143], v[168:171], v[180:183], v[140:143]
  v_mfma_f32_16x16x32_bf16 v[140:143], v[172:175], v[176:179], v[140:143]
  s_waitcnt lgkmcnt(0)
  v_mfma_f32_16x16x32_bf16 v[112:115], v[208:211], v[48:51], v[112:115]
  v_mfma_f32_16x16x32_bf16 v[116:119], v[208:211], v[52:55], v[116:119]
  v_mfma_f32_16x16x32_bf16 v[120:123], v[208:211], v[56:59], v[120:123]
  v_mfma_f32_16x16x32_bf16 v[124:127], v[208:211], v[60:63], v[124:127]
  v_mfma_f32_16x16x32_bf16 v[128:131], v[208:211], v[64:67], v[128:131]
  v_mfma_f32_16x16x32_bf16 v[132:135], v[208:211], v[68:71], v[132:135]
  v_mfma_f32_16x16x32_bf16 v[136:139], v[208:211], v[72:75], v[136:139]
  v_mfma_f32_16x16x32_bf16 v[140:143], v[208:211], v[76:79], v[140:143]
  v_mfma_f32_16x16x32_bf16 v[116:119], v[212:215], v[48:51], v[116:119]
  v_mfma_f32_16x16x32_bf16 v[120:123], v[212:215], v[52:55], v[120:123]
  v_mfma_f32_16x16x32_bf16 v[124:127], v[212:215], v[56:59], v[124:127]
  v_mfma_f32_16x16x32_bf16 v[128:131], v[212:215], v[60:63], v[128:131]
  v_mfma_f32_16x16x32_bf16 v[132:135], v[212:215], v[64:67], v[132:135]
  v_mfma_f32_16x16x32_bf16 v[136:139], v[212:215], v[68:71], v[136:139]
  v_mfma_f32_16x16x32_bf16 v[140:143], v[212:215], v[72:75], v[140:143]
  v_mfma_f32_16x16x32_bf16 v[120:123], v[216:219], v[48:51], v[120:123]
  v_mfma_f32_16x16x32_bf16 v[124:127], v[216:219], v[52:55], v[124:127]
  v_mfma_f32_16x16x32_bf16 v[128:131], v[216:219], v[56:59], v[128:131]
  v_mfma_f32_16x16x32_bf16 v[132:135], v[216:219], v[60:63], v[132:135]
  v_mfma_f32_16x16x32_bf16 v[136:139], v[216:219], v[64:67], v[136:139]
  v_mfma_f32_16x16x32_bf16 v[140:143], v[216:219], v[68:71], v[140:143]
  v_mfma_f32_16x16x32_bf16 v[124:127], v[220:223], v[48:51], v[124:127]
  v_mfma_f32_16x16x32_bf16 v[128:131], v[220:223], v[52:55], v[128:131]
  v_mfma_f32_16x16x32_bf16 v[132:135], v[220:223], v[56:59], v[132:135]
  v_mfma_f32_16x16x32_bf16 v[136:139], v[220:223], v[60:63], v[136:139]
  v_mfma_f32_16x16x32_bf16 v[140:143], v[220:223], v[64:67], v[140:143]
  v_mfma_f32_16x16x32_bf16 v[128:131], v[224:227], v[48:51], v[128:131]
  v_mfma_f32_16x16x32_bf16 v[132:135], v[224:227], v[52:55], v[132:135]
  v_mfma_f32_16x16x32_bf16 v[136:139], v[224:227], v[56:59], v[136:139]
  v_mfma_f32_16x16x32_bf16 v[140:143], v[224:227], v[60:63], v[140:143]
  v_mfma_f32_16x16x32_bf16 v[132:135], v[228:231], v[48:51], v[132:135]
  v_mfma_f32_16x16x32_bf16 v[136:139], v[228:231], v[52:55], v[136:139]
  v_mfma_f32_16x16x32_bf16 v[140:143], v[228:231], v[56:59], v[140:143]
  v_mfma_f32_16x16x32_bf16 v[136:139], v[232:235], v[48:51], v[136:139]
  v_mfma_f32_16x16x32_bf16 v[140:143], v[232:235], v[52:55], v[140:143]
  v_mfma_f32_16x16x32_bf16 v[140:143], v[236:239], v[48:51], v[140:143]
  v_mul_u32_u24 v2, 80, v14
  v_lshl_add_u32 v2, v15, 4, v2
  v_add_u32 v2, s38, v2
  ds_write_b128 v2, v[112:115] offset:0
  ds_write_b128 v2, v[116:119] offset:1280
  ds_write_b128 v2, v[120:123] offset:2560
  ds_write_b128 v2, v[124:127] offset:3840
  ds_write_b128 v2, v[128:131] offset:5120
  ds_write_b128 v2, v[132:135] offset:6400
  ds_write_b128 v2, v[136:139] offset:7680
  ds_write_b128 v2, v[140:143] offset:8960
  v_lshrrev_b32 v3, 3, v1
  v_mul_u32_u24 v3, 80, v3
  v_and_b32 v4, 7, v1
  v_lshl_add_u32 v3, v4, 3, v3
  s_mul_i32 s39, s19, 2560
  v_add_u32 v3, s39, v3
  v_add_u32 v5, 42496, v3
  s_lshl_b32 s50, s36, 16
  s_and_b32 s51, s36, 0xffff0000
  s_lshl_b32 s52, s37, 16
  s_and_b32 s53, s37, 0xffff0000
  s_mul_i32 s21, s20, 16640
  s_lshl_b32 s22, s19, 12
  s_add_u32 s21, s21, s22
  v_lshlrev_b32 v4, 4, v1
  s_waitcnt lgkmcnt(0)
  s_barrier
  ds_read_b64 v[144:145], v3 offset:0
  ds_read_b64 v[146:147], v3 offset:21248
  ds_read_b64 v[148:149], v5 offset:0
  ds_read_b64 v[150:151], v5 offset:21248
  ds_read_b64 v[152:153], v3 offset:640
  ds_read_b64 v[154:155], v3 offset:21888
  ds_read_b64 v[156:157], v5 offset:640
  ds_read_b64 v[158:159], v5 offset:21888
  ds_read_b64 v[160:161], v3 offset:1280
  ds_read_b64 v[162:163], v3 offset:22528
  ds_read_b64 v[164:165], v5 offset:1280
  ds_read_b64 v[166:167], v5 offset:22528
  ds_read_b64 v[168:169], v3 offset:1920
  ds_read_b64 v[170:171], v3 offset:23168
  ds_read_b64 v[172:173], v5 offset:1920
  ds_read_b64 v[174:175], v5 offset:23168
  s_waitcnt lgkmcnt(12)
  v_lshlrev_b32 v6, 16, v96
  v_and_b32 v7, 0xffff0000, v96
  v_lshlrev_b32 v8, 16, v16
  v_lshlrev_b32 v9, 16, v18
  v_pk_fma_f32 v[144:145], v[6:7], s[50:51], v[144:145] op_sel:[0,0,0] op_sel_hi:[1,0,1]
  v_pk_fma_f32 v[8:9], v[144:145], v[84:85], v[8:9] op_sel:[0,0,0] op_sel_hi:[1,0,1]
  v_lshlrev_b32 v80, 16, v97
  v_and_b32 v81, 0xffff0000, v97
  v_and_b32 v10, 0xffff0000, v16
  v_and_b32 v11, 0xffff0000, v18
  v_pk_fma_f32 v[146:147], v[80:81], s[50:51], v[146:147] op_sel:[0,1,0] op_sel_hi:[1,1,1]
  v_pk_fma_f32 v[10:11], v[146:147], v[84:85], v[10:11] op_sel:[0,1,0] op_sel_hi:[1,1,1]
  v_lshlrev_b32 v6, 16, v98
  v_and_b32 v7, 0xffff0000, v98
  v_lshlrev_b32 v12, 16, v17
  v_lshlrev_b32 v13, 16, v19
  v_pk_fma_f32 v[148:149], v[6:7], s[52:53], v[148:149] op_sel:[0,0,0] op_sel_hi:[1,0,1]
  v_pk_fma_f32 v[12:13], v[148:149], v[86:87], v[12:13] op_sel:[0,0,0] op_sel_hi:[1,0,1]
  v_lshlrev_b32 v80, 16, v99
  v_and_b32 v81, 0xffff0000, v99
  v_and_b32 v14, 0xffff0000, v17
  v_and_b32 v15, 0xffff0000, v19
  v_pk_fma_f32 v[150:151], v[80:81], s[52:53], v[150:151] op_sel:[0,1,0] op_sel_hi:[1,1,1]
  v_pk_fma_f32 v[14:15], v[150:151], v[86:87], v[14:15] op_sel:[0,1,0] op_sel_hi:[1,1,1]
  v_cvt_pk_bf16_f32 v176, v8, v10
  v_cvt_pk_bf16_f32 v177, v12, v14
  v_cvt_pk_bf16_f32 v178, v9, v11
  v_cvt_pk_bf16_f32 v179, v13, v15
  buffer_store_dwordx4 v[176:179], v4, s[40:43], s21 offen offset:0 sc1
  s_waitcnt lgkmcnt(8)
  v_lshlrev_b32 v6, 16, v100
  v_and_b32 v7, 0xffff0000, v100
  v_lshlrev_b32 v8, 16, v20
  v_lshlrev_b32 v9, 16, v22
  v_pk_fma_f32 v[152:153], v[6:7], s[50:51], v[152:153] op_sel:[0,0,0] op_sel_hi:[1,0,1]
  v_pk_fma_f32 v[8:9], v[152:153], v[84:85], v[8:9] op_sel:[0,0,0] op_sel_hi:[1,0,1]
  v_lshlrev_b32 v80, 16, v101
  v_and_b32 v81, 0xffff0000, v101
  v_and_b32 v10, 0xffff0000, v20
  v_and_b32 v11, 0xffff0000, v22
  v_pk_fma_f32 v[154:155], v[80:81], s[50:51], v[154:155] op_sel:[0,1,0] op_sel_hi:[1,1,1]
  v_pk_fma_f32 v[10:11], v[154:155], v[84:85], v[10:11] op_sel:[0,1,0] op_sel_hi:[1,1,1]
  v_lshlrev_b32 v6, 16, v102
  v_and_b32 v7, 0xffff0000, v102
  v_lshlrev_b32 v12, 16, v21
  v_lshlrev_b32 v13, 16, v23
  v_pk_fma_f32 v[156:157], v[6:7], s[52:53], v[156:157] op_sel:[0,0,0] op_sel_hi:[1,0,1]
  v_pk_fma_f32 v[12:13], v[156:157], v[86:87], v[12:13] op_sel:[0,0,0] op_sel_hi:[1,0,1]
  v_lshlrev_b32 v80, 16, v103
  v_and_b32 v81, 0xffff0000, v103
  v_and_b32 v14, 0xffff0000, v21
  v_and_b32 v15, 0xffff0000, v23
  v_pk_fma_f32 v[158:159], v[80:81], s[52:53], v[158:159] op_sel:[0,1,0] op_sel_hi:[1,1,1]
  v_pk_fma_f32 v[14:15], v[158:159], v[86:87], v[14:15] op_sel:[0,1,0] op_sel_hi:[1,1,1]
  v_cvt_pk_bf16_f32 v180, v8, v10
  v_cvt_pk_bf16_f32 v181, v12, v14
  v_cvt_pk_bf16_f32 v182, v9, v11
  v_cvt_pk_bf16_f32 v183, v13, v15
  buffer_store_dwordx4 v[180:183], v4, s[40:43], s21 offen offset:1024 sc1
  s_waitcnt lgkmcnt(4)
  v_lshlrev_b32 v6, 16, v104
  v_and_b32 v7, 0xffff0000, v104
  v_lshlrev_b32 v8, 16, v24
  v_lshlrev_b32 v9, 16, v26
  v_pk_fma_f32 v[160:161], v[6:7], s[50:51], v[160:161] op_sel:[0,0,0] op_sel_hi:[1,0,1]
  v_pk_fma_f32 v[8:9], v[160:161], v[84:85], v[8:9] op_sel:[0,0,0] op_sel_hi:[1,0,1]
  v_lshlrev_b32 v80, 16, v105
  v_and_b32 v81, 0xffff0000, v105
  v_and_b32 v10, 0xffff0000, v24
  v_and_b32 v11, 0xffff0000, v26
  v_pk_fma_f32 v[162:163], v[80:81], s[50:51], v[162:163] op_sel:[0,1,0] op_sel_hi:[1,1,1]
  v_pk_fma_f32 v[10:11], v[162:163], v[84:85], v[10:11] op_sel:[0,1,0] op_sel_hi:[1,1,1]
  v_lshlrev_b32 v6, 16, v106
  v_and_b32 v7, 0xffff0000, v106
  v_lshlrev_b32 v12, 16, v25
  v_lshlrev_b32 v13, 16, v27
  v_pk_fma_f32 v[164:165], v[6:7], s[52:53], v[164:165] op_sel:[0,0,0] op_sel_hi:[1,0,1]
  v_pk_fma_f32 v[12:13], v[164:165], v[86:87], v[12:13] op_sel:[0,0,0] op_sel_hi:[1,0,1]
  v_lshlrev_b32 v80, 16, v107
  v_and_b32 v81, 0xffff0000, v107
  v_and_b32 v14, 0xffff0000, v25
  v_and_b32 v15, 0xffff0000, v27
  v_pk_fma_f32 v[166:167], v[80:81], s[52:53], v[166:167] op_sel:[0,1,0] op_sel_hi:[1,1,1]
  v_pk_fma_f32 v[14:15], v[166:167], v[86:87], v[14:15] op_sel:[0,1,0] op_sel_hi:[1,1,1]
  v_cvt_pk_bf16_f32 v184, v8, v10
  v_cvt_pk_bf16_f32 v185, v12, v14
  v_cvt_pk_bf16_f32 v186, v9, v11
  v_cvt_pk_bf16_f32 v187, v13, v15
  buffer_store_dwordx4 v[184:187], v4, s[40:43], s21 offen offset:2048 sc1
  s_waitcnt lgkmcnt(0)
  v_lshlrev_b32 v6, 16, v108
  v_and_b32 v7, 0xffff0000, v108
  v_lshlrev_b32 v8, 16, v28
  v_lshlrev_b32 v9, 16, v30
  v_pk_fma_f32 v[168:169], v[6:7], s[50:51], v[168:169] op_sel:[0,0,0] op_sel_hi:[1,0,1]
  v_pk_fma_f32 v[8:9], v[168:169], v[84:85], v[8:9] op_sel:[0,0,0] op_sel_hi:[1,0,1]
  v_lshlrev_b32 v80, 16, v109
  v_and_b32 v81, 0xffff0000, v109
  v_and_b32 v10, 0xffff0000, v28
  v_and_b32 v11, 0xffff0000, v30
  v_pk_fma_f32 v[170:171], v[80:81], s[50:51], v[170:171] op_sel:[0,1,0] op_sel_hi:[1,1,1]
  v_pk_fma_f32 v[10:11], v[170:171], v[84:85], v[10:11] op_sel:[0,1,0] op_sel_hi:[1,1,1]
  v_lshlrev_b32 v6, 16, v110
  v_and_b32 v7, 0xffff0000, v110
  v_lshlrev_b32 v12, 16, v29
  v_lshlrev_b32 v13, 16, v31
  v_pk_fma_f32 v[172:173], v[6:7], s[52:53], v[172:173] op_sel:[0,0,0] op_sel_hi:[1,0,1]
  v_pk_fma_f32 v[12:13], v[172:173], v[86:87], v[12:13] op_sel:[0,0,0] op_sel_hi:[1,0,1]
  v_lshlrev_b32 v80, 16, v111
  v_and_b32 v81, 0xffff0000, v111
  v_and_b32 v14, 0xffff0000, v29
  v_and_b32 v15, 0xffff0000, v31
  v_pk_fma_f32 v[174:175], v[80:81], s[52:53], v[174:175] op_sel:[0,1,0] op_sel_hi:[1,1,1]
  v_pk_fma_f32 v[14:15], v[174:175], v[86:87], v[14:15] op_sel:[0,1,0] op_sel_hi:[1,1,1]
  v_cvt_pk_bf16_f32 v188, v8, v10
  v_cvt_pk_bf16_f32 v189, v12, v14
  v_cvt_pk_bf16_f32 v190, v9, v11
  v_cvt_pk_bf16_f32 v191, v13, v15
  buffer_store_dwordx4 v[188:191], v4, s[40:43], s21 offen offset:3072 sc1
  s_branch k2_kernel_end
k2_kernel_w1:
  s_sub_u32 s20, s2, 160
  s_and_b32 s21, s20, 1
  s_lshr_b32 s22, s20, 1
  s_lshl_b32 s23, s21, 3
  s_add_u32 s6, s0, s23
  s_addc_u32 s7, s1, 0
  s_load_dwordx2 s[6:7], s[6:7], 64
  v_and_b32 v1, 63, v0
  v_lshrrev_b32 v2, 3, v1
  v_and_b32 v3, 7, v1
  v_mul_u32_u24 v4, 3456, v2
  v_lshl_add_u32 v4, v3, 4, v4
  s_lshl_b32 s23, s22, 7
  s_mul_i32 s24, s19, 27648
  s_add_u32 s23, s23, s24
  v_add_u32 v4, s23, v4
  s_waitcnt lgkmcnt(0)
  s_mov_b32 s8, s6
  s_mov_b32 s9, s7
  s_mov_b32 s10, 2211840
  s_mov_b32 s11, 0x20000
  s_lshl_b32 s25, s19, 10
  s_add_u32 m0, s25, 12800
  s_mov_b32 s26, 0
  buffer_load_dwordx4 v4, s[8:11], s26 offen nt lds
  s_add_u32 m0, s25, 16896
  s_mov_b32 s26, 110592
  buffer_load_dwordx4 v4, s[8:11], s26 offen nt lds
  s_add_u32 m0, s25, 20992
  s_mov_b32 s26, 221184
  buffer_load_dwordx4 v4, s[8:11], s26 offen nt lds
  s_add_u32 m0, s25, 25088
  s_mov_b32 s26, 331776
  buffer_load_dwordx4 v4, s[8:11], s26 offen nt lds
  s_add_u32 m0, s25, 29184
  s_mov_b32 s26, 442368
  buffer_load_dwordx4 v4, s[8:11], s26 offen nt lds
  s_add_u32 m0, s25, 33280
  s_mov_b32 s26, 552960
  buffer_load_dwordx4 v4, s[8:11], s26 offen nt lds
  s_add_u32 m0, s25, 37376
  s_mov_b32 s26, 663552
  buffer_load_dwordx4 v4, s[8:11], s26 offen nt lds
  s_add_u32 m0, s25, 41472
  s_mov_b32 s26, 774144
  buffer_load_dwordx4 v4, s[8:11], s26 offen nt lds
  s_add_u32 m0, s25, 45568
  s_mov_b32 s26, 884736
  buffer_load_dwordx4 v4, s[8:11], s26 offen nt lds
  s_add_u32 m0, s25, 49664
  s_mov_b32 s26, 995328
  buffer_load_dwordx4 v4, s[8:11], s26 offen nt lds
  s_add_u32 m0, s25, 53760
  s_mov_b32 s26, 1105920
  buffer_load_dwordx4 v4, s[8:11], s26 offen nt lds
  s_add_u32 m0, s25, 57856
  s_mov_b32 s26, 1216512
  buffer_load_dwordx4 v4, s[8:11], s26 offen nt lds
  s_add_u32 m0, s25, 61952
  s_mov_b32 s26, 1327104
  buffer_load_dwordx4 v4, s[8:11], s26 offen nt lds
  s_add_u32 m0, s25, 66048
  s_mov_b32 s26, 1437696
  buffer_load_dwordx4 v4, s[8:11], s26 offen nt lds
  s_add_u32 m0, s25, 70144
  s_mov_b32 s26, 1548288
  buffer_load_dwordx4 v4, s[8:11], s26 offen nt lds
  s_add_u32 m0, s25, 74240
  s_mov_b32 s26, 1658880
  buffer_load_dwordx4 v4, s[8:11], s26 offen nt lds
  s_add_u32 m0, s25, 78336
  s_mov_b32 s26, 1769472
  buffer_load_dwordx4 v4, s[8:11], s26 offen nt lds
  s_add_u32 m0, s25, 82432
  s_mov_b32 s26, 1880064
  buffer_load_dwordx4 v4, s[8:11], s26 offen nt lds
  s_add_u32 m0, s25, 86528
  s_mov_b32 s26, 1990656
  buffer_load_dwordx4 v4, s[8:11], s26 offen nt lds
  s_add_u32 m0, s25, 90624
  s_mov_b32 s26, 2101248
  buffer_load_dwordx4 v4, s[8:11], s26 offen nt lds
  s_add_u32 s12, s4, 7680
  s_addc_u32 s13, s5, 0
  s_mov_b32 s14, 24064
  s_mov_b32 s15, 0x20000
  s_add_u32 s40, s4, 13631488
  s_addc_u32 s41, s5, 0
  s_mov_b32 s42, 4423680
  s_mov_b32 s43, 0x20000
  s_add_u32 s44, s4, 65536
  s_addc_u32 s45, s5, 0
  s_mov_b32 s46, 27648
  s_mov_b32 s47, 0x20000
  v_lshlrev_b32 v5, 2, v0
  buffer_load_dword v6, v5, s[12:15], 0 offen offset:0
  buffer_load_dword v7, v5, s[12:15], 0 offen offset:1024
  buffer_load_dword v8, v5, s[12:15], 0 offen offset:2048
  s_mov_b32 s26, 2560
  buffer_load_dword v9, v5, s[12:15], s26 offen offset:0
  buffer_load_dword v10, v5, s[12:15], s26 offen offset:1024
  buffer_load_dword v11, v5, s[12:15], s26 offen offset:2048
  s_mov_b32 s26, 16384
  buffer_load_dword v144, v5, s[12:15], s26 offen offset:0
  buffer_load_dword v145, v5, s[12:15], s26 offen offset:1024
  buffer_load_dword v146, v5, s[12:15], s26 offen offset:2048
  s_mov_b32 s26, 18944
  buffer_load_dword v147, v5, s[12:15], s26 offen offset:0
  buffer_load_dword v148, v5, s[12:15], s26 offen offset:1024
  buffer_load_dword v149, v5, s[12:15], s26 offen offset:2048
  s_mov_b32 s26, 5120
  buffer_load_dword v150, v5, s[12:15], s26 offen offset:0
  buffer_load_dword v151, v5, s[12:15], s26 offen offset:1024
  buffer_load_dword v152, v5, s[12:15], s26 offen offset:2048
  s_mov_b32 s26, 21504
  buffer_load_dword v153, v5, s[12:15], s26 offen offset:0
  buffer_load_dword v154, v5, s[12:15], s26 offen offset:1024
  buffer_load_dword v155, v5, s[12:15], s26 offen offset:2048
  v_lshlrev_b32 v12, 1, v0
  v_lshrrev_b32 v13, 4, v1
  v_and_b32 v16, 15, v1
  v_lshrrev_b32 v17, 2, v16
  v_lshl_add_u32 v17, v13, 3, v17
  v_lshlrev_b32 v17, 7, v17
  v_and_b32 v18, 3, v1
  v_lshl_add_u32 v17, v18, 3, v17
  s_lshl_b32 s25, s19, 12
  s_add_u32 s25, s25, 12800
  v_add_u32 v17, s25, v17
  v_add_u32 v18, 49152, v17
  v_lshlrev_b32 v19, 5, v13
  s_lshl_b32 s25, s19, 7
  v_add_u32 v19, s25, v19
  v_lshrrev_b32 v20, 1, v19
  v_lshlrev_b32 v21, 4, v1
  s_mul_i32 s25, s22, 163840
  s_lshl_b32 s26, s21, 10
  s_add_u32 s25, s25, s26
  s_lshl_b32 s26, s19, 12
  s_add_u32 s25, s25, s26
  v_add_u32 v21, s25, v21
  s_mov_b32 s27, 0x3f803f80
  v_mov_b32 v24, 0
  v_mov_b32 v25, 0
  v_mov_b32 v26, 0
  v_mov_b32 v27, 0
  v_mov_b32 v28, 0
  v_mov_b32 v29, 0
  v_mov_b32 v30, 0
  v_mov_b32 v31, 0
  s_waitcnt vmcnt(0)
  v_add_f32 v6, v6, v144
  v_add_f32 v9, v9, v147
  v_add_f32 v150, v150, v153
  v_cvt_pk_bf16_f32 v6, v6, v6
  v_and_b32 v6, 0xffff0000, v6
  v_cvt_pk_bf16_f32 v9, v9, v9
  v_and_b32 v9, 0xffff0000, v9
  v_cvt_pk_bf16_f32 v150, v150, v150
  v_and_b32 v150, 0xffff0000, v150
  v_add_f32 v7, v7, v145
  v_add_f32 v10, v10, v148
  v_add_f32 v151, v151, v154
  v_cvt_pk_bf16_f32 v7, v7, v7
  v_and_b32 v7, 0xffff0000, v7
  v_cvt_pk_bf16_f32 v10, v10, v10
  v_and_b32 v10, 0xffff0000, v10
  v_cvt_pk_bf16_f32 v151, v151, v151
  v_and_b32 v151, 0xffff0000, v151
  v_add_f32 v8, v8, v146
  v_add_f32 v11, v11, v149
  v_add_f32 v152, v152, v155
  v_cvt_pk_bf16_f32 v8, v8, v8
  v_and_b32 v8, 0xffff0000, v8
  v_cvt_pk_bf16_f32 v11, v11, v11
  v_and_b32 v11, 0xffff0000, v11
  v_cvt_pk_bf16_f32 v152, v152, v152
  v_and_b32 v152, 0xffff0000, v152
  s_add_u32 s48, s4, 32768
  s_addc_u32 s49, s5, 0
  s_mov_b32 s50, 2560
  s_mov_b32 s51, 0x20000
  s_cmp_lg_u32 s20, 0
  s_cbranch_scc1 L_k2_kernel_nogb_1
  buffer_store_dword v150, v5, s[48:51], 0 offen offset:0 sc1
  buffer_store_dword v151, v5, s[48:51], 0 offen offset:1024 sc1
  buffer_store_dword v152, v5, s[48:51], 0 offen offset:2048 sc1
L_k2_kernel_nogb_1:
  v_add_f32 v9, 1.0, v9
  v_cvt_pk_bf16_f32 v9, v9, v9
  v_and_b32 v9, 0xffff0000, v9
  ds_write_b32 v5, v9 offset:0
  v_lshrrev_b32 v6, 16, v6
  ds_write_b16 v12, v6 offset:3072
  v_add_f32 v10, 1.0, v10
  v_cvt_pk_bf16_f32 v10, v10, v10
  v_and_b32 v10, 0xffff0000, v10
  ds_write_b32 v5, v10 offset:1024
  v_lshrrev_b32 v7, 16, v7
  ds_write_b16 v12, v7 offset:3584
  v_add_f32 v11, 1.0, v11
  v_cvt_pk_bf16_f32 v11, v11, v11
  v_and_b32 v11, 0xffff0000, v11
  ds_write_b32 v5, v11 offset:2048
  v_lshrrev_b32 v8, 16, v8
  ds_write_b16 v12, v8 offset:4096
  s_waitcnt lgkmcnt(0)
  s_barrier
  ds_read_b128 v[32:35], v19 offset:0
  ds_read_b128 v[36:39], v19 offset:16
  ds_read_b128 v[40:43], v20 offset:3072
  ds_read_b64_tr_b16 v[44:45], v17 offset:0
  ds_read_b64_tr_b16 v[46:47], v17 offset:512
  ds_read_b64_tr_b16 v[48:49], v17 offset:32
  ds_read_b64_tr_b16 v[50:51], v17 offset:544
  ds_read_b64_tr_b16 v[52:53], v17 offset:64
  ds_read_b64_tr_b16 v[54:55], v17 offset:576
  ds_read_b64_tr_b16 v[56:57], v17 offset:96
  ds_read_b64_tr_b16 v[58:59], v17 offset:608
  s_waitcnt lgkmcnt(6)
  v_lshlrev_b32 v60, 16, v44
  v_and_b32 v61, 0xffff0000, v44
  v_lshlrev_b32 v62, 16, v45
  v_and_b32 v63, 0xffff0000, v45
  v_lshlrev_b32 v64, 16, v46
  v_and_b32 v65, 0xffff0000, v46
  v_lshlrev_b32 v66, 16, v47
  v_and_b32 v67, 0xffff0000, v47
  v_pk_mul_f32 v[60:61], v[60:61], v[32:33]
  v_pk_mul_f32 v[62:63], v[62:63], v[34:35]
  v_pk_mul_f32 v[64:65], v[64:65], v[36:37]
  v_pk_mul_f32 v[66:67], v[66:67], v[38:39]
  v_cvt_pk_bf16_f32 v128, v60, v61
  v_cvt_pk_bf16_f32 v129, v62, v63
  v_cvt_pk_bf16_f32 v130, v64, v65
  v_cvt_pk_bf16_f32 v131, v66, v67
  v_dot2_f32_bf16 v25, v44, v40, v25
  v_dot2_f32_bf16 v25, v45, v41, v25
  v_dot2_f32_bf16 v25, v46, v42, v25
  v_dot2_f32_bf16 v25, v47, v43, v25
  v_dot2_f32_bf16 v24, v128, s27, v24
  v_dot2_f32_bf16 v24, v129, s27, v24
  v_dot2_f32_bf16 v24, v130, s27, v24
  v_dot2_f32_bf16 v24, v131, s27, v24
  s_mov_b32 s26, 0
  buffer_store_dwordx4 v[128:131], v21, s[40:43], s26 offen sc1
  s_waitcnt lgkmcnt(4)
  v_lshlrev_b32 v60, 16, v48
  v_and_b32 v61, 0xffff0000, v48
  v_lshlrev_b32 v62, 16, v49
  v_and_b32 v63, 0xffff0000, v49
  v_lshlrev_b32 v64, 16, v50
  v_and_b32 v65, 0xffff0000, v50
  v_lshlrev_b32 v66, 16, v51
  v_and_b32 v67, 0xffff0000, v51
  v_pk_mul_f32 v[60:61], v[60:61], v[32:33]
  v_pk_mul_f32 v[62:63], v[62:63], v[34:35]
  v_pk_mul_f32 v[64:65], v[64:65], v[36:37]
  v_pk_mul_f32 v[66:67], v[66:67], v[38:39]
  v_cvt_pk_bf16_f32 v132, v60, v61
  v_cvt_pk_bf16_f32 v133, v62, v63
  v_cvt_pk_bf16_f32 v134, v64, v65
  v_cvt_pk_bf16_f32 v135, v66, v67
  v_dot2_f32_bf16 v27, v48, v40, v27
  v_dot2_f32_bf16 v27, v49, v41, v27
  v_dot2_f32_bf16 v27, v50, v42, v27
  v_dot2_f32_bf16 v27, v51, v43, v27
  v_dot2_f32_bf16 v26, v132, s27, v26
  v_dot2_f32_bf16 v26, v133, s27, v26
  v_dot2_f32_bf16 v26, v134, s27, v26
  v_dot2_f32_bf16 v26, v135, s27, v26
  s_mov_b32 s26, 2048
  buffer_store_dwordx4 v[132:135], v21, s[40:43], s26 offen sc1
  s_waitcnt lgkmcnt(2)
  v_lshlrev_b32 v60, 16, v52
  v_and_b32 v61, 0xffff0000, v52
  v_lshlrev_b32 v62, 16, v53
  v_and_b32 v63, 0xffff0000, v53
  v_lshlrev_b32 v64, 16, v54
  v_and_b32 v65, 0xffff0000, v54
  v_lshlrev_b32 v66, 16, v55
  v_and_b32 v67, 0xffff0000, v55
  v_pk_mul_f32 v[60:61], v[60:61], v[32:33]
  v_pk_mul_f32 v[62:63], v[62:63], v[34:35]
  v_pk_mul_f32 v[64:65], v[64:65], v[36:37]
  v_pk_mul_f32 v[66:67], v[66:67], v[38:39]
  v_cvt_pk_bf16_f32 v136, v60, v61
  v_cvt_pk_bf16_f32 v137, v62, v63
  v_cvt_pk_bf16_f32 v138, v64, v65
  v_cvt_pk_bf16_f32 v139, v66, v67
  v_dot2_f32_bf16 v29, v52, v40, v29
  v_dot2_f32_bf16 v29, v53, v41, v29
  v_dot2_f32_bf16 v29, v54, v42, v29
  v_dot2_f32_bf16 v29, v55, v43, v29
  v_dot2_f32_bf16 v28, v136, s27, v28
  v_dot2_f32_bf16 v28, v137, s27, v28
  v_dot2_f32_bf16 v28, v138, s27, v28
  v_dot2_f32_bf16 v28, v139, s27, v28
  s_mov_b32 s26, 81920
  buffer_store_dwordx4 v[136:139], v21, s[40:43], s26 offen sc1
  s_waitcnt lgkmcnt(0)
  v_lshlrev_b32 v60, 16, v56
  v_and_b32 v61, 0xffff0000, v56
  v_lshlrev_b32 v62, 16, v57
  v_and_b32 v63, 0xffff0000, v57
  v_lshlrev_b32 v64, 16, v58
  v_and_b32 v65, 0xffff0000, v58
  v_lshlrev_b32 v66, 16, v59
  v_and_b32 v67, 0xffff0000, v59
  v_pk_mul_f32 v[60:61], v[60:61], v[32:33]
  v_pk_mul_f32 v[62:63], v[62:63], v[34:35]
  v_pk_mul_f32 v[64:65], v[64:65], v[36:37]
  v_pk_mul_f32 v[66:67], v[66:67], v[38:39]
  v_cvt_pk_bf16_f32 v140, v60, v61
  v_cvt_pk_bf16_f32 v141, v62, v63
  v_cvt_pk_bf16_f32 v142, v64, v65
  v_cvt_pk_bf16_f32 v143, v66, v67
  v_dot2_f32_bf16 v31, v56, v40, v31
  v_dot2_f32_bf16 v31, v57, v41, v31
  v_dot2_f32_bf16 v31, v58, v42, v31
  v_dot2_f32_bf16 v31, v59, v43, v31
  v_dot2_f32_bf16 v30, v140, s27, v30
  v_dot2_f32_bf16 v30, v141, s27, v30
  v_dot2_f32_bf16 v30, v142, s27, v30
  v_dot2_f32_bf16 v30, v143, s27, v30
  s_mov_b32 s26, 83968
  buffer_store_dwordx4 v[140:143], v21, s[40:43], s26 offen sc1
  ds_read_b128 v[80:83], v19 offset:512
  ds_read_b128 v[84:87], v19 offset:528
  ds_read_b128 v[88:91], v20 offset:3328
  ds_read_b64_tr_b16 v[92:93], v17 offset:16384
  ds_read_b64_tr_b16 v[94:95], v17 offset:16896
  ds_read_b64_tr_b16 v[96:97], v17 offset:16416
  ds_read_b64_tr_b16 v[98:99], v17 offset:16928
  ds_read_b64_tr_b16 v[100:101], v17 offset:16448
  ds_read_b64_tr_b16 v[102:103], v17 offset:16960
  ds_read_b64_tr_b16 v[104:105], v17 offset:16480
  ds_read_b64_tr_b16 v[106:107], v17 offset:16992
  s_waitcnt lgkmcnt(6)
  v_lshlrev_b32 v108, 16, v92
  v_and_b32 v109, 0xffff0000, v92
  v_lshlrev_b32 v110, 16, v93
  v_and_b32 v111, 0xffff0000, v93
  v_lshlrev_b32 v112, 16, v94
  v_and_b32 v113, 0xffff0000, v94
  v_lshlrev_b32 v114, 16, v95
  v_and_b32 v115, 0xffff0000, v95
  v_pk_mul_f32 v[108:109], v[108:109], v[80:81]
  v_pk_mul_f32 v[110:111], v[110:111], v[82:83]
  v_pk_mul_f32 v[112:113], v[112:113], v[84:85]
  v_pk_mul_f32 v[114:115], v[114:115], v[86:87]
  v_cvt_pk_bf16_f32 v128, v108, v109
  v_cvt_pk_bf16_f32 v129, v110, v111
  v_cvt_pk_bf16_f32 v130, v112, v113
  v_cvt_pk_bf16_f32 v131, v114, v115
  v_dot2_f32_bf16 v25, v92, v88, v25
  v_dot2_f32_bf16 v25, v93, v89, v25
  v_dot2_f32_bf16 v25, v94, v90, v25
  v_dot2_f32_bf16 v25, v95, v91, v25
  v_dot2_f32_bf16 v24, v128, s27, v24
  v_dot2_f32_bf16 v24, v129, s27, v24
  v_dot2_f32_bf16 v24, v130, s27, v24
  v_dot2_f32_bf16 v24, v131, s27, v24
  s_mov_b32 s26, 16384
  buffer_store_dwordx4 v[128:131], v21, s[40:43], s26 offen sc1
  s_waitcnt lgkmcnt(4)
  v_lshlrev_b32 v108, 16, v96
  v_and_b32 v109, 0xffff0000, v96
  v_lshlrev_b32 v110, 16, v97
  v_and_b32 v111, 0xffff0000, v97
  v_lshlrev_b32 v112, 16, v98
  v_and_b32 v113, 0xffff0000, v98
  v_lshlrev_b32 v114, 16, v99
  v_and_b32 v115, 0xffff0000, v99
  v_pk_mul_f32 v[108:109], v[108:109], v[80:81]
  v_pk_mul_f32 v[110:111], v[110:111], v[82:83]
  v_pk_mul_f32 v[112:113], v[112:113], v[84:85]
  v_pk_mul_f32 v[114:115], v[114:115], v[86:87]
  v_cvt_pk_bf16_f32 v132, v108, v109
  v_cvt_pk_bf16_f32 v133, v110, v111
  v_cvt_pk_bf16_f32 v134, v112, v113
  v_cvt_pk_bf16_f32 v135, v114, v115
  v_dot2_f32_bf16 v27, v96, v88, v27
  v_dot2_f32_bf16 v27, v97, v89, v27
  v_dot2_f32_bf16 v27, v98, v90, v27
  v_dot2_f32_bf16 v27, v99, v91, v27
  v_dot2_f32_bf16 v26, v132, s27, v26
  v_dot2_f32_bf16 v26, v133, s27, v26
  v_dot2_f32_bf16 v26, v134, s27, v26
  v_dot2_f32_bf16 v26, v135, s27, v26
  s_mov_b32 s26, 18432
  buffer_store_dwordx4 v[132:135], v21, s[40:43], s26 offen sc1
  s_waitcnt lgkmcnt(2)
  v_lshlrev_b32 v108, 16, v100
  v_and_b32 v109, 0xffff0000, v100
  v_lshlrev_b32 v110, 16, v101
  v_and_b32 v111, 0xffff0000, v101
  v_lshlrev_b32 v112, 16, v102
  v_and_b32 v113, 0xffff0000, v102
  v_lshlrev_b32 v114, 16, v103
  v_and_b32 v115, 0xffff0000, v103
  v_pk_mul_f32 v[108:109], v[108:109], v[80:81]
  v_pk_mul_f32 v[110:111], v[110:111], v[82:83]
  v_pk_mul_f32 v[112:113], v[112:113], v[84:85]
  v_pk_mul_f32 v[114:115], v[114:115], v[86:87]
  v_cvt_pk_bf16_f32 v136, v108, v109
  v_cvt_pk_bf16_f32 v137, v110, v111
  v_cvt_pk_bf16_f32 v138, v112, v113
  v_cvt_pk_bf16_f32 v139, v114, v115
  v_dot2_f32_bf16 v29, v100, v88, v29
  v_dot2_f32_bf16 v29, v101, v89, v29
  v_dot2_f32_bf16 v29, v102, v90, v29
  v_dot2_f32_bf16 v29, v103, v91, v29
  v_dot2_f32_bf16 v28, v136, s27, v28
  v_dot2_f32_bf16 v28, v137, s27, v28
  v_dot2_f32_bf16 v28, v138, s27, v28
  v_dot2_f32_bf16 v28, v139, s27, v28
  s_mov_b32 s26, 98304
  buffer_store_dwordx4 v[136:139], v21, s[40:43], s26 offen sc1
  s_waitcnt lgkmcnt(0)
  v_lshlrev_b32 v108, 16, v104
  v_and_b32 v109, 0xffff0000, v104
  v_lshlrev_b32 v110, 16, v105
  v_and_b32 v111, 0xffff0000, v105
  v_lshlrev_b32 v112, 16, v106
  v_and_b32 v113, 0xffff0000, v106
  v_lshlrev_b32 v114, 16, v107
  v_and_b32 v115, 0xffff0000, v107
  v_pk_mul_f32 v[108:109], v[108:109], v[80:81]
  v_pk_mul_f32 v[110:111], v[110:111], v[82:83]
  v_pk_mul_f32 v[112:113], v[112:113], v[84:85]
  v_pk_mul_f32 v[114:115], v[114:115], v[86:87]
  v_cvt_pk_bf16_f32 v140, v108, v109
  v_cvt_pk_bf16_f32 v141, v110, v111
  v_cvt_pk_bf16_f32 v142, v112, v113
  v_cvt_pk_bf16_f32 v143, v114, v115
  v_dot2_f32_bf16 v31, v104, v88, v31
  v_dot2_f32_bf16 v31, v105, v89, v31
  v_dot2_f32_bf16 v31, v106, v90, v31
  v_dot2_f32_bf16 v31, v107, v91, v31
  v_dot2_f32_bf16 v30, v140, s27, v30
  v_dot2_f32_bf16 v30, v141, s27, v30
  v_dot2_f32_bf16 v30, v142, s27, v30
  v_dot2_f32_bf16 v30, v143, s27, v30
  s_mov_b32 s26, 100352
  buffer_store_dwordx4 v[140:143], v21, s[40:43], s26 offen sc1
  ds_read_b128 v[32:35], v19 offset:1024
  ds_read_b128 v[36:39], v19 offset:1040
  ds_read_b128 v[40:43], v20 offset:3584
  ds_read_b64_tr_b16 v[44:45], v17 offset:32768
  ds_read_b64_tr_b16 v[46:47], v17 offset:33280
  ds_read_b64_tr_b16 v[48:49], v17 offset:32800
  ds_read_b64_tr_b16 v[50:51], v17 offset:33312
  ds_read_b64_tr_b16 v[52:53], v17 offset:32832
  ds_read_b64_tr_b16 v[54:55], v17 offset:33344
  ds_read_b64_tr_b16 v[56:57], v17 offset:32864
  ds_read_b64_tr_b16 v[58:59], v17 offset:33376
  s_waitcnt lgkmcnt(6)
  v_lshlrev_b32 v60, 16, v44
  v_and_b32 v61, 0xffff0000, v44
  v_lshlrev_b32 v62, 16, v45
  v_and_b32 v63, 0xffff0000, v45
  v_lshlrev_b32 v64, 16, v46
  v_and_b32 v65, 0xffff0000, v46
  v_lshlrev_b32 v66, 16, v47
  v_and_b32 v67, 0xffff0000, v47
  v_pk_mul_f32 v[60:61], v[60:61], v[32:33]
  v_pk_mul_f32 v[62:63], v[62:63], v[34:35]
  v_pk_mul_f32 v[64:65], v[64:65], v[36:37]
  v_pk_mul_f32 v[66:67], v[66:67], v[38:39]
  v_cvt_pk_bf16_f32 v128, v60, v61
  v_cvt_pk_bf16_f32 v129, v62, v63
  v_cvt_pk_bf16_f32 v130, v64, v65
  v_cvt_pk_bf16_f32 v131, v66, v67
  v_dot2_f32_bf16 v25, v44, v40, v25
  v_dot2_f32_bf16 v25, v45, v41, v25
  v_dot2_f32_bf16 v25, v46, v42, v25
  v_dot2_f32_bf16 v25, v47, v43, v25
  v_dot2_f32_bf16 v24, v128, s27, v24
  v_dot2_f32_bf16 v24, v129, s27, v24
  v_dot2_f32_bf16 v24, v130, s27, v24
  v_dot2_f32_bf16 v24, v131, s27, v24
  s_mov_b32 s26, 32768
  buffer_store_dwordx4 v[128:131], v21, s[40:43], s26 offen sc1
  s_waitcnt lgkmcnt(4)
  v_lshlrev_b32 v60, 16, v48
  v_and_b32 v61, 0xffff0000, v48
  v_lshlrev_b32 v62, 16, v49
  v_and_b32 v63, 0xffff0000, v49
  v_lshlrev_b32 v64, 16, v50
  v_and_b32 v65, 0xffff0000, v50
  v_lshlrev_b32 v66, 16, v51
  v_and_b32 v67, 0xffff0000, v51
  v_pk_mul_f32 v[60:61], v[60:61], v[32:33]
  v_pk_mul_f32 v[62:63], v[62:63], v[34:35]
  v_pk_mul_f32 v[64:65], v[64:65], v[36:37]
  v_pk_mul_f32 v[66:67], v[66:67], v[38:39]
  v_cvt_pk_bf16_f32 v132, v60, v61
  v_cvt_pk_bf16_f32 v133, v62, v63
  v_cvt_pk_bf16_f32 v134, v64, v65
  v_cvt_pk_bf16_f32 v135, v66, v67
  v_dot2_f32_bf16 v27, v48, v40, v27
  v_dot2_f32_bf16 v27, v49, v41, v27
  v_dot2_f32_bf16 v27, v50, v42, v27
  v_dot2_f32_bf16 v27, v51, v43, v27
  v_dot2_f32_bf16 v26, v132, s27, v26
  v_dot2_f32_bf16 v26, v133, s27, v26
  v_dot2_f32_bf16 v26, v134, s27, v26
  v_dot2_f32_bf16 v26, v135, s27, v26
  s_mov_b32 s26, 34816
  buffer_store_dwordx4 v[132:135], v21, s[40:43], s26 offen sc1
  s_waitcnt lgkmcnt(2)
  v_lshlrev_b32 v60, 16, v52
  v_and_b32 v61, 0xffff0000, v52
  v_lshlrev_b32 v62, 16, v53
  v_and_b32 v63, 0xffff0000, v53
  v_lshlrev_b32 v64, 16, v54
  v_and_b32 v65, 0xffff0000, v54
  v_lshlrev_b32 v66, 16, v55
  v_and_b32 v67, 0xffff0000, v55
  v_pk_mul_f32 v[60:61], v[60:61], v[32:33]
  v_pk_mul_f32 v[62:63], v[62:63], v[34:35]
  v_pk_mul_f32 v[64:65], v[64:65], v[36:37]
  v_pk_mul_f32 v[66:67], v[66:67], v[38:39]
  v_cvt_pk_bf16_f32 v136, v60, v61
  v_cvt_pk_bf16_f32 v137, v62, v63
  v_cvt_pk_bf16_f32 v138, v64, v65
  v_cvt_pk_bf16_f32 v139, v66, v67
  v_dot2_f32_bf16 v29, v52, v40, v29
  v_dot2_f32_bf16 v29, v53, v41, v29
  v_dot2_f32_bf16 v29, v54, v42, v29
  v_dot2_f32_bf16 v29, v55, v43, v29
  v_dot2_f32_bf16 v28, v136, s27, v28
  v_dot2_f32_bf16 v28, v137, s27, v28
  v_dot2_f32_bf16 v28, v138, s27, v28
  v_dot2_f32_bf16 v28, v139, s27, v28
  s_mov_b32 s26, 114688
  buffer_store_dwordx4 v[136:139], v21, s[40:43], s26 offen sc1
  s_waitcnt lgkmcnt(0)
  v_lshlrev_b32 v60, 16, v56
  v_and_b32 v61, 0xffff0000, v56
  v_lshlrev_b32 v62, 16, v57
  v_and_b32 v63, 0xffff0000, v57
  v_lshlrev_b32 v64, 16, v58
  v_and_b32 v65, 0xffff0000, v58
  v_lshlrev_b32 v66, 16, v59
  v_and_b32 v67, 0xffff0000, v59
  v_pk_mul_f32 v[60:61], v[60:61], v[32:33]
  v_pk_mul_f32 v[62:63], v[62:63], v[34:35]
  v_pk_mul_f32 v[64:65], v[64:65], v[36:37]
  v_pk_mul_f32 v[66:67], v[66:67], v[38:39]
  v_cvt_pk_bf16_f32 v140, v60, v61
  v_cvt_pk_bf16_f32 v141, v62, v63
  v_cvt_pk_bf16_f32 v142, v64, v65
  v_cvt_pk_bf16_f32 v143, v66, v67
  v_dot2_f32_bf16 v31, v56, v40, v31
  v_dot2_f32_bf16 v31, v57, v41, v31
  v_dot2_f32_bf16 v31, v58, v42, v31
  v_dot2_f32_bf16 v31, v59, v43, v31
  v_dot2_f32_bf16 v30, v140, s27, v30
  v_dot2_f32_bf16 v30, v141, s27, v30
  v_dot2_f32_bf16 v30, v142, s27, v30
  v_dot2_f32_bf16 v30, v143, s27, v30
  s_mov_b32 s26, 116736
  buffer_store_dwordx4 v[140:143], v21, s[40:43], s26 offen sc1
  ds_read_b128 v[80:83], v19 offset:1536
  ds_read_b128 v[84:87], v19 offset:1552
  ds_read_b128 v[88:91], v20 offset:3840
  ds_read_b64_tr_b16 v[92:93], v18 offset:0
  ds_read_b64_tr_b16 v[94:95], v18 offset:512
  ds_read_b64_tr_b16 v[96:97], v18 offset:32
  ds_read_b64_tr_b16 v[98:99], v18 offset:544
  ds_read_b64_tr_b16 v[100:101], v18 offset:64
  ds_read_b64_tr_b16 v[102:103], v18 offset:576
  ds_read_b64_tr_b16 v[104:105], v18 offset:96
  ds_read_b64_tr_b16 v[106:107], v18 offset:608
  s_waitcnt lgkmcnt(6)
  v_lshlrev_b32 v108, 16, v92
  v_and_b32 v109, 0xffff0000, v92
  v_lshlrev_b32 v110, 16, v93
  v_and_b32 v111, 0xffff0000, v93
  v_lshlrev_b32 v112, 16, v94
  v_and_b32 v113, 0xffff0000, v94
  v_lshlrev_b32 v114, 16, v95
  v_and_b32 v115, 0xffff0000, v95
  v_pk_mul_f32 v[108:109], v[108:109], v[80:81]
  v_pk_mul_f32 v[110:111], v[110:111], v[82:83]
  v_pk_mul_f32 v[112:113], v[112:113], v[84:85]
  v_pk_mul_f32 v[114:115], v[114:115], v[86:87]
  v_cvt_pk_bf16_f32 v128, v108, v109
  v_cvt_pk_bf16_f32 v129, v110, v111
  v_cvt_pk_bf16_f32 v130, v112, v113
  v_cvt_pk_bf16_f32 v131, v114, v115
  v_dot2_f32_bf16 v25, v92, v88, v25
  v_dot2_f32_bf16 v25, v93, v89, v25
  v_dot2_f32_bf16 v25, v94, v90, v25
  v_dot2_f32_bf16 v25, v95, v91, v25
  v_dot2_f32_bf16 v24, v128, s27, v24
  v_dot2_f32_bf16 v24, v129, s27, v24
  v_dot2_f32_bf16 v24, v130, s27, v24
  v_dot2_f32_bf16 v24, v131, s27, v24
  s_mov_b32 s26, 49152
  buffer_store_dwordx4 v[128:131], v21, s[40:43], s26 offen sc1
  s_waitcnt lgkmcnt(4)
  v_lshlrev_b32 v108, 16, v96
  v_and_b32 v109, 0xffff0000, v96
  v_lshlrev_b32 v110, 16, v97
  v_and_b32 v111, 0xffff0000, v97
  v_lshlrev_b32 v112, 16, v98
  v_and_b32 v113, 0xffff0000, v98
  v_lshlrev_b32 v114, 16, v99
  v_and_b32 v115, 0xffff0000, v99
  v_pk_mul_f32 v[108:109], v[108:109], v[80:81]
  v_pk_mul_f32 v[110:111], v[110:111], v[82:83]
  v_pk_mul_f32 v[112:113], v[112:113], v[84:85]
  v_pk_mul_f32 v[114:115], v[114:115], v[86:87]
  v_cvt_pk_bf16_f32 v132, v108, v109
  v_cvt_pk_bf16_f32 v133, v110, v111
  v_cvt_pk_bf16_f32 v134, v112, v113
  v_cvt_pk_bf16_f32 v135, v114, v115
  v_dot2_f32_bf16 v27, v96, v88, v27
  v_dot2_f32_bf16 v27, v97, v89, v27
  v_dot2_f32_bf16 v27, v98, v90, v27
  v_dot2_f32_bf16 v27, v99, v91, v27
  v_dot2_f32_bf16 v26, v132, s27, v26
  v_dot2_f32_bf16 v26, v133, s27, v26
  v_dot2_f32_bf16 v26, v134, s27, v26
  v_dot2_f32_bf16 v26, v135, s27, v26
  s_mov_b32 s26, 51200
  buffer_store_dwordx4 v[132:135], v21, s[40:43], s26 offen sc1
  s_waitcnt lgkmcnt(2)
  v_lshlrev_b32 v108, 16, v100
  v_and_b32 v109, 0xffff0000, v100
  v_lshlrev_b32 v110, 16, v101
  v_and_b32 v111, 0xffff0000, v101
  v_lshlrev_b32 v112, 16, v102
  v_and_b32 v113, 0xffff0000, v102
  v_lshlrev_b32 v114, 16, v103
  v_and_b32 v115, 0xffff0000, v103
  v_pk_mul_f32 v[108:109], v[108:109], v[80:81]
  v_pk_mul_f32 v[110:111], v[110:111], v[82:83]
  v_pk_mul_f32 v[112:113], v[112:113], v[84:85]
  v_pk_mul_f32 v[114:115], v[114:115], v[86:87]
  v_cvt_pk_bf16_f32 v136, v108, v109
  v_cvt_pk_bf16_f32 v137, v110, v111
  v_cvt_pk_bf16_f32 v138, v112, v113
  v_cvt_pk_bf16_f32 v139, v114, v115
  v_dot2_f32_bf16 v29, v100, v88, v29
  v_dot2_f32_bf16 v29, v101, v89, v29
  v_dot2_f32_bf16 v29, v102, v90, v29
  v_dot2_f32_bf16 v29, v103, v91, v29
  v_dot2_f32_bf16 v28, v136, s27, v28
  v_dot2_f32_bf16 v28, v137, s27, v28
  v_dot2_f32_bf16 v28, v138, s27, v28
  v_dot2_f32_bf16 v28, v139, s27, v28
  s_mov_b32 s26, 131072
  buffer_store_dwordx4 v[136:139], v21, s[40:43], s26 offen sc1
  s_waitcnt lgkmcnt(0)
  v_lshlrev_b32 v108, 16, v104
  v_and_b32 v109, 0xffff0000, v104
  v_lshlrev_b32 v110, 16, v105
  v_and_b32 v111, 0xffff0000, v105
  v_lshlrev_b32 v112, 16, v106
  v_and_b32 v113, 0xffff0000, v106
  v_lshlrev_b32 v114, 16, v107
  v_and_b32 v115, 0xffff0000, v107
  v_pk_mul_f32 v[108:109], v[108:109], v[80:81]
  v_pk_mul_f32 v[110:111], v[110:111], v[82:83]
  v_pk_mul_f32 v[112:113], v[112:113], v[84:85]
  v_pk_mul_f32 v[114:115], v[114:115], v[86:87]
  v_cvt_pk_bf16_f32 v140, v108, v109
  v_cvt_pk_bf16_f32 v141, v110, v111
  v_cvt_pk_bf16_f32 v142, v112, v113
  v_cvt_pk_bf16_f32 v143, v114, v115
  v_dot2_f32_bf16 v31, v104, v88, v31
  v_dot2_f32_bf16 v31, v105, v89, v31
  v_dot2_f32_bf16 v31, v106, v90, v31
  v_dot2_f32_bf16 v31, v107, v91, v31
  v_dot2_f32_bf16 v30, v140, s27, v30
  v_dot2_f32_bf16 v30, v141, s27, v30
  v_dot2_f32_bf16 v30, v142, s27, v30
  v_dot2_f32_bf16 v30, v143, s27, v30
  s_mov_b32 s26, 133120
  buffer_store_dwordx4 v[140:143], v21, s[40:43], s26 offen sc1
  ds_read_b128 v[32:35], v19 offset:2048
  ds_read_b128 v[36:39], v19 offset:2064
  ds_read_b128 v[40:43], v20 offset:4096
  ds_read_b64_tr_b16 v[44:45], v18 offset:16384
  ds_read_b64_tr_b16 v[46:47], v18 offset:16896
  ds_read_b64_tr_b16 v[48:49], v18 offset:16416
  ds_read_b64_tr_b16 v[50:51], v18 offset:16928
  ds_read_b64_tr_b16 v[52:53], v18 offset:16448
  ds_read_b64_tr_b16 v[54:55], v18 offset:16960
  ds_read_b64_tr_b16 v[56:57], v18 offset:16480
  ds_read_b64_tr_b16 v[58:59], v18 offset:16992
  s_waitcnt lgkmcnt(6)
  v_lshlrev_b32 v60, 16, v44
  v_and_b32 v61, 0xffff0000, v44
  v_lshlrev_b32 v62, 16, v45
  v_and_b32 v63, 0xffff0000, v45
  v_lshlrev_b32 v64, 16, v46
  v_and_b32 v65, 0xffff0000, v46
  v_lshlrev_b32 v66, 16, v47
  v_and_b32 v67, 0xffff0000, v47
  v_pk_mul_f32 v[60:61], v[60:61], v[32:33]
  v_pk_mul_f32 v[62:63], v[62:63], v[34:35]
  v_pk_mul_f32 v[64:65], v[64:65], v[36:37]
  v_pk_mul_f32 v[66:67], v[66:67], v[38:39]
  v_cvt_pk_bf16_f32 v128, v60, v61
  v_cvt_pk_bf16_f32 v129, v62, v63
  v_cvt_pk_bf16_f32 v130, v64, v65
  v_cvt_pk_bf16_f32 v131, v66, v67
  v_dot2_f32_bf16 v25, v44, v40, v25
  v_dot2_f32_bf16 v25, v45, v41, v25
  v_dot2_f32_bf16 v25, v46, v42, v25
  v_dot2_f32_bf16 v25, v47, v43, v25
  v_dot2_f32_bf16 v24, v128, s27, v24
  v_dot2_f32_bf16 v24, v129, s27, v24
  v_dot2_f32_bf16 v24, v130, s27, v24
  v_dot2_f32_bf16 v24, v131, s27, v24
  s_mov_b32 s26, 65536
  buffer_store_dwordx4 v[128:131], v21, s[40:43], s26 offen sc1
  s_waitcnt lgkmcnt(4)
  v_lshlrev_b32 v60, 16, v48
  v_and_b32 v61, 0xffff0000, v48
  v_lshlrev_b32 v62, 16, v49
  v_and_b32 v63, 0xffff0000, v49
  v_lshlrev_b32 v64, 16, v50
  v_and_b32 v65, 0xffff0000, v50
  v_lshlrev_b32 v66, 16, v51
  v_and_b32 v67, 0xffff0000, v51
  v_pk_mul_f32 v[60:61], v[60:61], v[32:33]
  v_pk_mul_f32 v[62:63], v[62:63], v[34:35]
  v_pk_mul_f32 v[64:65], v[64:65], v[36:37]
  v_pk_mul_f32 v[66:67], v[66:67], v[38:39]
  v_cvt_pk_bf16_f32 v132, v60, v61
  v_cvt_pk_bf16_f32 v133, v62, v63
  v_cvt_pk_bf16_f32 v134, v64, v65
  v_cvt_pk_bf16_f32 v135, v66, v67
  v_dot2_f32_bf16 v27, v48, v40, v27
  v_dot2_f32_bf16 v27, v49, v41, v27
  v_dot2_f32_bf16 v27, v50, v42, v27
  v_dot2_f32_bf16 v27, v51, v43, v27
  v_dot2_f32_bf16 v26, v132, s27, v26
  v_dot2_f32_bf16 v26, v133, s27, v26
  v_dot2_f32_bf16 v26, v134, s27, v26
  v_dot2_f32_bf16 v26, v135, s27, v26
  s_mov_b32 s26, 67584
  buffer_store_dwordx4 v[132:135], v21, s[40:43], s26 offen sc1
  s_waitcnt lgkmcnt(2)
  v_lshlrev_b32 v60, 16, v52
  v_and_b32 v61, 0xffff0000, v52
  v_lshlrev_b32 v62, 16, v53
  v_and_b32 v63, 0xffff0000, v53
  v_lshlrev_b32 v64, 16, v54
  v_and_b32 v65, 0xffff0000, v54
  v_lshlrev_b32 v66, 16, v55
  v_and_b32 v67, 0xffff0000, v55
  v_pk_mul_f32 v[60:61], v[60:61], v[32:33]
  v_pk_mul_f32 v[62:63], v[62:63], v[34:35]
  v_pk_mul_f32 v[64:65], v[64:65], v[36:37]
  v_pk_mul_f32 v[66:67], v[66:67], v[38:39]
  v_cvt_pk_bf16_f32 v136, v60, v61
  v_cvt_pk_bf16_f32 v137, v62, v63
  v_cvt_pk_bf16_f32 v138, v64, v65
  v_cvt_pk_bf16_f32 v139, v66, v67
  v_dot2_f32_bf16 v29, v52, v40, v29
  v_dot2_f32_bf16 v29, v53, v41, v29
  v_dot2_f32_bf16 v29, v54, v42, v29
  v_dot2_f32_bf16 v29, v55, v43, v29
  v_dot2_f32_bf16 v28, v136, s27, v28
  v_dot2_f32_bf16 v28, v137, s27, v28
  v_dot2_f32_bf16 v28, v138, s27, v28
  v_dot2_f32_bf16 v28, v139, s27, v28
  s_mov_b32 s26, 147456
  buffer_store_dwordx4 v[136:139], v21, s[40:43], s26 offen sc1
  s_waitcnt lgkmcnt(0)
  v_lshlrev_b32 v60, 16, v56
  v_and_b32 v61, 0xffff0000, v56
  v_lshlrev_b32 v62, 16, v57
  v_and_b32 v63, 0xffff0000, v57
  v_lshlrev_b32 v64, 16, v58
  v_and_b32 v65, 0xffff0000, v58
  v_lshlrev_b32 v66, 16, v59
  v_and_b32 v67, 0xffff0000, v59
  v_pk_mul_f32 v[60:61], v[60:61], v[32:33]
  v_pk_mul_f32 v[62:63], v[62:63], v[34:35]
  v_pk_mul_f32 v[64:65], v[64:65], v[36:37]
  v_pk_mul_f32 v[66:67], v[66:67], v[38:39]
  v_cvt_pk_bf16_f32 v140, v60, v61
  v_cvt_pk_bf16_f32 v141, v62, v63
  v_cvt_pk_bf16_f32 v142, v64, v65
  v_cvt_pk_bf16_f32 v143, v66, v67
  v_dot2_f32_bf16 v31, v56, v40, v31
  v_dot2_f32_bf16 v31, v57, v41, v31
  v_dot2_f32_bf16 v31, v58, v42, v31
  v_dot2_f32_bf16 v31, v59, v43, v31
  v_dot2_f32_bf16 v30, v140, s27, v30
  v_dot2_f32_bf16 v30, v141, s27, v30
  v_dot2_f32_bf16 v30, v142, s27, v30
  v_dot2_f32_bf16 v30, v143, s27, v30
  s_mov_b32 s26, 149504
  buffer_store_dwordx4 v[140:143], v21, s[40:43], s26 offen sc1
  v_lshlrev_b32 v5, 2, v1
  s_lshl_b32 s25, s19, 11
  v_add_u32 v5, s25, v5
  ds_write_b32 v5, v24 offset:4608
  ds_write_b32 v5, v25 offset:4864
  ds_write_b32 v5, v26 offset:5120
  ds_write_b32 v5, v27 offset:5376
  ds_write_b32 v5, v28 offset:5632
  ds_write_b32 v5, v29 offset:5888
  ds_write_b32 v5, v30 offset:6144
  ds_write_b32 v5, v31 offset:6400
  s_waitcnt lgkmcnt(0)
  s_barrier
  v_cmp_gt_u32 vcc, 128, v0
  s_nop 2
  s_and_saveexec_b64 s[50:51], vcc
  s_cbranch_execz k2_kernel_end
  v_bfe_u32 v6, v0, 4, 2
  v_lshlrev_b32 v6, 9, v6
  v_lshrrev_b32 v7, 6, v0
  v_lshl_add_u32 v6, v7, 8, v6
  v_and_b32 v8, 15, v0
  v_lshl_add_u32 v6, v8, 2, v6
  ds_read_b32 v32, v6 offset:4608
  ds_read_b32 v33, v6 offset:4672
  ds_read_b32 v34, v6 offset:4736
  ds_read_b32 v35, v6 offset:4800
  ds_read_b32 v36, v6 offset:6656
  ds_read_b32 v37, v6 offset:6720
  ds_read_b32 v38, v6 offset:6784
  ds_read_b32 v39, v6 offset:6848
  ds_read_b32 v40, v6 offset:8704
  ds_read_b32 v41, v6 offset:8768
  ds_read_b32 v42, v6 offset:8832
  ds_read_b32 v43, v6 offset:8896
  ds_read_b32 v44, v6 offset:10752
  ds_read_b32 v45, v6 offset:10816
  ds_read_b32 v46, v6 offset:10880
  ds_read_b32 v47, v6 offset:10944
  s_waitcnt lgkmcnt(0)
  v_add_f32 v32, v32, v40
  v_add_f32 v33, v33, v41
  v_add_f32 v34, v34, v42
  v_add_f32 v35, v35, v43
  v_add_f32 v36, v36, v44
  v_add_f32 v37, v37, v45
  v_add_f32 v38, v38, v46
  v_add_f32 v39, v39, v47
  v_add_f32 v32, v32, v36
  v_add_f32 v33, v33, v37
  v_add_f32 v34, v34, v38
  v_add_f32 v35, v35, v39
  v_add_f32 v32, v32, v34
  v_add_f32 v33, v33, v35
  v_add_f32 v32, v32, v33
  v_mul_u32_u24 v9, 13824, v7
  v_and_b32 v10, 63, v0
  v_lshl_add_u32 v9, v10, 2, v9
  s_mul_i32 s25, s21, 6912
  s_lshl_b32 s26, s22, 8
  s_add_u32 s25, s25, s26
  buffer_store_dword v32, v9, s[44:47], s25 offen sc1
  s_branch k2_kernel_end
k2_kernel_wd:
  s_sub_u32 s20, s2, 214
  s_load_dwordx2 s[6:7], s[0:1], 80
  s_mul_hi_u32 s22, s20, 429496730
  s_mul_i32 s23, s22, 10
  s_sub_u32 s21, s20, s23
  v_and_b32 v1, 63, v0
  v_lshrrev_b32 v2, 3, v1
  v_and_b32 v3, 7, v1
  v_mul_u32_u24 v4, 1280, v2
  v_lshl_add_u32 v4, v3, 4, v4
  s_lshl_b32 s23, s21, 7
  s_mul_i32 s24, s22, 737280
  s_add_u32 s23, s23, s24
  s_mul_i32 s24, s19, 10240
  s_add_u32 s23, s23, s24
  v_add_u32 v4, s23, v4
  s_waitcnt lgkmcnt(0)
  s_mov_b32 s8, s6
  s_mov_b32 s9, s7
  s_mov_b32 s10, 2211840
  s_mov_b32 s11, 0x20000
  s_lshl_b32 s25, s19, 10
  s_add_u32 m0, s25, 0
  s_mov_b32 s26, 0
  buffer_load_dwordx4 v4, s[8:11], s26 offen nt lds
  s_add_u32 m0, s25, 4096
  s_mov_b32 s26, 40960
  buffer_load_dwordx4 v4, s[8:11], s26 offen nt lds
  s_add_u32 m0, s25, 8192
  s_mov_b32 s26, 81920
  buffer_load_dwordx4 v4, s[8:11], s26 offen nt lds
  s_add_u32 m0, s25, 12288
  s_mov_b32 s26, 122880
  buffer_load_dwordx4 v4, s[8:11], s26 offen nt lds
  s_add_u32 m0, s25, 16384
  s_mov_b32 s26, 163840
  buffer_load_dwordx4 v4, s[8:11], s26 offen nt lds
  s_add_u32 m0, s25, 20480
  s_mov_b32 s26, 204800
  buffer_load_dwordx4 v4, s[8:11], s26 offen nt lds
  s_add_u32 m0, s25, 24576
  s_mov_b32 s26, 245760
  buffer_load_dwordx4 v4, s[8:11], s26 offen nt lds
  s_add_u32 m0, s25, 28672
  s_mov_b32 s26, 286720
  buffer_load_dwordx4 v4, s[8:11], s26 offen nt lds
  s_add_u32 m0, s25, 32768
  s_mov_b32 s26, 327680
  buffer_load_dwordx4 v4, s[8:11], s26 offen nt lds
  s_add_u32 m0, s25, 36864
  s_mov_b32 s26, 368640
  buffer_load_dwordx4 v4, s[8:11], s26 offen nt lds
  s_add_u32 m0, s25, 40960
  s_mov_b32 s26, 409600
  buffer_load_dwordx4 v4, s[8:11], s26 offen nt lds
  s_add_u32 m0, s25, 45056
  s_mov_b32 s26, 450560
  buffer_load_dwordx4 v4, s[8:11], s26 offen nt lds
  s_add_u32 m0, s25, 49152
  s_mov_b32 s26, 491520
  buffer_load_dwordx4 v4, s[8:11], s26 offen nt lds
  s_add_u32 m0, s25, 53248
  s_mov_b32 s26, 532480
  buffer_load_dwordx4 v4, s[8:11], s26 offen nt lds
  s_add_u32 m0, s25, 57344
  s_mov_b32 s26, 573440
  buffer_load_dwordx4 v4, s[8:11], s26 offen nt lds
  s_add_u32 m0, s25, 61440
  s_mov_b32 s26, 614400
  buffer_load_dwordx4 v4, s[8:11], s26 offen nt lds
  s_add_u32 m0, s25, 65536
  s_mov_b32 s26, 655360
  buffer_load_dwordx4 v4, s[8:11], s26 offen nt lds
  s_add_u32 m0, s25, 69632
  s_mov_b32 s26, 696320
  buffer_load_dwordx4 v4, s[8:11], s26 offen nt lds
  s_add_u32 s40, s4, 18874368
  s_addc_u32 s41, s5, 0
  s_mov_b32 s42, 2211840
  s_mov_b32 s43, 0x20000
  s_add_u32 s44, s4, 163840
  s_addc_u32 s45, s5, 0
  s_mov_b32 s46, 2048
  s_mov_b32 s47, 0x20000
  s_add_u32 s26, s20, s19
  s_cmp_lg_u32 s26, 0
  s_cbranch_scc1 L_k2_kernel_noz_2
  v_mov_b32 v24, 0
  v_mov_b32 v25, 0
  v_mov_b32 v26, 0
  v_mov_b32 v27, 0
  v_lshlrev_b32 v28, 4, v1
  buffer_store_dwordx4 v[24:27], v28, s[44:47], 0 offen sc1
  buffer_store_dwordx4 v[24:27], v28, s[44:47], 0 offen offset:1024 sc1
L_k2_kernel_noz_2:
  v_lshrrev_b32 v13, 4, v1
  v_lshlrev_b32 v14, 2, v13
  v_and_b32 v16, 15, v1
  v_lshrrev_b32 v16, 2, v16
  v_add_u32 v14, v14, v16
  v_lshlrev_b32 v14, 7, v14
  v_and_b32 v16, 3, v1
  v_lshl_add_u32 v14, v16, 3, v14
  s_lshl_b32 s25, s19, 5
  v_add_u32 v17, s25, v14
  v_add_u32 v18, 36864, v17
  v_lshlrev_b32 v21, 4, v1
  s_lshl_b32 s25, s21, 2
  s_add_u32 s25, s25, s19
  s_mul_i32 s25, s25, 55296
  s_mul_i32 s26, s22, 18432
  s_add_u32 s25, s25, s26
  s_waitcnt vmcnt(0)
  s_barrier
  ds_read_b64_tr_b16 v[32:33], v17 offset:0
  ds_read_b64_tr_b16 v[34:35], v17 offset:2048
  ds_read_b64_tr_b16 v[36:37], v17 offset:4096
  ds_read_b64_tr_b16 v[38:39], v17 offset:6144
  ds_read_b64_tr_b16 v[40:41], v17 offset:8192
  ds_read_b64_tr_b16 v[42:43], v17 offset:10240
  ds_read_b64_tr_b16 v[44:45], v17 offset:12288
  ds_read_b64_tr_b16 v[46:47], v17 offset:14336
  ds_read_b64_tr_b16 v[48:49], v17 offset:16384
  ds_read_b64_tr_b16 v[50:51], v17 offset:18432
  ds_read_b64_tr_b16 v[52:53], v17 offset:20480
  ds_read_b64_tr_b16 v[54:55], v17 offset:22528
  s_waitcnt lgkmcnt(10)
  s_add_u32 s26, s25, 0
  buffer_store_dwordx4 v[32:35], v21, s[40:43], s26 offen sc1
  s_waitcnt lgkmcnt(8)
  s_add_u32 s26, s25, 1024
  buffer_store_dwordx4 v[36:39], v21, s[40:43], s26 offen sc1
  s_waitcnt lgkmcnt(6)
  s_add_u32 s26, s25, 2048
  buffer_store_dwordx4 v[40:43], v21, s[40:43], s26 offen sc1
  s_waitcnt lgkmcnt(4)
  s_add_u32 s26, s25, 3072
  buffer_store_dwordx4 v[44:47], v21, s[40:43], s26 offen sc1
  s_waitcnt lgkmcnt(2)
  s_add_u32 s26, s25, 4096
  buffer_store_dwordx4 v[48:51], v21, s[40:43], s26 offen sc1
  s_waitcnt lgkmcnt(0)
  s_add_u32 s26, s25, 5120
  buffer_store_dwordx4 v[52:55], v21, s[40:43], s26 offen sc1
  ds_read_b64_tr_b16 v[32:33], v17 offset:24576
  ds_read_b64_tr_b16 v[34:35], v17 offset:26624
  ds_read_b64_tr_b16 v[36:37], v17 offset:28672
  ds_read_b64_tr_b16 v[38:39], v17 offset:30720
  ds_read_b64_tr_b16 v[40:41], v17 offset:32768
  ds_read_b64_tr_b16 v[42:43], v17 offset:34816
  ds_read_b64_tr_b16 v[44:45], v18 offset:0
  ds_read_b64_tr_b16 v[46:47], v18 offset:2048
  ds_read_b64_tr_b16 v[48:49], v18 offset:4096
  ds_read_b64_tr_b16 v[50:51], v18 offset:6144
  ds_read_b64_tr_b16 v[52:53], v18 offset:8192
  ds_read_b64_tr_b16 v[54:55], v18 offset:10240
  s_waitcnt lgkmcnt(10)
  s_add_u32 s26, s25, 6144
  buffer_store_dwordx4 v[32:35], v21, s[40:43], s26 offen sc1
  s_waitcnt lgkmcnt(8)
  s_add_u32 s26, s25, 7168
  buffer_store_dwordx4 v[36:39], v21, s[40:43], s26 offen sc1
  s_waitcnt lgkmcnt(6)
  s_add_u32 s26, s25, 8192
  buffer_store_dwordx4 v[40:43], v21, s[40:43], s26 offen sc1
  s_waitcnt lgkmcnt(4)
  s_add_u32 s26, s25, 9216
  buffer_store_dwordx4 v[44:47], v21, s[40:43], s26 offen sc1
  s_waitcnt lgkmcnt(2)
  s_add_u32 s26, s25, 10240
  buffer_store_dwordx4 v[48:51], v21, s[40:43], s26 offen sc1
  s_waitcnt lgkmcnt(0)
  s_add_u32 s26, s25, 11264
  buffer_store_dwordx4 v[52:55], v21, s[40:43], s26 offen sc1
  ds_read_b64_tr_b16 v[32:33], v18 offset:12288
  ds_read_b64_tr_b16 v[34:35], v18 offset:14336
  ds_read_b64_tr_b16 v[36:37], v18 offset:16384
  ds_read_b64_tr_b16 v[38:39], v18 offset:18432
  ds_read_b64_tr_b16 v[40:41], v18 offset:20480
  ds_read_b64_tr_b16 v[42:43], v18 offset:22528
  ds_read_b64_tr_b16 v[44:45], v18 offset:24576
  ds_read_b64_tr_b16 v[46:47], v18 offset:26624
  ds_read_b64_tr_b16 v[48:49], v18 offset:28672
  ds_read_b64_tr_b16 v[50:51], v18 offset:30720
  ds_read_b64_tr_b16 v[52:53], v18 offset:32768
  ds_read_b64_tr_b16 v[54:55], v18 offset:34816
  s_waitcnt lgkmcnt(10)
  s_add_u32 s26, s25, 12288
  buffer_store_dwordx4 v[32:35], v21, s[40:43], s26 offen sc1
  s_waitcnt lgkmcnt(8)
  s_add_u32 s26, s25, 13312
  buffer_store_dwordx4 v[36:39], v21, s[40:43], s26 offen sc1
  s_waitcnt lgkmcnt(6)
  s_add_u32 s26, s25, 14336
  buffer_store_dwordx4 v[40:43], v21, s[40:43], s26 offen sc1
  s_waitcnt lgkmcnt(4)
  s_add_u32 s26, s25, 15360
  buffer_store_dwordx4 v[44:47], v21, s[40:43], s26 offen sc1
  s_waitcnt lgkmcnt(2)
  s_add_u32 s26, s25, 16384
  buffer_store_dwordx4 v[48:51], v21, s[40:43], s26 offen sc1
  s_waitcnt lgkmcnt(0)
  s_add_u32 s26, s25, 17408
  buffer_store_dwordx4 v[52:55], v21, s[40:43], s26 offen sc1
  s_branch k2_kernel_end
k2_kernel_end:
k2_kernel_exit:
  s_endpgm
.globl k3_kernel
.p2align 8
.type k3_kernel,@function
k3_kernel:
  s_cmp_ge_u32 s2, 256
  s_cbranch_scc1 k3_kernel_exit
  s_load_dwordx2 s[4:5], s[0:1], 120
  s_load_dwordx4 s[36:39], s[0:1], 104
  v_lshrrev_b32 v1, 6, v0
  s_and_b32 s20, s2, 7
  v_readfirstlane_b32 s19, v1
  s_cmp_lt_u32 s2, 32
  s_cbranch_scc1 k3_kernel_stats
  s_sub_u32 s21, s2, 32
  s_lshr_b32 s21, s21, 3
  s_and_b32 s22, s20, 3
  s_lshl_b32 s22, s22, 2
  s_and_b32 s23, s21, 3
  s_add_u32 s22, s22, s23
  s_lshr_b32 s23, s20, 2
  s_mul_i32 s23, s23, 7
  s_lshr_b32 s24, s21, 2
  s_add_u32 s23, s23, s24
  s_lshl_b32 s23, s23, 2
  s_add_u32 s23, s23, s19
  v_and_b32 v1, 63, v0
  v_lshlrev_b32 v2, 4, v1
  s_lshl_b32 s24, s22, 10
  s_mul_i32 s25, s19, 33280
  s_add_u32 s24, s24, s25
  v_add_u32 v3, s24, v2
  s_mul_i32 s27, s19, 2176
  s_mul_i32 s25, s23, 81920
  s_cmp_lt_u32 s23, 54
  s_cselect_b32 s25, s25, 2146435072
  v_add_u32 v4, s25, v2
  s_waitcnt lgkmcnt(0)
  s_add_u32 s8, s4, 10485760
  s_addc_u32 s9, s5, 0
  s_mov_b32 s10, 2662400
  s_mov_b32 s11, 0x20000
  s_add_u32 s12, s4, 13631488
  s_addc_u32 s13, s5, 0
  s_mov_b32 s14, 4423680
  s_mov_b32 s15, 0x20000
  s_add_u32 m0, s27, 0
  s_mov_b32 s28, 0
  buffer_load_dwordx4 v3, s[8:11], s28 offen lds
  s_add_u32 m0, s27, 1088
  s_mov_b32 s28, 16640
  buffer_load_dwordx4 v3, s[8:11], s28 offen lds
  s_add_u32 m0, s27, 8704
  s_mov_b32 s28, 133120
  buffer_load_dwordx4 v3, s[8:11], s28 offen lds
  s_add_u32 m0, s27, 9792
  s_mov_b32 s28, 149760
  buffer_load_dwordx4 v3, s[8:11], s28 offen lds
  s_add_u32 m0, s27, 17408
  s_mov_b32 s28, 266240
  buffer_load_dwordx4 v3, s[8:11], s28 offen lds
  s_add_u32 m0, s27, 18496
  s_mov_b32 s28, 282880
  buffer_load_dwordx4 v3, s[8:11], s28 offen lds
  s_add_u32 m0, s27, 26112
  s_mov_b32 s28, 399360
  buffer_load_dwordx4 v3, s[8:11], s28 offen lds
  s_add_u32 m0, s27, 27200
  s_mov_b32 s28, 416000
  buffer_load_dwordx4 v3, s[8:11], s28 offen lds
  s_mov_b32 s29, 0
  buffer_load_dwordx4 a[0:3], v4, s[12:15], s29 offen offset:0
  buffer_load_dwordx4 a[4:7], v4, s[12:15], s29 offen offset:1024
  buffer_load_dwordx4 a[8:11], v4, s[12:15], s29 offen offset:2048
  buffer_load_dwordx4 a[12:15], v4, s[12:15], s29 offen offset:3072
  v_and_b32 v5, 15, v1
  v_lshrrev_b32 v6, 4, v1
  v_mul_u32_u24 v7, 2176, v6
  v_lshl_add_u32 v40, v5, 3, v7
  s_lshl_b32 s24, s19, 1
  s_add_u32 s25, s24, 0
  s_and_b32 s25, s25, 7
  s_lshl_b32 s25, s25, 7
  v_add_u32 v8, s25, v40
  s_add_u32 s25, s24, 1
  s_and_b32 s25, s25, 7
  s_lshl_b32 s25, s25, 7
  v_add_u32 v9, s25, v40
  s_add_u32 s25, s24, 2
  s_and_b32 s25, s25, 7
  s_lshl_b32 s25, s25, 7
  v_add_u32 v10, s25, v40
  s_add_u32 s25, s24, 3
  s_and_b32 s25, s25, 7
  s_lshl_b32 s25, s25, 7
  v_add_u32 v11, s25, v40
  s_add_u32 s25, s24, 4
  s_and_b32 s25, s25, 7
  s_lshl_b32 s25, s25, 7
  v_add_u32 v12, s25, v40
  s_add_u32 s25, s24, 5
  s_and_b32 s25, s25, 7
  s_lshl_b32 s25, s25, 7
  v_add_u32 v13, s25, v40
  s_add_u32 s25, s24, 6
  s_and_b32 s25, s25, 7
  s_lshl_b32 s25, s25, 7
  v_add_u32 v14, s25, v40
  s_add_u32 s25, s24, 7
  s_and_b32 s25, s25, 7
  s_lshl_b32 s25, s25, 7
  v_add_u32 v15, s25, v40
  s_mov_b32 s29, 4096
  buffer_load_dwordx4 a[16:19], v4, s[12:15], s29 offen offset:0
  buffer_load_dwordx4 a[20:23], v4, s[12:15], s29 offen offset:1024
  buffer_load_dwordx4 a[24:27], v4, s[12:15], s29 offen offset:2048
  buffer_load_dwordx4 a[28:31], v4, s[12:15], s29 offen offset:3072
  v_add_u32 v32, 69632, v8
  v_add_u32 v33, 69632, v9
  v_add_u32 v34, 69632, v10
  v_add_u32 v35, 69632, v11
  v_add_u32 v36, 69632, v12
  v_add_u32 v37, 69632, v13
  v_add_u32 v38, 69632, v14
  v_add_u32 v39, 69632, v15
  s_add_u32 s44, s4, 65536
  s_addc_u32 s45, s5, 0
  s_mov_b32 s46, 27648
  s_mov_b32 s47, 0x20000
  s_add_u32 s52, s4, 98304
  s_addc_u32 s53, s5, 0
  s_mov_b32 s54, 16384
  s_mov_b32 s55, 0x20000
  s_add_u32 s40, s4, 22020096
  s_addc_u32 s41, s5, 0
  s_mov_b32 s42, 7077888
  s_mov_b32 s43, 0x20000
  s_mov_b32 s48, s38
  s_mov_b32 s49, s39
  s_mov_b32 s50, 256
  s_mov_b32 s51, 0x20000
  s_add_u32 s56, s4, 18874368
  s_addc_u32 s57, s5, 0
  s_mov_b32 s58, 2211840
  s_mov_b32 s59, 0x20000
  s_add_u32 s72, s4, 32768
  s_addc_u32 s73, s5, 0
  s_mov_b32 s74, 2560
  s_mov_b32 s75, 0x20000
  s_mov_b32 s76, s36
  s_mov_b32 s77, s37
  s_mov_b32 s78, 2621440
  s_mov_b32 s79, 0x20000
  s_add_u32 s80, s4, 163840
  s_addc_u32 s81, s5, 0
  s_mov_b32 s82, 2048
  s_mov_b32 s83, 0x20000
  s_and_b32 s24, s2, 7
  s_lshr_b32 s25, s2, 3
  s_add_u32 s61, s24, 1
  s_and_b32 s61, s61, 3
  s_lshl_b32 s61, s61, 1
  s_lshr_b32 s26, s24, 2
  s_add_u32 s61, s61, s26
  s_lshl_b32 s61, s61, 2
  s_and_b32 s26, s25, 3
  s_add_u32 s61, s61, s26
  s_lshr_b32 s62, s25, 2
  s_mul_i32 s60, s19, 14336
  s_mul_i32 s65, s62, 276480
  s_add_u32 s65, s65, s60
  s_mul_i32 s66, s61, 221184
  s_add_u32 s66, s66, s60
  s_lshl_b32 s24, s22, 10
  v_subrev_u32 v7, s24, v7
  v_lshlrev_b32 v0, 4, v6
  s_lshl_b32 s24, s23, 7
  s_cmp_lt_u32 s23, 54
  s_cselect_b32 s24, s24, 2146435072
  v_add_u32 v0, s24, v0
  s_lshl_b32 s24, s22, 3
  v_mov_b32 v1, s24
  v_mov_b32 v128, 0
  v_mov_b32 v129, 0
  v_mov_b32 v130, 0
  v_mov_b32 v131, 0
  v_mov_b32 v132, 0
  v_mov_b32 v133, 0
  v_mov_b32 v134, 0
  v_mov_b32 v135, 0
  v_mov_b32 v136, 0
  v_mov_b32 v137, 0
  v_mov_b32 v138, 0
  v_mov_b32 v139, 0
  v_mov_b32 v140, 0
  v_mov_b32 v141, 0
  v_mov_b32 v142, 0
  v_mov_b32 v143, 0
  v_mov_b32 v144, 0
  v_mov_b32 v145, 0
  v_mov_b32 v146, 0
  v_mov_b32 v147, 0
  v_mov_b32 v148, 0
  v_mov_b32 v149, 0
  v_mov_b32 v150, 0
  v_mov_b32 v151, 0
  v_mov_b32 v152, 0
  v_mov_b32 v153, 0
  v_mov_b32 v154, 0
  v_mov_b32 v155, 0
  v_mov_b32 v156, 0
  v_mov_b32 v157, 0
  v_mov_b32 v158, 0
  v_mov_b32 v159, 0
  v_mov_b32 v160, 0
  v_mov_b32 v161, 0
  v_mov_b32 v162, 0
  v_mov_b32 v163, 0
  v_mov_b32 v164, 0
  v_mov_b32 v165, 0
  v_mov_b32 v166, 0
  v_mov_b32 v167, 0
  v_mov_b32 v168, 0
  v_mov_b32 v169, 0
  v_mov_b32 v170, 0
  v_mov_b32 v171, 0
  v_mov_b32 v172, 0
  v_mov_b32 v173, 0
  v_mov_b32 v174, 0
  v_mov_b32 v175, 0
  v_mov_b32 v176, 0
  v_mov_b32 v177, 0
  v_mov_b32 v178, 0
  v_mov_b32 v179, 0
  v_mov_b32 v180, 0
  v_mov_b32 v181, 0
  v_mov_b32 v182, 0
  v_mov_b32 v183, 0
  v_mov_b32 v184, 0
  v_mov_b32 v185, 0
  v_mov_b32 v186, 0
  v_mov_b32 v187, 0
  v_mov_b32 v188, 0
  v_mov_b32 v189, 0
  v_mov_b32 v190, 0
  v_mov_b32 v191, 0
  v_mov_b32 v192, 0
  v_mov_b32 v193, 0
  v_mov_b32 v194, 0
  v_mov_b32 v195, 0
  v_mov_b32 v196, 0
  v_mov_b32 v197, 0
  v_mov_b32 v198, 0
  v_mov_b32 v199, 0
  v_mov_b32 v200, 0
  v_mov_b32 v201, 0
  v_mov_b32 v202, 0
  v_mov_b32 v203, 0
  v_mov_b32 v204, 0
  v_mov_b32 v205, 0
  v_mov_b32 v206, 0
  v_mov_b32 v207, 0
  v_mov_b32 v208, 0
  v_mov_b32 v209, 0
  v_mov_b32 v210, 0
  v_mov_b32 v211, 0
  v_mov_b32 v212, 0
  v_mov_b32 v213, 0
  v_mov_b32 v214, 0
  v_mov_b32 v215, 0
  v_mov_b32 v216, 0
  v_mov_b32 v217, 0
  v_mov_b32 v218, 0
  v_mov_b32 v219, 0
  v_mov_b32 v220, 0
  v_mov_b32 v221, 0
  v_mov_b32 v222, 0
  v_mov_b32 v223, 0
  v_mov_b32 v224, 0
  v_mov_b32 v225, 0
  v_mov_b32 v226, 0
  v_mov_b32 v227, 0
  v_mov_b32 v228, 0
  v_mov_b32 v229, 0
  v_mov_b32 v230, 0
  v_mov_b32 v231, 0
  v_mov_b32 v232, 0
  v_mov_b32 v233, 0
  v_mov_b32 v234, 0
  v_mov_b32 v235, 0
  v_mov_b32 v236, 0
  v_mov_b32 v237, 0
  v_mov_b32 v238, 0
  v_mov_b32 v239, 0
  v_mov_b32 v240, 0
  v_mov_b32 v241, 0
  v_mov_b32 v242, 0
  v_mov_b32 v243, 0
  v_mov_b32 v244, 0
  v_mov_b32 v245, 0
  v_mov_b32 v246, 0
  v_mov_b32 v247, 0
  v_mov_b32 v248, 0
  v_mov_b32 v249, 0
  v_mov_b32 v250, 0
  v_mov_b32 v251, 0
  v_mov_b32 v252, 0
  v_mov_b32 v253, 0
  v_mov_b32 v254, 0
  v_mov_b32 v255, 0
  s_waitcnt vmcnt(8)
  s_barrier
  ds_read_b64 v[64:65], v8 offset:0
  ds_read_b64 v[66:67], v8 offset:1088
  ds_read_b64 v[68:69], v9 offset:0
  ds_read_b64 v[70:71], v9 offset:1088
  ds_read_b64 v[72:73], v10 offset:0
  ds_read_b64 v[74:75], v10 offset:1088
  ds_read_b64 v[76:77], v11 offset:0
  ds_read_b64 v[78:79], v11 offset:1088
  ds_read_b64 v[80:81], v12 offset:0
  ds_read_b64 v[82:83], v12 offset:1088
  ds_read_b64 v[84:85], v13 offset:0
  ds_read_b64 v[86:87], v13 offset:1088
  ds_read_b64 v[88:89], v14 offset:0
  ds_read_b64 v[90:91], v14 offset:1088
  ds_read_b64 v[92:93], v15 offset:0
  ds_read_b64 v[94:95], v15 offset:1088
  s_waitcnt lgkmcnt(0)
  s_waitcnt vmcnt(6)
  v_mfma_f32_16x16x32_bf16 v[128:131], a[0:3], v[64:67], v[128:131]
  ds_read_b64 v[96:97], v8 offset:8704
  s_add_u32 m0, s27, 34816
  v_mfma_f32_16x16x32_bf16 v[144:147], a[0:3], v[68:71], v[144:147]
  ds_read_b64 v[98:99], v8 offset:9792
  s_mov_b32 s28, 532480
  v_mfma_f32_16x16x32_bf16 v[160:163], a[0:3], v[72:75], v[160:163]
  ds_read_b64 v[100:101], v9 offset:8704
  buffer_load_dwordx4 v3, s[8:11], s28 offen lds
  v_mfma_f32_16x16x32_bf16 v[176:179], a[0:3], v[76:79], v[176:179]
  ds_read_b64 v[102:103], v9 offset:9792
  v_mfma_f32_16x16x32_bf16 v[192:195], a[0:3], v[80:83], v[192:195]
  s_add_u32 m0, s27, 35904
  ds_read_b64 v[104:105], v10 offset:8704
  v_mfma_f32_16x16x32_bf16 v[208:211], a[0:3], v[84:87], v[208:211]
  s_mov_b32 s28, 549120
  ds_read_b64 v[106:107], v10 offset:9792
  v_mfma_f32_16x16x32_bf16 v[224:227], a[0:3], v[88:91], v[224:227]
  buffer_load_dwordx4 v3, s[8:11], s28 offen lds
  ds_read_b64 v[108:109], v11 offset:8704
  v_mfma_f32_16x16x32_bf16 v[240:243], a[0:3], v[92:95], v[240:243]
  ds_read_b64 v[110:111], v11 offset:9792
  v_mfma_f32_16x16x32_bf16 v[132:135], a[4:7], v[64:67], v[132:135]
  ds_read_b64 v[112:113], v12 offset:8704
  s_add_u32 m0, s27, 43520
  v_mfma_f32_16x16x32_bf16 v[148:151], a[4:7], v[68:71], v[148:151]
  ds_read_b64 v[114:115], v12 offset:9792
  s_mov_b32 s28, 665600
  v_mfma_f32_16x16x32_bf16 v[164:167], a[4:7], v[72:75], v[164:167]
  ds_read_b64 v[116:117], v13 offset:8704
  buffer_load_dwordx4 v3, s[8:11], s28 offen lds
  v_mfma_f32_16x16x32_bf16 v[180:183], a[4:7], v[76:79], v[180:183]
  ds_read_b64 v[118:119], v13 offset:9792
  v_mfma_f32_16x16x32_bf16 v[196:199], a[4:7], v[80:83], v[196:199]
  s_add_u32 m0, s27, 44608
  ds_read_b64 v[120:121], v14 offset:8704
  v_mfma_f32_16x16x32_bf16 v[212:215], a[4:7], v[84:87], v[212:215]
  s_mov_b32 s28, 682240
  ds_read_b64 v[122:123], v14 offset:9792
  v_mfma_f32_16x16x32_bf16 v[228:231], a[4:7], v[88:91], v[228:231]
  buffer_load_dwordx4 v3, s[8:11], s28 offen lds
  ds_read_b64 v[124:125], v15 offset:8704
  v_mfma_f32_16x16x32_bf16 v[244:247], a[4:7], v[92:95], v[244:247]
  ds_read_b64 v[126:127], v15 offset:9792
  s_waitcnt vmcnt(8)
  v_mfma_f32_16x16x32_bf16 v[136:139], a[8:11], v[64:67], v[136:139]
  s_add_u32 m0, s27, 52224
  v_mfma_f32_16x16x32_bf16 v[152:155], a[8:11], v[68:71], v[152:155]
  s_mov_b32 s28, 798720
  v_mfma_f32_16x16x32_bf16 v[168:171], a[8:11], v[72:75], v[168:171]
  buffer_load_dwordx4 v3, s[8:11], s28 offen lds
  v_mfma_f32_16x16x32_bf16 v[184:187], a[8:11], v[76:79], v[184:187]
  s_add_u32 m0, s27, 53312
  v_mfma_f32_16x16x32_bf16 v[200:203], a[8:11], v[80:83], v[200:203]
  s_mov_b32 s28, 815360
  v_mfma_f32_16x16x32_bf16 v[216:219], a[8:11], v[84:87], v[216:219]
  buffer_load_dwordx4 v3, s[8:11], s28 offen lds
  v_mfma_f32_16x16x32_bf16 v[232:235], a[8:11], v[88:91], v[232:235]
  v_mfma_f32_16x16x32_bf16 v[248:251], a[8:11], v[92:95], v[248:251]
  v_mfma_f32_16x16x32_bf16 v[140:143], a[12:15], v[64:67], v[140:143]
  s_add_u32 m0, s27, 60928
  v_mfma_f32_16x16x32_bf16 v[156:159], a[12:15], v[68:71], v[156:159]
  s_mov_b32 s28, 931840
  v_mfma_f32_16x16x32_bf16 v[172:175], a[12:15], v[72:75], v[172:175]
  buffer_load_dwordx4 v3, s[8:11], s28 offen lds
  v_mfma_f32_16x16x32_bf16 v[188:191], a[12:15], v[76:79], v[188:191]
  s_add_u32 m0, s27, 62016
  v_mfma_f32_16x16x32_bf16 v[204:207], a[12:15], v[80:83], v[204:207]
  s_mov_b32 s28, 948480
  v_mfma_f32_16x16x32_bf16 v[220:223], a[12:15], v[84:87], v[220:223]
  buffer_load_dwordx4 v3, s[8:11], s28 offen lds
  v_mfma_f32_16x16x32_bf16 v[236:239], a[12:15], v[88:91], v[236:239]
  v_mfma_f32_16x16x32_bf16 v[252:255], a[12:15], v[92:95], v[252:255]
  s_waitcnt lgkmcnt(0)
  s_waitcnt vmcnt(10)
  v_mfma_f32_16x16x32_bf16 v[128:131], a[16:19], v[96:99], v[128:131]
  ds_read_b64 v[64:65], v8 offset:17408
  s_mov_b32 s29, 8192
  v_mfma_f32_16x16x32_bf16 v[144:147], a[16:19], v[100:103], v[144:147]
  ds_read_b64 v[66:67], v8 offset:18496
  v_mfma_f32_16x16x32_bf16 v[160:163], a[16:19], v[104:107], v[160:163]
  buffer_load_dwordx4 a[32:35], v4, s[12:15], s29 offen offset:0
  ds_read_b64 v[68:69], v9 offset:17408
  v_mfma_f32_16x16x32_bf16 v[176:179], a[16:19], v[108:111], v[176:179]
  buffer_load_dwordx4 a[36:39], v4, s[12:15], s29 offen offset:1024
  v_mfma_f32_16x16x32_bf16 v[192:195], a[16:19], v[112:115], v[192:195]
  ds_read_b64 v[70:71], v9 offset:18496
  v_mfma_f32_16x16x32_bf16 v[208:211], a[16:19], v[116:119], v[208:211]
  ds_read_b64 v[72:73], v10 offset:17408
  ds_read_b64 v[74:75], v10 offset:18496
  v_mfma_f32_16x16x32_bf16 v[224:227], a[16:19], v[120:123], v[224:227]
  ds_read_b64 v[76:77], v11 offset:17408
  v_mfma_f32_16x16x32_bf16 v[240:243], a[16:19], v[124:127], v[240:243]
  ds_read_b64 v[78:79], v11 offset:18496
  v_mfma_f32_16x16x32_bf16 v[132:135], a[20:23], v[96:99], v[132:135]
  ds_read_b64 v[80:81], v12 offset:17408
  buffer_load_dwordx4 a[40:43], v4, s[12:15], s29 offen offset:2048
  v_mfma_f32_16x16x32_bf16 v[148:151], a[20:23], v[100:103], v[148:151]
  ds_read_b64 v[82:83], v12 offset:18496
  v_mfma_f32_16x16x32_bf16 v[164:167], a[20:23], v[104:107], v[164:167]
  buffer_load_dwordx4 a[44:47], v4, s[12:15], s29 offen offset:3072
  v_mfma_f32_16x16x32_bf16 v[180:183], a[20:23], v[108:111], v[180:183]
  ds_read_b64 v[84:85], v13 offset:17408
  v_mfma_f32_16x16x32_bf16 v[196:199], a[20:23], v[112:115], v[196:199]
  ds_read_b64 v[86:87], v13 offset:18496
  ds_read_b64 v[88:89], v14 offset:17408
  v_mfma_f32_16x16x32_bf16 v[212:215], a[20:23], v[116:119], v[212:215]
  ds_read_b64 v[90:91], v14 offset:18496
  v_mfma_f32_16x16x32_bf16 v[228:231], a[20:23], v[120:123], v[228:231]
  ds_read_b64 v[92:93], v15 offset:17408
  v_mfma_f32_16x16x32_bf16 v[244:247], a[20:23], v[124:127], v[244:247]
  ds_read_b64 v[94:95], v15 offset:18496
  s_waitcnt vmcnt(12)
  v_mfma_f32_16x16x32_bf16 v[136:139], a[24:27], v[96:99], v[136:139]
  s_mov_b32 s29, 12288
  v_mfma_f32_16x16x32_bf16 v[152:155], a[24:27], v[100:103], v[152:155]
  buffer_load_dwordx4 a[48:51], v4, s[12:15], s29 offen offset:0
  v_mfma_f32_16x16x32_bf16 v[168:171], a[24:27], v[104:107], v[168:171]
  buffer_load_dwordx4 a[52:55], v4, s[12:15], s29 offen offset:1024
  v_mfma_f32_16x16x32_bf16 v[184:187], a[24:27], v[108:111], v[184:187]
  v_mfma_f32_16x16x32_bf16 v[200:203], a[24:27], v[112:115], v[200:203]
  v_mfma_f32_16x16x32_bf16 v[216:219], a[24:27], v[116:119], v[216:219]
  v_mfma_f32_16x16x32_bf16 v[232:235], a[24:27], v[120:123], v[232:235]
  v_mfma_f32_16x16x32_bf16 v[248:251], a[24:27], v[124:127], v[248:251]
  v_mfma_f32_16x16x32_bf16 v[140:143], a[28:31], v[96:99], v[140:143]
  buffer_load_dwordx4 a[56:59], v4, s[12:15], s29 offen offset:2048
  v_mfma_f32_16x16x32_bf16 v[156:159], a[28:31], v[100:103], v[156:159]
  buffer_load_dwordx4 a[60:63], v4, s[12:15], s29 offen offset:3072
  v_mfma_f32_16x16x32_bf16 v[172:175], a[28:31], v[104:107], v[172:175]
  v_mfma_f32_16x16x32_bf16 v[188:191], a[28:31], v[108:111], v[188:191]
  v_mfma_f32_16x16x32_bf16 v[204:207], a[28:31], v[112:115], v[204:207]
  v_mfma_f32_16x16x32_bf16 v[220:223], a[28:31], v[116:119], v[220:223]
  v_mfma_f32_16x16x32_bf16 v[236:239], a[28:31], v[120:123], v[236:239]
  v_mfma_f32_16x16x32_bf16 v[252:255], a[28:31], v[124:127], v[252:255]
  s_waitcnt lgkmcnt(0)
  s_waitcnt vmcnt(6)
  v_mfma_f32_16x16x32_bf16 v[128:131], a[32:35], v[64:67], v[128:131]
  ds_read_b64 v[96:97], v8 offset:26112
  s_mov_b32 s29, 16384
  v_mfma_f32_16x16x32_bf16 v[144:147], a[32:35], v[68:71], v[144:147]
  ds_read_b64 v[98:99], v8 offset:27200
  v_mfma_f32_16x16x32_bf16 v[160:163], a[32:35], v[72:75], v[160:163]
  buffer_load_dwordx4 a[0:3], v4, s[12:15], s29 offen offset:0
  ds_read_b64 v[100:101], v9 offset:26112
  v_mfma_f32_16x16x32_bf16 v[176:179], a[32:35], v[76:79], v[176:179]
  buffer_load_dwordx4 a[4:7], v4, s[12:15], s29 offen offset:1024
  v_mfma_f32_16x16x32_bf16 v[192:195], a[32:35], v[80:83], v[192:195]
  ds_read_b64 v[102:103], v9 offset:27200
  v_mfma_f32_16x16x32_bf16 v[208:211], a[32:35], v[84:87], v[208:211]
  ds_read_b64 v[104:105], v10 offset:26112
  ds_read_b64 v[106:107], v10 offset:27200
  v_mfma_f32_16x16x32_bf16 v[224:227], a[32:35], v[88:91], v[224:227]
  ds_read_b64 v[108:109], v11 offset:26112
  v_mfma_f32_16x16x32_bf16 v[240:243], a[32:35], v[92:95], v[240:243]
  ds_read_b64 v[110:111], v11 offset:27200
  v_mfma_f32_16x16x32_bf16 v[132:135], a[36:39], v[64:67], v[132:135]
  ds_read_b64 v[112:113], v12 offset:26112
  buffer_load_dwordx4 a[8:11], v4, s[12:15], s29 offen offset:2048
  v_mfma_f32_16x16x32_bf16 v[148:151], a[36:39], v[68:71], v[148:151]
  ds_read_b64 v[114:115], v12 offset:27200
  v_mfma_f32_16x16x32_bf16 v[164:167], a[36:39], v[72:75], v[164:167]
  buffer_load_dwordx4 a[12:15], v4, s[12:15], s29 offen offset:3072
  v_mfma_f32_16x16x32_bf16 v[180:183], a[36:39], v[76:79], v[180:183]
  ds_read_b64 v[116:117], v13 offset:26112
  v_mfma_f32_16x16x32_bf16 v[196:199], a[36:39], v[80:83], v[196:199]
  ds_read_b64 v[118:119], v13 offset:27200
  ds_read_b64 v[120:121], v14 offset:26112
  v_mfma_f32_16x16x32_bf16 v[212:215], a[36:39], v[84:87], v[212:215]
  ds_read_b64 v[122:123], v14 offset:27200
  v_mfma_f32_16x16x32_bf16 v[228:231], a[36:39], v[88:91], v[228:231]
  ds_read_b64 v[124:125], v15 offset:26112
  v_mfma_f32_16x16x32_bf16 v[244:247], a[36:39], v[92:95], v[244:247]
  ds_read_b64 v[126:127], v15 offset:27200
  s_waitcnt vmcnt(8)
  v_mfma_f32_16x16x32_bf16 v[136:139], a[40:43], v[64:67], v[136:139]
  s_mov_b32 s29, 20480
  v_mfma_f32_16x16x32_bf16 v[152:155], a[40:43], v[68:71], v[152:155]
  buffer_load_dwordx4 a[16:19], v4, s[12:15], s29 offen offset:0
  v_mfma_f32_16x16x32_bf16 v[168:171], a[40:43], v[72:75], v[168:171]
  buffer_load_dwordx4 a[20:23], v4, s[12:15], s29 offen offset:1024
  v_mfma_f32_16x16x32_bf16 v[184:187], a[40:43], v[76:79], v[184:187]
  v_mfma_f32_16x16x32_bf16 v[200:203], a[40:43], v[80:83], v[200:203]
  v_mfma_f32_16x16x32_bf16 v[216:219], a[40:43], v[84:87], v[216:219]
  v_mfma_f32_16x16x32_bf16 v[232:235], a[40:43], v[88:91], v[232:235]
  v_mfma_f32_16x16x32_bf16 v[248:251], a[40:43], v[92:95], v[248:251]
  v_mfma_f32_16x16x32_bf16 v[140:143], a[44:47], v[64:67], v[140:143]
  buffer_load_dwordx4 a[24:27], v4, s[12:15], s29 offen offset:2048
  v_mfma_f32_16x16x32_bf16 v[156:159], a[44:47], v[68:71], v[156:159]
  s_add_u32 m0, s27, 69632
  v_mfma_f32_16x16x32_bf16 v[172:175], a[44:47], v[72:75], v[172:175]
  s_mov_b32 s28, 1064960
  v_mfma_f32_16x16x32_bf16 v[188:191], a[44:47], v[76:79], v[188:191]
  buffer_load_dwordx4 v3, s[8:11], s28 offen lds
  v_mfma_f32_16x16x32_bf16 v[204:207], a[44:47], v[80:83], v[204:207]
  v_mfma_f32_16x16x32_bf16 v[220:223], a[44:47], v[84:87], v[220:223]
  v_mfma_f32_16x16x32_bf16 v[236:239], a[44:47], v[88:91], v[236:239]
  v_mfma_f32_16x16x32_bf16 v[252:255], a[44:47], v[92:95], v[252:255]
  s_waitcnt lgkmcnt(0)
  s_waitcnt vmcnt(16)
  s_barrier
  s_waitcnt vmcnt(10)
  v_mfma_f32_16x16x32_bf16 v[128:131], a[48:51], v[96:99], v[128:131]
  ds_read_b64 v[64:65], v8 offset:34816
  s_add_u32 m0, s27, 70720
  v_mfma_f32_16x16x32_bf16 v[144:147], a[48:51], v[100:103], v[144:147]
  ds_read_b64 v[66:67], v8 offset:35904
  s_mov_b32 s28, 1081600
  v_mfma_f32_16x16x32_bf16 v[160:163], a[48:51], v[104:107], v[160:163]
  ds_read_b64 v[68:69], v9 offset:34816
  buffer_load_dwordx4 v3, s[8:11], s28 offen lds
  v_mfma_f32_16x16x32_bf16 v[176:179], a[48:51], v[108:111], v[176:179]
  ds_read_b64 v[70:71], v9 offset:35904
  v_mfma_f32_16x16x32_bf16 v[192:195], a[48:51], v[112:115], v[192:195]
  s_add_u32 m0, s27, 78336
  ds_read_b64 v[72:73], v10 offset:34816
  v_mfma_f32_16x16x32_bf16 v[208:211], a[48:51], v[116:119], v[208:211]
  s_mov_b32 s28, 1198080
  ds_read_b64 v[74:75], v10 offset:35904
  v_mfma_f32_16x16x32_bf16 v[224:227], a[48:51], v[120:123], v[224:227]
  buffer_load_dwordx4 v3, s[8:11], s28 offen lds
  ds_read_b64 v[76:77], v11 offset:34816
  v_mfma_f32_16x16x32_bf16 v[240:243], a[48:51], v[124:127], v[240:243]
  ds_read_b64 v[78:79], v11 offset:35904
  v_mfma_f32_16x16x32_bf16 v[132:135], a[52:55], v[96:99], v[132:135]
  ds_read_b64 v[80:81], v12 offset:34816
  s_add_u32 m0, s27, 79424
  v_mfma_f32_16x16x32_bf16 v[148:151], a[52:55], v[100:103], v[148:151]
  ds_read_b64 v[82:83], v12 offset:35904
  s_mov_b32 s28, 1214720
  v_mfma_f32_16x16x32_bf16 v[164:167], a[52:55], v[104:107], v[164:167]
  ds_read_b64 v[84:85], v13 offset:34816
  buffer_load_dwordx4 v3, s[8:11], s28 offen lds
  v_mfma_f32_16x16x32_bf16 v[180:183], a[52:55], v[108:111], v[180:183]
  ds_read_b64 v[86:87], v13 offset:35904
  v_mfma_f32_16x16x32_bf16 v[196:199], a[52:55], v[112:115], v[196:199]
  s_add_u32 m0, s27, 87040
  ds_read_b64 v[88:89], v14 offset:34816
  v_mfma_f32_16x16x32_bf16 v[212:215], a[52:55], v[116:119], v[212:215]
  s_mov_b32 s28, 1331200
  ds_read_b64 v[90:91], v14 offset:35904
  v_mfma_f32_16x16x32_bf16 v[228:231], a[52:55], v[120:123], v[228:231]
  buffer_load_dwordx4 v3, s[8:11], s28 offen lds
  ds_read_b64 v[92:93], v15 offset:34816
  v_mfma_f32_16x16x32_bf16 v[244:247], a[52:55], v[124:127], v[244:247]
  ds_read_b64 v[94:95], v15 offset:35904
  s_waitcnt vmcnt(12)
  v_mfma_f32_16x16x32_bf16 v[136:139], a[56:59], v[96:99], v[136:139]
  s_add_u32 m0, s27, 88128
  v_mfma_f32_16x16x32_bf16 v[152:155], a[56:59], v[100:103], v[152:155]
  s_mov_b32 s28, 1347840
  v_mfma_f32_16x16x32_bf16 v[168:171], a[56:59], v[104:107], v[168:171]
  buffer_load_dwordx4 v3, s[8:11], s28 offen lds
  v_mfma_f32_16x16x32_bf16 v[184:187], a[56:59], v[108:111], v[184:187]
  s_add_u32 m0, s27, 95744
  v_mfma_f32_16x16x32_bf16 v[200:203], a[56:59], v[112:115], v[200:203]
  s_mov_b32 s28, 1464320
  v_mfma_f32_16x16x32_bf16 v[216:219], a[56:59], v[116:119], v[216:219]
  buffer_load_dwordx4 v3, s[8:11], s28 offen lds
  v_mfma_f32_16x16x32_bf16 v[232:235], a[56:59], v[120:123], v[232:235]
  v_mfma_f32_16x16x32_bf16 v[248:251], a[56:59], v[124:127], v[248:251]
  v_mfma_f32_16x16x32_bf16 v[140:143], a[60:63], v[96:99], v[140:143]
  s_add_u32 m0, s27, 96832
  v_mfma_f32_16x16x32_bf16 v[156:159], a[60:63], v[100:103], v[156:159]
  s_mov_b32 s28, 1480960
  v_mfma_f32_16x16x32_bf16 v[172:175], a[60:63], v[104:107], v[172:175]
  buffer_load_dwordx4 v3, s[8:11], s28 offen lds
  v_mfma_f32_16x16x32_bf16 v[188:191], a[60:63], v[108:111], v[188:191]
  buffer_load_dwordx4 a[28:31], v4, s[12:15], s29 offen offset:3072
  v_mfma_f32_16x16x32_bf16 v[204:207], a[60:63], v[112:115], v[204:207]
  v_mfma_f32_16x16x32_bf16 v[220:223], a[60:63], v[116:119], v[220:223]
  v_mfma_f32_16x16x32_bf16 v[236:239], a[60:63], v[120:123], v[236:239]
  v_mfma_f32_16x16x32_bf16 v[252:255], a[60:63], v[124:127], v[252:255]
  s_waitcnt lgkmcnt(0)
  s_waitcnt vmcnt(14)
  v_mfma_f32_16x16x32_bf16 v[128:131], a[0:3], v[64:67], v[128:131]
  ds_read_b64 v[96:97], v8 offset:43520
  s_mov_b32 s29, 24576
  v_mfma_f32_16x16x32_bf16 v[144:147], a[0:3], v[68:71], v[144:147]
  ds_read_b64 v[98:99], v8 offset:44608
  v_mfma_f32_16x16x32_bf16 v[160:163], a[0:3], v[72:75], v[160:163]
  buffer_load_dwordx4 a[32:35], v4, s[12:15], s29 offen offset:0
  ds_read_b64 v[100:101], v9 offset:43520
  v_mfma_f32_16x16x32_bf16 v[176:179], a[0:3], v[76:79], v[176:179]
  buffer_load_dwordx4 a[36:39], v4, s[12:15], s29 offen offset:1024
  v_mfma_f32_16x16x32_bf16 v[192:195], a[0:3], v[80:83], v[192:195]
  ds_read_b64 v[102:103], v9 offset:44608
  v_mfma_f32_16x16x32_bf16 v[208:211], a[0:3], v[84:87], v[208:211]
  ds_read_b64 v[104:105], v10 offset:43520
  ds_read_b64 v[106:107], v10 offset:44608
  v_mfma_f32_16x16x32_bf16 v[224:227], a[0:3], v[88:91], v[224:227]
  ds_read_b64 v[108:109], v11 offset:43520
  v_mfma_f32_16x16x32_bf16 v[240:243], a[0:3], v[92:95], v[240:243]
  ds_read_b64 v[110:111], v11 offset:44608
  v_mfma_f32_16x16x32_bf16 v[132:135], a[4:7], v[64:67], v[132:135]
  ds_read_b64 v[112:113], v12 offset:43520
  buffer_load_dwordx4 a[40:43], v4, s[12:15], s29 offen offset:2048
  v_mfma_f32_16x16x32_bf16 v[148:151], a[4:7], v[68:71], v[148:151]
  ds_read_b64 v[114:115], v12 offset:44608
  v_mfma_f32_16x16x32_bf16 v[164:167], a[4:7], v[72:75], v[164:167]
  buffer_load_dwordx4 a[44:47], v4, s[12:15], s29 offen offset:3072
  v_mfma_f32_16x16x32_bf16 v[180:183], a[4:7], v[76:79], v[180:183]
  ds_read_b64 v[116:117], v13 offset:43520
  v_mfma_f32_16x16x32_bf16 v[196:199], a[4:7], v[80:83], v[196:199]
  ds_read_b64 v[118:119], v13 offset:44608
  ds_read_b64 v[120:121], v14 offset:43520
  v_mfma_f32_16x16x32_bf16 v[212:215], a[4:7], v[84:87], v[212:215]
  ds_read_b64 v[122:123], v14 offset:44608
  v_mfma_f32_16x16x32_bf16 v[228:231], a[4:7], v[88:91], v[228:231]
  ds_read_b64 v[124:125], v15 offset:43520
  v_mfma_f32_16x16x32_bf16 v[244:247], a[4:7], v[92:95], v[244:247]
  ds_read_b64 v[126:127], v15 offset:44608
  s_waitcnt vmcnt(16)
  v_mfma_f32_16x16x32_bf16 v[136:139], a[8:11], v[64:67], v[136:139]
  s_mov_b32 s29, 28672
  v_mfma_f32_16x16x32_bf16 v[152:155], a[8:11], v[68:71], v[152:155]
  buffer_load_dwordx4 a[48:51], v4, s[12:15], s29 offen offset:0
  v_mfma_f32_16x16x32_bf16 v[168:171], a[8:11], v[72:75], v[168:171]
  buffer_load_dwordx4 a[52:55], v4, s[12:15], s29 offen offset:1024
  v_mfma_f32_16x16x32_bf16 v[184:187], a[8:11], v[76:79], v[184:187]
  v_mfma_f32_16x16x32_bf16 v[200:203], a[8:11], v[80:83], v[200:203]
  v_mfma_f32_16x16x32_bf16 v[216:219], a[8:11], v[84:87], v[216:219]
  v_mfma_f32_16x16x32_bf16 v[232:235], a[8:11], v[88:91], v[232:235]
  v_mfma_f32_16x16x32_bf16 v[248:251], a[8:11], v[92:95], v[248:251]
  v_mfma_f32_16x16x32_bf16 v[140:143], a[12:15], v[64:67], v[140:143]
  buffer_load_dwordx4 a[56:59], v4, s[12:15], s29 offen offset:2048
  v_mfma_f32_16x16x32_bf16 v[156:159], a[12:15], v[68:71], v[156:159]
  buffer_load_dwordx4 a[60:63], v4, s[12:15], s29 offen offset:3072
  v_mfma_f32_16x16x32_bf16 v[172:175], a[12:15], v[72:75], v[172:175]
  v_mfma_f32_16x16x32_bf16 v[188:191], a[12:15], v[76:79], v[188:191]
  v_mfma_f32_16x16x32_bf16 v[204:207], a[12:15], v[80:83], v[204:207]
  v_mfma_f32_16x16x32_bf16 v[220:223], a[12:15], v[84:87], v[220:223]
  v_mfma_f32_16x16x32_bf16 v[236:239], a[12:15], v[88:91], v[236:239]
  v_mfma_f32_16x16x32_bf16 v[252:255], a[12:15], v[92:95], v[252:255]
  s_waitcnt lgkmcnt(0)
  s_waitcnt vmcnt(18)
  v_mfma_f32_16x16x32_bf16 v[128:131], a[16:19], v[96:99], v[128:131]
  ds_read_b64 v[64:65], v8 offset:52224
  s_mov_b32 s29, 32768
  v_mfma_f32_16x16x32_bf16 v[144:147], a[16:19], v[100:103], v[144:147]
  ds_read_b64 v[66:67], v8 offset:53312
  v_mfma_f32_16x16x32_bf16 v[160:163], a[16:19], v[104:107], v[160:163]
  buffer_load_dwordx4 a[0:3], v4, s[12:15], s29 offen offset:0
  ds_read_b64 v[68:69], v9 offset:52224
  v_mfma_f32_16x16x32_bf16 v[176:179], a[16:19], v[108:111], v[176:179]
  buffer_load_dwordx4 a[4:7], v4, s[12:15], s29 offen offset:1024
  v_mfma_f32_16x16x32_bf16 v[192:195], a[16:19], v[112:115], v[192:195]
  ds_read_b64 v[70:71], v9 offset:53312
  v_mfma_f32_16x16x32_bf16 v[208:211], a[16:19], v[116:119], v[208:211]
  ds_read_b64 v[72:73], v10 offset:52224
  ds_read_b64 v[74:75], v10 offset:53312
  v_mfma_f32_16x16x32_bf16 v[224:227], a[16:19], v[120:123], v[224:227]
  ds_read_b64 v[76:77], v11 offset:52224
  v_mfma_f32_16x16x32_bf16 v[240:243], a[16:19], v[124:127], v[240:243]
  ds_read_b64 v[78:79], v11 offset:53312
  v_mfma_f32_16x16x32_bf16 v[132:135], a[20:23], v[96:99], v[132:135]
  ds_read_b64 v[80:81], v12 offset:52224
  buffer_load_dwordx4 a[8:11], v4, s[12:15], s29 offen offset:2048
  v_mfma_f32_16x16x32_bf16 v[148:151], a[20:23], v[100:103], v[148:151]
  ds_read_b64 v[82:83], v12 offset:53312
  v_mfma_f32_16x16x32_bf16 v[164:167], a[20:23], v[104:107], v[164:167]
  buffer_load_dwordx4 a[12:15], v4, s[12:15], s29 offen offset:3072
  v_mfma_f32_16x16x32_bf16 v[180:183], a[20:23], v[108:111], v[180:183]
  ds_read_b64 v[84:85], v13 offset:52224
  v_mfma_f32_16x16x32_bf16 v[196:199], a[20:23], v[112:115], v[196:199]
  ds_read_b64 v[86:87], v13 offset:53312
  ds_read_b64 v[88:89], v14 offset:52224
  v_mfma_f32_16x16x32_bf16 v[212:215], a[20:23], v[116:119], v[212:215]
  ds_read_b64 v[90:91], v14 offset:53312
  v_mfma_f32_16x16x32_bf16 v[228:231], a[20:23], v[120:123], v[228:231]
  ds_read_b64 v[92:93], v15 offset:52224
  v_mfma_f32_16x16x32_bf16 v[244:247], a[20:23], v[124:127], v[244:247]
  ds_read_b64 v[94:95], v15 offset:53312
  s_waitcnt vmcnt(12)
  v_mfma_f32_16x16x32_bf16 v[136:139], a[24:27], v[96:99], v[136:139]
  s_mov_b32 s29, 36864
  v_mfma_f32_16x16x32_bf16 v[152:155], a[24:27], v[100:103], v[152:155]
  buffer_load_dwordx4 a[16:19], v4, s[12:15], s29 offen offset:0
  v_mfma_f32_16x16x32_bf16 v[168:171], a[24:27], v[104:107], v[168:171]
  buffer_load_dwordx4 a[20:23], v4, s[12:15], s29 offen offset:1024
  v_mfma_f32_16x16x32_bf16 v[184:187], a[24:27], v[108:111], v[184:187]
  v_mfma_f32_16x16x32_bf16 v[200:203], a[24:27], v[112:115], v[200:203]
  v_mfma_f32_16x16x32_bf16 v[216:219], a[24:27], v[116:119], v[216:219]
  v_mfma_f32_16x16x32_bf16 v[232:235], a[24:27], v[120:123], v[232:235]
  v_mfma_f32_16x16x32_bf16 v[248:251], a[24:27], v[124:127], v[248:251]
  v_mfma_f32_16x16x32_bf16 v[140:143], a[28:31], v[96:99], v[140:143]
  buffer_load_dwordx4 a[24:27], v4, s[12:15], s29 offen offset:2048
  v_mfma_f32_16x16x32_bf16 v[156:159], a[28:31], v[100:103], v[156:159]
  s_add_u32 m0, s27, 0
  v_mfma_f32_16x16x32_bf16 v[172:175], a[28:31], v[104:107], v[172:175]
  s_mov_b32 s28, 1597440
  v_mfma_f32_16x16x32_bf16 v[188:191], a[28:31], v[108:111], v[188:191]
  buffer_load_dwordx4 v3, s[8:11], s28 offen lds
  v_mfma_f32_16x16x32_bf16 v[204:207], a[28:31], v[112:115], v[204:207]
  v_mfma_f32_16x16x32_bf16 v[220:223], a[28:31], v[116:119], v[220:223]
  v_mfma_f32_16x16x32_bf16 v[236:239], a[28:31], v[120:123], v[236:239]
  v_mfma_f32_16x16x32_bf16 v[252:255], a[28:31], v[124:127], v[252:255]
  s_waitcnt lgkmcnt(0)
  s_waitcnt vmcnt(14)
  v_mfma_f32_16x16x32_bf16 v[128:131], a[32:35], v[64:67], v[128:131]
  ds_read_b64 v[96:97], v8 offset:60928
  s_add_u32 m0, s27, 1088
  v_mfma_f32_16x16x32_bf16 v[144:147], a[32:35], v[68:71], v[144:147]
  ds_read_b64 v[98:99], v8 offset:62016
  s_mov_b32 s28, 1614080
  v_mfma_f32_16x16x32_bf16 v[160:163], a[32:35], v[72:75], v[160:163]
  ds_read_b64 v[100:101], v9 offset:60928
  buffer_load_dwordx4 v3, s[8:11], s28 offen lds
  v_mfma_f32_16x16x32_bf16 v[176:179], a[32:35], v[76:79], v[176:179]
  ds_read_b64 v[102:103], v9 offset:62016
  v_mfma_f32_16x16x32_bf16 v[192:195], a[32:35], v[80:83], v[192:195]
  s_add_u32 m0, s27, 8704
  ds_read_b64 v[104:105], v10 offset:60928
  v_mfma_f32_16x16x32_bf16 v[208:211], a[32:35], v[84:87], v[208:211]
  s_mov_b32 s28, 1730560
  ds_read_b64 v[106:107], v10 offset:62016
  v_mfma_f32_16x16x32_bf16 v[224:227], a[32:35], v[88:91], v[224:227]
  buffer_load_dwordx4 v3, s[8:11], s28 offen lds
  ds_read_b64 v[108:109], v11 offset:60928
  v_mfma_f32_16x16x32_bf16 v[240:243], a[32:35], v[92:95], v[240:243]
  ds_read_b64 v[110:111], v11 offset:62016
  v_mfma_f32_16x16x32_bf16 v[132:135], a[36:39], v[64:67], v[132:135]
  ds_read_b64 v[112:113], v12 offset:60928
  s_add_u32 m0, s27, 9792
  v_mfma_f32_16x16x32_bf16 v[148:151], a[36:39], v[68:71], v[148:151]
  ds_read_b64 v[114:115], v12 offset:62016
  s_mov_b32 s28, 1747200
  v_mfma_f32_16x16x32_bf16 v[164:167], a[36:39], v[72:75], v[164:167]
  ds_read_b64 v[116:117], v13 offset:60928
  buffer_load_dwordx4 v3, s[8:11], s28 offen lds
  v_mfma_f32_16x16x32_bf16 v[180:183], a[36:39], v[76:79], v[180:183]
  ds_read_b64 v[118:119], v13 offset:62016
  v_mfma_f32_16x16x32_bf16 v[196:199], a[36:39], v[80:83], v[196:199]
  s_add_u32 m0, s27, 17408
  ds_read_b64 v[120:121], v14 offset:60928
  v_mfma_f32_16x16x32_bf16 v[212:215], a[36:39], v[84:87], v[212:215]
  s_mov_b32 s28, 1863680
  ds_read_b64 v[122:123], v14 offset:62016
  v_mfma_f32_16x16x32_bf16 v[228:231], a[36:39], v[88:91], v[228:231]
  buffer_load_dwordx4 v3, s[8:11], s28 offen lds
  ds_read_b64 v[124:125], v15 offset:60928
  v_mfma_f32_16x16x32_bf16 v[244:247], a[36:39], v[92:95], v[244:247]
  ds_read_b64 v[126:127], v15 offset:62016
  s_waitcnt vmcnt(16)
  v_mfma_f32_16x16x32_bf16 v[136:139], a[40:43], v[64:67], v[136:139]
  s_add_u32 m0, s27, 18496
  v_mfma_f32_16x16x32_bf16 v[152:155], a[40:43], v[68:71], v[152:155]
  s_mov_b32 s28, 1880320
  v_mfma_f32_16x16x32_bf16 v[168:171], a[40:43], v[72:75], v[168:171]
  buffer_load_dwordx4 v3, s[8:11], s28 offen lds
  v_mfma_f32_16x16x32_bf16 v[184:187], a[40:43], v[76:79], v[184:187]
  s_add_u32 m0, s27, 26112
  v_mfma_f32_16x16x32_bf16 v[200:203], a[40:43], v[80:83], v[200:203]
  s_mov_b32 s28, 1996800
  v_mfma_f32_16x16x32_bf16 v[216:219], a[40:43], v[84:87], v[216:219]
  buffer_load_dwordx4 v3, s[8:11], s28 offen lds
  v_mfma_f32_16x16x32_bf16 v[232:235], a[40:43], v[88:91], v[232:235]
  v_mfma_f32_16x16x32_bf16 v[248:251], a[40:43], v[92:95], v[248:251]
  v_mfma_f32_16x16x32_bf16 v[140:143], a[44:47], v[64:67], v[140:143]
  s_add_u32 m0, s27, 27200
  v_mfma_f32_16x16x32_bf16 v[156:159], a[44:47], v[68:71], v[156:159]
  s_mov_b32 s28, 2013440
  v_mfma_f32_16x16x32_bf16 v[172:175], a[44:47], v[72:75], v[172:175]
  buffer_load_dwordx4 v3, s[8:11], s28 offen lds
  v_mfma_f32_16x16x32_bf16 v[188:191], a[44:47], v[76:79], v[188:191]
  buffer_load_dwordx4 a[28:31], v4, s[12:15], s29 offen offset:3072
  v_mfma_f32_16x16x32_bf16 v[204:207], a[44:47], v[80:83], v[204:207]
  v_mfma_f32_16x16x32_bf16 v[220:223], a[44:47], v[84:87], v[220:223]
  v_mfma_f32_16x16x32_bf16 v[236:239], a[44:47], v[88:91], v[236:239]
  v_mfma_f32_16x16x32_bf16 v[252:255], a[44:47], v[92:95], v[252:255]
  s_waitcnt lgkmcnt(0)
  s_waitcnt vmcnt(25)
  s_barrier
  s_waitcnt vmcnt(18)
  v_mfma_f32_16x16x32_bf16 v[128:131], a[48:51], v[96:99], v[128:131]
  ds_read_b64 v[64:65], v32 offset:0
  s_mov_b32 s29, 40960
  v_mfma_f32_16x16x32_bf16 v[144:147], a[48:51], v[100:103], v[144:147]
  ds_read_b64 v[66:67], v32 offset:1088
  v_mfma_f32_16x16x32_bf16 v[160:163], a[48:51], v[104:107], v[160:163]
  buffer_load_dwordx4 a[32:35], v4, s[12:15], s29 offen offset:0
  ds_read_b64 v[68:69], v33 offset:0
  v_mfma_f32_16x16x32_bf16 v[176:179], a[48:51], v[108:111], v[176:179]
  buffer_load_dwordx4 a[36:39], v4, s[12:15], s29 offen offset:1024
  v_mfma_f32_16x16x32_bf16 v[192:195], a[48:51], v[112:115], v[192:195]
  ds_read_b64 v[70:71], v33 offset:1088
  v_mfma_f32_16x16x32_bf16 v[208:211], a[48:51], v[116:119], v[208:211]
  ds_read_b64 v[72:73], v34 offset:0
  ds_read_b64 v[74:75], v34 offset:1088
  v_mfma_f32_16x16x32_bf16 v[224:227], a[48:51], v[120:123], v[224:227]
  ds_read_b64 v[76:77], v35 offset:0
  v_mfma_f32_16x16x32_bf16 v[240:243], a[48:51], v[124:127], v[240:243]
  ds_read_b64 v[78:79], v35 offset:1088
  v_mfma_f32_16x16x32_bf16 v[132:135], a[52:55], v[96:99], v[132:135]
  ds_read_b64 v[80:81], v36 offset:0
  buffer_load_dwordx4 a[40:43], v4, s[12:15], s29 offen offset:2048
  v_mfma_f32_16x16x32_bf16 v[148:151], a[52:55], v[100:103], v[148:151]
  ds_read_b64 v[82:83], v36 offset:1088
  v_mfma_f32_16x16x32_bf16 v[164:167], a[52:55], v[104:107], v[164:167]
  buffer_load_dwordx4 a[44:47], v4, s[12:15], s29 offen offset:3072
  v_mfma_f32_16x16x32_bf16 v[180:183], a[52:55], v[108:111], v[180:183]
  ds_read_b64 v[84:85], v37 offset:0
  v_mfma_f32_16x16x32_bf16 v[196:199], a[52:55], v[112:115], v[196:199]
  ds_read_b64 v[86:87], v37 offset:1088
  ds_read_b64 v[88:89], v38 offset:0
  v_mfma_f32_16x16x32_bf16 v[212:215], a[52:55], v[116:119], v[212:215]
  ds_read_b64 v[90:91], v38 offset:1088
  v_mfma_f32_16x16x32_bf16 v[228:231], a[52:55], v[120:123], v[228:231]
  ds_read_b64 v[92:93], v39 offset:0
  v_mfma_f32_16x16x32_bf16 v[244:247], a[52:55], v[124:127], v[244:247]
  ds_read_b64 v[94:95], v39 offset:1088
  s_waitcnt vmcnt(20)
  v_mfma_f32_16x16x32_bf16 v[136:139], a[56:59], v[96:99], v[136:139]
  s_mov_b32 s29, 45056
  v_mfma_f32_16x16x32_bf16 v[152:155], a[56:59], v[100:103], v[152:155]
  buffer_load_dwordx4 a[48:51], v4, s[12:15], s29 offen offset:0
  v_mfma_f32_16x16x32_bf16 v[168:171], a[56:59], v[104:107], v[168:171]
  buffer_load_dwordx4 a[52:55], v4, s[12:15], s29 offen offset:1024
  v_mfma_f32_16x16x32_bf16 v[184:187], a[56:59], v[108:111], v[184:187]
  v_mfma_f32_16x16x32_bf16 v[200:203], a[56:59], v[112:115], v[200:203]
  v_mfma_f32_16x16x32_bf16 v[216:219], a[56:59], v[116:119], v[216:219]
  v_mfma_f32_16x16x32_bf16 v[232:235], a[56:59], v[120:123], v[232:235]
  v_mfma_f32_16x16x32_bf16 v[248:251], a[56:59], v[124:127], v[248:251]
  v_mfma_f32_16x16x32_bf16 v[140:143], a[60:63], v[96:99], v[140:143]
  buffer_load_dwordx4 a[56:59], v4, s[12:15], s29 offen offset:2048
  v_mfma_f32_16x16x32_bf16 v[156:159], a[60:63], v[100:103], v[156:159]
  s_add_u32 m0, s27, 34816
  v_mfma_f32_16x16x32_bf16 v[172:175], a[60:63], v[104:107], v[172:175]
  s_mov_b32 s28, 2129920
  v_mfma_f32_16x16x32_bf16 v[188:191], a[60:63], v[108:111], v[188:191]
  buffer_load_dwordx4 v3, s[8:11], s28 offen lds
  v_mfma_f32_16x16x32_bf16 v[204:207], a[60:63], v[112:115], v[204:207]
  v_mfma_f32_16x16x32_bf16 v[220:223], a[60:63], v[116:119], v[220:223]
  v_mfma_f32_16x16x32_bf16 v[236:239], a[60:63], v[120:123], v[236:239]
  v_mfma_f32_16x16x32_bf16 v[252:255], a[60:63], v[124:127], v[252:255]
  s_waitcnt lgkmcnt(0)
  s_waitcnt vmcnt(22)
  v_mfma_f32_16x16x32_bf16 v[128:131], a[0:3], v[64:67], v[128:131]
  ds_read_b64 v[96:97], v32 offset:8704
  buffer_load_dwordx2 v[16:17], v1, s[48:51], 0 offen sc1
  v_mfma_f32_16x16x32_bf16 v[144:147], a[0:3], v[68:71], v[144:147]
  ds_read_b64 v[98:99], v32 offset:9792
  v_mfma_f32_16x16x32_bf16 v[160:163], a[0:3], v[72:75], v[160:163]
  buffer_load_dwordx4 a[60:63], v4, s[12:15], s29 offen offset:3072
  v_mfma_f32_16x16x32_bf16 v[176:179], a[0:3], v[76:79], v[176:179]
  ds_read_b64 v[100:101], v33 offset:8704
  v_mfma_f32_16x16x32_bf16 v[192:195], a[0:3], v[80:83], v[192:195]
  ds_read_b64 v[102:103], v33 offset:9792
  ds_read_b64 v[104:105], v34 offset:8704
  v_mfma_f32_16x16x32_bf16 v[208:211], a[0:3], v[84:87], v[208:211]
  ds_read_b64 v[106:107], v34 offset:9792
  v_mfma_f32_16x16x32_bf16 v[224:227], a[0:3], v[88:91], v[224:227]
  ds_read_b64 v[108:109], v35 offset:8704
  v_mfma_f32_16x16x32_bf16 v[240:243], a[0:3], v[92:95], v[240:243]
  ds_read_b64 v[110:111], v35 offset:9792
  v_mfma_f32_16x16x32_bf16 v[132:135], a[4:7], v[64:67], v[132:135]
  ds_read_b64 v[112:113], v36 offset:8704
  s_mov_b32 s29, 49152
  v_mfma_f32_16x16x32_bf16 v[148:151], a[4:7], v[68:71], v[148:151]
  ds_read_b64 v[114:115], v36 offset:9792
  buffer_load_dwordx4 a[0:3], v4, s[12:15], s29 offen offset:0
  v_mfma_f32_16x16x32_bf16 v[164:167], a[4:7], v[72:75], v[164:167]
  ds_read_b64 v[116:117], v37 offset:8704
  v_mfma_f32_16x16x32_bf16 v[180:183], a[4:7], v[76:79], v[180:183]
  s_add_u32 m0, s27, 35904
  ds_read_b64 v[118:119], v37 offset:9792
  v_mfma_f32_16x16x32_bf16 v[196:199], a[4:7], v[80:83], v[196:199]
  s_mov_b32 s28, 2146560
  ds_read_b64 v[120:121], v38 offset:8704
  v_mfma_f32_16x16x32_bf16 v[212:215], a[4:7], v[84:87], v[212:215]
  buffer_load_dwordx4 v3, s[8:11], s28 offen lds
  v_mfma_f32_16x16x32_bf16 v[228:231], a[4:7], v[88:91], v[228:231]
  ds_read_b64 v[122:123], v38 offset:9792
  ds_read_b64 v[124:125], v39 offset:8704
  v_mfma_f32_16x16x32_bf16 v[244:247], a[4:7], v[92:95], v[244:247]
  ds_read_b64 v[126:127], v39 offset:9792
  s_waitcnt vmcnt(24)
  v_mfma_f32_16x16x32_bf16 v[136:139], a[8:11], v[64:67], v[136:139]
  buffer_load_dwordx4 a[4:7], v4, s[12:15], s29 offen offset:1024
  v_mfma_f32_16x16x32_bf16 v[152:155], a[8:11], v[68:71], v[152:155]
  s_add_u32 m0, s27, 43520
  v_mfma_f32_16x16x32_bf16 v[168:171], a[8:11], v[72:75], v[168:171]
  s_mov_b32 s28, 2263040
  v_mfma_f32_16x16x32_bf16 v[184:187], a[8:11], v[76:79], v[184:187]
  buffer_load_dwordx4 v3, s[8:11], s28 offen lds
  v_mfma_f32_16x16x32_bf16 v[200:203], a[8:11], v[80:83], v[200:203]
  v_mfma_f32_16x16x32_bf16 v[216:219], a[8:11], v[84:87], v[216:219]
  v_mfma_f32_16x16x32_bf16 v[232:235], a[8:11], v[88:91], v[232:235]
  v_mfma_f32_16x16x32_bf16 v[248:251], a[8:11], v[92:95], v[248:251]
  v_mfma_f32_16x16x32_bf16 v[140:143], a[12:15], v[64:67], v[140:143]
  buffer_load_dwordx4 a[8:11], v4, s[12:15], s29 offen offset:2048
  v_mfma_f32_16x16x32_bf16 v[156:159], a[12:15], v[68:71], v[156:159]
  s_add_u32 m0, s27, 44608
  v_mfma_f32_16x16x32_bf16 v[172:175], a[12:15], v[72:75], v[172:175]
  s_mov_b32 s28, 2279680
  v_mfma_f32_16x16x32_bf16 v[188:191], a[12:15], v[76:79], v[188:191]
  buffer_load_dwordx4 v3, s[8:11], s28 offen lds
  v_mfma_f32_16x16x32_bf16 v[204:207], a[12:15], v[80:83], v[204:207]
  v_mfma_f32_16x16x32_bf16 v[220:223], a[12:15], v[84:87], v[220:223]
  v_mfma_f32_16x16x32_bf16 v[236:239], a[12:15], v[88:91], v[236:239]
  v_mfma_f32_16x16x32_bf16 v[252:255], a[12:15], v[92:95], v[252:255]
  s_waitcnt lgkmcnt(0)
  s_waitcnt vmcnt(26)
  v_mfma_f32_16x16x32_bf16 v[128:131], a[16:19], v[96:99], v[128:131]
  ds_read_b64 v[64:65], v32 offset:17408
  buffer_load_dwordx4 a[12:15], v4, s[12:15], s29 offen offset:3072
  v_mfma_f32_16x16x32_bf16 v[144:147], a[16:19], v[100:103], v[144:147]
  ds_read_b64 v[66:67], v32 offset:18496
  v_mfma_f32_16x16x32_bf16 v[160:163], a[16:19], v[104:107], v[160:163]
  s_add_u32 m0, s27, 52224
  ds_read_b64 v[68:69], v33 offset:17408
  v_mfma_f32_16x16x32_bf16 v[176:179], a[16:19], v[108:111], v[176:179]
  s_mov_b32 s28, 2396160
  v_mfma_f32_16x16x32_bf16 v[192:195], a[16:19], v[112:115], v[192:195]
  ds_read_b64 v[70:71], v33 offset:18496
  buffer_load_dwordx4 v3, s[8:11], s28 offen lds
  v_mfma_f32_16x16x32_bf16 v[208:211], a[16:19], v[116:119], v[208:211]
  ds_read_b64 v[72:73], v34 offset:17408
  v_mfma_f32_16x16x32_bf16 v[224:227], a[16:19], v[120:123], v[224:227]
  ds_read_b64 v[74:75], v34 offset:18496
  ds_read_b64 v[76:77], v35 offset:17408
  v_mfma_f32_16x16x32_bf16 v[240:243], a[16:19], v[124:127], v[240:243]
  ds_read_b64 v[78:79], v35 offset:18496
  v_mfma_f32_16x16x32_bf16 v[132:135], a[20:23], v[96:99], v[132:135]
  ds_read_b64 v[80:81], v36 offset:17408
  s_mov_b32 s29, 53248
  v_mfma_f32_16x16x32_bf16 v[148:151], a[20:23], v[100:103], v[148:151]
  ds_read_b64 v[82:83], v36 offset:18496
  buffer_load_dwordx4 a[16:19], v4, s[12:15], s29 offen offset:0
  v_mfma_f32_16x16x32_bf16 v[164:167], a[20:23], v[104:107], v[164:167]
  ds_read_b64 v[84:85], v37 offset:17408
  v_mfma_f32_16x16x32_bf16 v[180:183], a[20:23], v[108:111], v[180:183]
  s_add_u32 m0, s27, 53312
  ds_read_b64 v[86:87], v37 offset:18496
  v_mfma_f32_16x16x32_bf16 v[196:199], a[20:23], v[112:115], v[196:199]
  s_mov_b32 s28, 2412800
  ds_read_b64 v[88:89], v38 offset:17408
  v_mfma_f32_16x16x32_bf16 v[212:215], a[20:23], v[116:119], v[212:215]
  buffer_load_dwordx4 v3, s[8:11], s28 offen lds
  v_mfma_f32_16x16x32_bf16 v[228:231], a[20:23], v[120:123], v[228:231]
  ds_read_b64 v[90:91], v38 offset:18496
  ds_read_b64 v[92:93], v39 offset:17408
  v_mfma_f32_16x16x32_bf16 v[244:247], a[20:23], v[124:127], v[244:247]
  ds_read_b64 v[94:95], v39 offset:18496
  s_waitcnt vmcnt(20)
  v_mfma_f32_16x16x32_bf16 v[136:139], a[24:27], v[96:99], v[136:139]
  buffer_load_dwordx4 a[20:23], v4, s[12:15], s29 offen offset:1024
  v_mfma_f32_16x16x32_bf16 v[152:155], a[24:27], v[100:103], v[152:155]
  s_add_u32 m0, s27, 60928
  v_mfma_f32_16x16x32_bf16 v[168:171], a[24:27], v[104:107], v[168:171]
  s_mov_b32 s28, 2529280
  v_mfma_f32_16x16x32_bf16 v[184:187], a[24:27], v[108:111], v[184:187]
  buffer_load_dwordx4 v3, s[8:11], s28 offen lds
  v_mfma_f32_16x16x32_bf16 v[200:203], a[24:27], v[112:115], v[200:203]
  v_mfma_f32_16x16x32_bf16 v[216:219], a[24:27], v[116:119], v[216:219]
  v_mfma_f32_16x16x32_bf16 v[232:235], a[24:27], v[120:123], v[232:235]
  v_mfma_f32_16x16x32_bf16 v[248:251], a[24:27], v[124:127], v[248:251]
  v_mfma_f32_16x16x32_bf16 v[140:143], a[28:31], v[96:99], v[140:143]
  buffer_load_dwordx4 a[24:27], v4, s[12:15], s29 offen offset:2048
  v_mfma_f32_16x16x32_bf16 v[156:159], a[28:31], v[100:103], v[156:159]
  s_add_u32 m0, s27, 62016
  v_mfma_f32_16x16x32_bf16 v[172:175], a[28:31], v[104:107], v[172:175]
  s_mov_b32 s28, 2545920
  v_mfma_f32_16x16x32_bf16 v[188:191], a[28:31], v[108:111], v[188:191]
  buffer_load_dwordx4 v3, s[8:11], s28 offen lds
  v_mfma_f32_16x16x32_bf16 v[204:207], a[28:31], v[112:115], v[204:207]
  v_mfma_f32_16x16x32_bf16 v[220:223], a[28:31], v[116:119], v[220:223]
  v_mfma_f32_16x16x32_bf16 v[236:239], a[28:31], v[120:123], v[236:239]
  v_mfma_f32_16x16x32_bf16 v[252:255], a[28:31], v[124:127], v[252:255]
  s_waitcnt lgkmcnt(0)
  s_waitcnt vmcnt(22)
  v_mfma_f32_16x16x32_bf16 v[128:131], a[32:35], v[64:67], v[128:131]
  ds_read_b64 v[96:97], v32 offset:26112
  buffer_load_dwordx4 a[28:31], v4, s[12:15], s29 offen offset:3072
  v_mfma_f32_16x16x32_bf16 v[144:147], a[32:35], v[68:71], v[144:147]
  ds_read_b64 v[98:99], v32 offset:27200
  v_mfma_f32_16x16x32_bf16 v[160:163], a[32:35], v[72:75], v[160:163]
  s_add_u32 s63, s65, 0
  ds_read_b64 v[100:101], v33 offset:26112
  v_mfma_f32_16x16x32_bf16 v[176:179], a[32:35], v[76:79], v[176:179]
  buffer_load_dwordx4 a[64:67], v2, s[56:59], s63 offen
  v_mfma_f32_16x16x32_bf16 v[192:195], a[32:35], v[80:83], v[192:195]
  ds_read_b64 v[102:103], v33 offset:27200
  v_mfma_f32_16x16x32_bf16 v[208:211], a[32:35], v[84:87], v[208:211]
  ds_read_b64 v[104:105], v34 offset:26112
  ds_read_b64 v[106:107], v34 offset:27200
  v_mfma_f32_16x16x32_bf16 v[224:227], a[32:35], v[88:91], v[224:227]
  ds_read_b64 v[108:109], v35 offset:26112
  v_mfma_f32_16x16x32_bf16 v[240:243], a[32:35], v[92:95], v[240:243]
  ds_read_b64 v[110:111], v35 offset:27200
  v_mfma_f32_16x16x32_bf16 v[132:135], a[36:39], v[64:67], v[132:135]
  ds_read_b64 v[112:113], v36 offset:26112
  s_mov_b32 s29, 57344
  v_mfma_f32_16x16x32_bf16 v[148:151], a[36:39], v[68:71], v[148:151]
  ds_read_b64 v[114:115], v36 offset:27200
  v_mfma_f32_16x16x32_bf16 v[164:167], a[36:39], v[72:75], v[164:167]
  buffer_load_dwordx4 a[32:35], v4, s[12:15], s29 offen offset:0
  ds_read_b64 v[116:117], v37 offset:26112
  v_mfma_f32_16x16x32_bf16 v[180:183], a[36:39], v[76:79], v[180:183]
  s_add_u32 s63, s65, 55296
  v_mfma_f32_16x16x32_bf16 v[196:199], a[36:39], v[80:83], v[196:199]
  ds_read_b64 v[118:119], v37 offset:27200
  buffer_load_dwordx4 a[68:71], v2, s[56:59], s63 offen
  v_mfma_f32_16x16x32_bf16 v[212:215], a[36:39], v[84:87], v[212:215]
  ds_read_b64 v[120:121], v38 offset:26112
  v_mfma_f32_16x16x32_bf16 v[228:231], a[36:39], v[88:91], v[228:231]
  ds_read_b64 v[122:123], v38 offset:27200
  ds_read_b64 v[124:125], v39 offset:26112
  v_mfma_f32_16x16x32_bf16 v[244:247], a[36:39], v[92:95], v[244:247]
  ds_read_b64 v[126:127], v39 offset:27200
  s_waitcnt vmcnt(24)
  v_mfma_f32_16x16x32_bf16 v[136:139], a[40:43], v[64:67], v[136:139]
  buffer_load_dwordx4 a[36:39], v4, s[12:15], s29 offen offset:1024
  v_mfma_f32_16x16x32_bf16 v[152:155], a[40:43], v[68:71], v[152:155]
  s_add_u32 s63, s65, 110592
  v_mfma_f32_16x16x32_bf16 v[168:171], a[40:43], v[72:75], v[168:171]
  buffer_load_dwordx4 a[72:75], v2, s[56:59], s63 offen
  v_mfma_f32_16x16x32_bf16 v[184:187], a[40:43], v[76:79], v[184:187]
  v_mfma_f32_16x16x32_bf16 v[200:203], a[40:43], v[80:83], v[200:203]
  v_mfma_f32_16x16x32_bf16 v[216:219], a[40:43], v[84:87], v[216:219]
  v_mfma_f32_16x16x32_bf16 v[232:235], a[40:43], v[88:91], v[232:235]
  v_mfma_f32_16x16x32_bf16 v[248:251], a[40:43], v[92:95], v[248:251]
  v_mfma_f32_16x16x32_bf16 v[140:143], a[44:47], v[64:67], v[140:143]
  buffer_load_dwordx4 a[40:43], v4, s[12:15], s29 offen offset:2048
  v_mfma_f32_16x16x32_bf16 v[156:159], a[44:47], v[68:71], v[156:159]
  s_add_u32 s63, s65, 165888
  v_mfma_f32_16x16x32_bf16 v[172:175], a[44:47], v[72:75], v[172:175]
  buffer_load_dwordx4 a[76:79], v2, s[56:59], s63 offen
  v_mfma_f32_16x16x32_bf16 v[188:191], a[44:47], v[76:79], v[188:191]
  v_mfma_f32_16x16x32_bf16 v[204:207], a[44:47], v[80:83], v[204:207]
  v_mfma_f32_16x16x32_bf16 v[220:223], a[44:47], v[84:87], v[220:223]
  v_mfma_f32_16x16x32_bf16 v[236:239], a[44:47], v[88:91], v[236:239]
  v_mfma_f32_16x16x32_bf16 v[252:255], a[44:47], v[92:95], v[252:255]
  s_waitcnt lgkmcnt(0)
  s_waitcnt vmcnt(33)
  s_barrier
  s_waitcnt vmcnt(23)
  v_min_u32 v16, v16, v17
  s_mov_b32 s34, 100000
  v_readfirstlane_b32 s35, v16
  s_nop 2
  s_cmp_lg_u32 s35, 0
  s_cbranch_scc1 L_k3_kernel_flagok_1
L_k3_kernel_spin_2:
  s_sleep 8
  buffer_load_dwordx2 v[16:17], v1, s[48:51], 0 offen sc1
  s_waitcnt vmcnt(0)
  v_min_u32 v16, v16, v17
  s_sub_u32 s34, s34, 1
  v_readfirstlane_b32 s35, v16
  s_cmp_eq_u32 s34, 0
  s_nop 1
  s_cselect_b32 s35, 1, s35
  s_cmp_eq_u32 s35, 0
  s_cbranch_scc1 L_k3_kernel_spin_2
L_k3_kernel_flagok_1:
  s_waitcnt vmcnt(26)
  v_mfma_f32_16x16x32_bf16 v[128:131], a[48:51], v[96:99], v[128:131]
  ds_read_b64 v[64:65], v8 offset:0
  buffer_load_dwordx4 a[44:47], v4, s[12:15], s29 offen offset:3072
  v_mfma_f32_16x16x32_bf16 v[144:147], a[48:51], v[100:103], v[144:147]
  ds_read_b64 v[66:67], v8 offset:1088
  v_mfma_f32_16x16x32_bf16 v[160:163], a[48:51], v[104:107], v[160:163]
  v_sub_u32 v1, v8, v7
  ds_read_b64 v[68:69], v9 offset:0
  v_mfma_f32_16x16x32_bf16 v[176:179], a[48:51], v[108:111], v[176:179]
  buffer_load_dwordx2 v[16:17], v1, s[52:55], 0 offen sc1
  v_mfma_f32_16x16x32_bf16 v[192:195], a[48:51], v[112:115], v[192:195]
  ds_read_b64 v[70:71], v9 offset:1088
  v_mfma_f32_16x16x32_bf16 v[208:211], a[48:51], v[116:119], v[208:211]
  ds_read_b64 v[72:73], v10 offset:0
  ds_read_b64 v[74:75], v10 offset:1088
  v_mfma_f32_16x16x32_bf16 v[224:227], a[48:51], v[120:123], v[224:227]
  ds_read_b64 v[76:77], v11 offset:0
  v_mfma_f32_16x16x32_bf16 v[240:243], a[48:51], v[124:127], v[240:243]
  ds_read_b64 v[78:79], v11 offset:1088
  v_mfma_f32_16x16x32_bf16 v[132:135], a[52:55], v[96:99], v[132:135]
  ds_read_b64 v[80:81], v12 offset:0
  s_mov_b32 s29, 61440
  v_mfma_f32_16x16x32_bf16 v[148:151], a[52:55], v[100:103], v[148:151]
  ds_read_b64 v[82:83], v12 offset:1088
  v_mfma_f32_16x16x32_bf16 v[164:167], a[52:55], v[104:107], v[164:167]
  buffer_load_dwordx4 a[48:51], v4, s[12:15], s29 offen offset:0
  ds_read_b64 v[84:85], v13 offset:0
  v_mfma_f32_16x16x32_bf16 v[180:183], a[52:55], v[108:111], v[180:183]
  v_sub_u32 v1, v9, v7
  v_mfma_f32_16x16x32_bf16 v[196:199], a[52:55], v[112:115], v[196:199]
  ds_read_b64 v[86:87], v13 offset:1088
  buffer_load_dwordx2 v[18:19], v1, s[52:55], 0 offen sc1
  v_mfma_f32_16x16x32_bf16 v[212:215], a[52:55], v[116:119], v[212:215]
  ds_read_b64 v[88:89], v14 offset:0
  v_mfma_f32_16x16x32_bf16 v[228:231], a[52:55], v[120:123], v[228:231]
  ds_read_b64 v[90:91], v14 offset:1088
  ds_read_b64 v[92:93], v15 offset:0
  v_mfma_f32_16x16x32_bf16 v[244:247], a[52:55], v[124:127], v[244:247]
  ds_read_b64 v[94:95], v15 offset:1088
  s_waitcnt vmcnt(26)
  v_mfma_f32_16x16x32_bf16 v[136:139], a[56:59], v[96:99], v[136:139]
  buffer_load_dwordx4 a[52:55], v4, s[12:15], s29 offen offset:1024
  v_mfma_f32_16x16x32_bf16 v[152:155], a[56:59], v[100:103], v[152:155]
  v_sub_u32 v1, v10, v7
  v_mfma_f32_16x16x32_bf16 v[168:171], a[56:59], v[104:107], v[168:171]
  buffer_load_dwordx2 v[20:21], v1, s[52:55], 0 offen sc1
  v_mfma_f32_16x16x32_bf16 v[184:187], a[56:59], v[108:111], v[184:187]
  v_mfma_f32_16x16x32_bf16 v[200:203], a[56:59], v[112:115], v[200:203]
  v_mfma_f32_16x16x32_bf16 v[216:219], a[56:59], v[116:119], v[216:219]
  v_mfma_f32_16x16x32_bf16 v[232:235], a[56:59], v[120:123], v[232:235]
  v_mfma_f32_16x16x32_bf16 v[248:251], a[56:59], v[124:127], v[248:251]
  v_mfma_f32_16x16x32_bf16 v[140:143], a[60:63], v[96:99], v[140:143]
  buffer_load_dwordx4 a[56:59], v4, s[12:15], s29 offen offset:2048
  v_mfma_f32_16x16x32_bf16 v[156:159], a[60:63], v[100:103], v[156:159]
  v_sub_u32 v1, v11, v7
  v_mfma_f32_16x16x32_bf16 v[172:175], a[60:63], v[104:107], v[172:175]
  buffer_load_dwordx2 v[22:23], v1, s[52:55], 0 offen sc1
  v_mfma_f32_16x16x32_bf16 v[188:191], a[60:63], v[108:111], v[188:191]
  v_mfma_f32_16x16x32_bf16 v[204:207], a[60:63], v[112:115], v[204:207]
  v_mfma_f32_16x16x32_bf16 v[220:223], a[60:63], v[116:119], v[220:223]
  v_mfma_f32_16x16x32_bf16 v[236:239], a[60:63], v[120:123], v[236:239]
  v_mfma_f32_16x16x32_bf16 v[252:255], a[60:63], v[124:127], v[252:255]
  s_waitcnt lgkmcnt(0)
  s_waitcnt vmcnt(27)
  v_mfma_f32_16x16x32_bf16 v[128:131], a[0:3], v[64:67], v[128:131]
  ds_read_b64 v[96:97], v8 offset:8704
  buffer_load_dwordx4 a[60:63], v4, s[12:15], s29 offen offset:3072
  v_mfma_f32_16x16x32_bf16 v[144:147], a[0:3], v[68:71], v[144:147]
  ds_read_b64 v[98:99], v8 offset:9792
  v_mfma_f32_16x16x32_bf16 v[160:163], a[0:3], v[72:75], v[160:163]
  v_sub_u32 v1, v12, v7
  ds_read_b64 v[100:101], v9 offset:8704
  v_mfma_f32_16x16x32_bf16 v[176:179], a[0:3], v[76:79], v[176:179]
  buffer_load_dwordx2 v[24:25], v1, s[52:55], 0 offen sc1
  v_mfma_f32_16x16x32_bf16 v[192:195], a[0:3], v[80:83], v[192:195]
  ds_read_b64 v[102:103], v9 offset:9792
  v_mfma_f32_16x16x32_bf16 v[208:211], a[0:3], v[84:87], v[208:211]
  ds_read_b64 v[104:105], v10 offset:8704
  ds_read_b64 v[106:107], v10 offset:9792
  v_mfma_f32_16x16x32_bf16 v[224:227], a[0:3], v[88:91], v[224:227]
  ds_read_b64 v[108:109], v11 offset:8704
  v_mfma_f32_16x16x32_bf16 v[240:243], a[0:3], v[92:95], v[240:243]
  ds_read_b64 v[110:111], v11 offset:9792
  v_mfma_f32_16x16x32_bf16 v[132:135], a[4:7], v[64:67], v[132:135]
  ds_read_b64 v[112:113], v12 offset:8704
  s_mov_b32 s29, 65536
  v_mfma_f32_16x16x32_bf16 v[148:151], a[4:7], v[68:71], v[148:151]
  ds_read_b64 v[114:115], v12 offset:9792
  v_mfma_f32_16x16x32_bf16 v[164:167], a[4:7], v[72:75], v[164:167]
  buffer_load_dwordx4 a[0:3], v4, s[12:15], s29 offen offset:0
  ds_read_b64 v[116:117], v13 offset:8704
  v_mfma_f32_16x16x32_bf16 v[180:183], a[4:7], v[76:79], v[180:183]
  v_sub_u32 v1, v13, v7
  v_mfma_f32_16x16x32_bf16 v[196:199], a[4:7], v[80:83], v[196:199]
  ds_read_b64 v[118:119], v13 offset:9792
  buffer_load_dwordx2 v[26:27], v1, s[52:55], 0 offen sc1
  v_mfma_f32_16x16x32_bf16 v[212:215], a[4:7], v[84:87], v[212:215]
  ds_read_b64 v[120:121], v14 offset:8704
  v_mfma_f32_16x16x32_bf16 v[228:231], a[4:7], v[88:91], v[228:231]
  ds_read_b64 v[122:123], v14 offset:9792
  ds_read_b64 v[124:125], v15 offset:8704
  v_mfma_f32_16x16x32_bf16 v[244:247], a[4:7], v[92:95], v[244:247]
  ds_read_b64 v[126:127], v15 offset:9792
  s_waitcnt vmcnt(27)
  v_mfma_f32_16x16x32_bf16 v[136:139], a[8:11], v[64:67], v[136:139]
  v_sub_u32 v1, v14, v7
  v_mfma_f32_16x16x32_bf16 v[152:155], a[8:11], v[68:71], v[152:155]
  buffer_load_dwordx2 v[28:29], v1, s[52:55], 0 offen sc1
  v_mfma_f32_16x16x32_bf16 v[168:171], a[8:11], v[72:75], v[168:171]
  v_sub_u32 v1, v15, v7
  v_mfma_f32_16x16x32_bf16 v[184:187], a[8:11], v[76:79], v[184:187]
  buffer_load_dwordx2 v[30:31], v1, s[52:55], 0 offen sc1
  v_mfma_f32_16x16x32_bf16 v[200:203], a[8:11], v[80:83], v[200:203]
  v_mfma_f32_16x16x32_bf16 v[216:219], a[8:11], v[84:87], v[216:219]
  v_mfma_f32_16x16x32_bf16 v[232:235], a[8:11], v[88:91], v[232:235]
  v_mfma_f32_16x16x32_bf16 v[248:251], a[8:11], v[92:95], v[248:251]
  v_mfma_f32_16x16x32_bf16 v[140:143], a[12:15], v[64:67], v[140:143]
  buffer_load_dwordx4 a[4:7], v4, s[12:15], s29 offen offset:1024
  v_mfma_f32_16x16x32_bf16 v[156:159], a[12:15], v[68:71], v[156:159]
  buffer_load_dwordx4 a[8:11], v4, s[12:15], s29 offen offset:2048
  v_mfma_f32_16x16x32_bf16 v[172:175], a[12:15], v[72:75], v[172:175]
  v_mfma_f32_16x16x32_bf16 v[188:191], a[12:15], v[76:79], v[188:191]
  v_mfma_f32_16x16x32_bf16 v[204:207], a[12:15], v[80:83], v[204:207]
  v_mfma_f32_16x16x32_bf16 v[220:223], a[12:15], v[84:87], v[220:223]
  v_mfma_f32_16x16x32_bf16 v[236:239], a[12:15], v[88:91], v[236:239]
  v_mfma_f32_16x16x32_bf16 v[252:255], a[12:15], v[92:95], v[252:255]
  s_waitcnt lgkmcnt(0)
  s_waitcnt vmcnt(27)
  v_mfma_f32_16x16x32_bf16 v[128:131], a[16:19], v[96:99], v[128:131]
  ds_read_b64 v[64:65], v8 offset:17408
  buffer_load_dwordx4 a[12:15], v4, s[12:15], s29 offen offset:3072
  v_mfma_f32_16x16x32_bf16 v[144:147], a[16:19], v[100:103], v[144:147]
  ds_read_b64 v[66:67], v8 offset:18496
  v_mfma_f32_16x16x32_bf16 v[160:163], a[16:19], v[104:107], v[160:163]
  s_mov_b32 s33, 0
  ds_read_b64 v[68:69], v9 offset:17408
  v_mfma_f32_16x16x32_bf16 v[176:179], a[16:19], v[108:111], v[176:179]
  buffer_load_dwordx4 v[32:35], v0, s[44:47], s33 offen
  v_mfma_f32_16x16x32_bf16 v[192:195], a[16:19], v[112:115], v[192:195]
  ds_read_b64 v[70:71], v9 offset:18496
  v_mfma_f32_16x16x32_bf16 v[208:211], a[16:19], v[116:119], v[208:211]
  ds_read_b64 v[72:73], v10 offset:17408
  ds_read_b64 v[74:75], v10 offset:18496
  v_mfma_f32_16x16x32_bf16 v[224:227], a[16:19], v[120:123], v[224:227]
  ds_read_b64 v[76:77], v11 offset:17408
  v_mfma_f32_16x16x32_bf16 v[240:243], a[16:19], v[124:127], v[240:243]
  ds_read_b64 v[78:79], v11 offset:18496
  v_mfma_f32_16x16x32_bf16 v[132:135], a[20:23], v[96:99], v[132:135]
  ds_read_b64 v[80:81], v12 offset:17408
  s_mov_b32 s29, 69632
  v_mfma_f32_16x16x32_bf16 v[148:151], a[20:23], v[100:103], v[148:151]
  ds_read_b64 v[82:83], v12 offset:18496
  v_mfma_f32_16x16x32_bf16 v[164:167], a[20:23], v[104:107], v[164:167]
  buffer_load_dwordx4 a[16:19], v4, s[12:15], s29 offen offset:0
  ds_read_b64 v[84:85], v13 offset:17408
  v_mfma_f32_16x16x32_bf16 v[180:183], a[20:23], v[108:111], v[180:183]
  s_mov_b32 s33, 13824
  v_mfma_f32_16x16x32_bf16 v[196:199], a[20:23], v[112:115], v[196:199]
  ds_read_b64 v[86:87], v13 offset:18496
  buffer_load_dwordx4 v[48:51], v0, s[44:47], s33 offen
  v_mfma_f32_16x16x32_bf16 v[212:215], a[20:23], v[116:119], v[212:215]
  ds_read_b64 v[88:89], v14 offset:17408
  v_mfma_f32_16x16x32_bf16 v[228:231], a[20:23], v[120:123], v[228:231]
  ds_read_b64 v[90:91], v14 offset:18496
  ds_read_b64 v[92:93], v15 offset:17408
  v_mfma_f32_16x16x32_bf16 v[244:247], a[20:23], v[124:127], v[244:247]
  ds_read_b64 v[94:95], v15 offset:18496
  s_waitcnt vmcnt(27)
  v_mfma_f32_16x16x32_bf16 v[136:139], a[24:27], v[96:99], v[136:139]
  buffer_load_dwordx4 a[20:23], v4, s[12:15], s29 offen offset:1024
  v_mfma_f32_16x16x32_bf16 v[152:155], a[24:27], v[100:103], v[152:155]
  s_mov_b32 s33, 6912
  v_mfma_f32_16x16x32_bf16 v[168:171], a[24:27], v[104:107], v[168:171]
  buffer_load_dwordx4 v[36:39], v0, s[44:47], s33 offen
  v_mfma_f32_16x16x32_bf16 v[184:187], a[24:27], v[108:111], v[184:187]
  v_mfma_f32_16x16x32_bf16 v[200:203], a[24:27], v[112:115], v[200:203]
  v_mfma_f32_16x16x32_bf16 v[216:219], a[24:27], v[116:119], v[216:219]
  v_mfma_f32_16x16x32_bf16 v[232:235], a[24:27], v[120:123], v[232:235]
  v_mfma_f32_16x16x32_bf16 v[248:251], a[24:27], v[124:127], v[248:251]
  v_mfma_f32_16x16x32_bf16 v[140:143], a[28:31], v[96:99], v[140:143]
  buffer_load_dwordx4 a[24:27], v4, s[12:15], s29 offen offset:2048
  v_mfma_f32_16x16x32_bf16 v[156:159], a[28:31], v[100:103], v[156:159]
  s_mov_b32 s33, 20736
  v_mfma_f32_16x16x32_bf16 v[172:175], a[28:31], v[104:107], v[172:175]
  buffer_load_dwordx4 v[52:55], v0, s[44:47], s33 offen
  v_mfma_f32_16x16x32_bf16 v[188:191], a[28:31], v[108:111], v[188:191]
  v_mfma_f32_16x16x32_bf16 v[204:207], a[28:31], v[112:115], v[204:207]
  v_mfma_f32_16x16x32_bf16 v[220:223], a[28:31], v[116:119], v[220:223]
  v_mfma_f32_16x16x32_bf16 v[236:239], a[28:31], v[120:123], v[236:239]
  v_mfma_f32_16x16x32_bf16 v[252:255], a[28:31], v[124:127], v[252:255]
  s_waitcnt lgkmcnt(0)
  s_waitcnt vmcnt(27)
  v_mfma_f32_16x16x32_bf16 v[128:131], a[32:35], v[64:67], v[128:131]
  ds_read_b64 v[96:97], v8 offset:26112
  buffer_load_dwordx4 a[28:31], v4, s[12:15], s29 offen offset:3072
  v_mfma_f32_16x16x32_bf16 v[144:147], a[32:35], v[68:71], v[144:147]
  ds_read_b64 v[98:99], v8 offset:27200
  v_mfma_f32_16x16x32_bf16 v[160:163], a[32:35], v[72:75], v[160:163]
  s_mov_b32 s33, 64
  ds_read_b64 v[100:101], v9 offset:26112
  v_mfma_f32_16x16x32_bf16 v[176:179], a[32:35], v[76:79], v[176:179]
  buffer_load_dwordx4 v[40:43], v0, s[44:47], s33 offen
  v_mfma_f32_16x16x32_bf16 v[192:195], a[32:35], v[80:83], v[192:195]
  ds_read_b64 v[102:103], v9 offset:27200
  v_mfma_f32_16x16x32_bf16 v[208:211], a[32:35], v[84:87], v[208:211]
  ds_read_b64 v[104:105], v10 offset:26112
  ds_read_b64 v[106:107], v10 offset:27200
  v_mfma_f32_16x16x32_bf16 v[224:227], a[32:35], v[88:91], v[224:227]
  ds_read_b64 v[108:109], v11 offset:26112
  v_mfma_f32_16x16x32_bf16 v[240:243], a[32:35], v[92:95], v[240:243]
  ds_read_b64 v[110:111], v11 offset:27200
  v_mfma_f32_16x16x32_bf16 v[132:135], a[36:39], v[64:67], v[132:135]
  ds_read_b64 v[112:113], v12 offset:26112
  s_mov_b32 s29, 73728
  v_mfma_f32_16x16x32_bf16 v[148:151], a[36:39], v[68:71], v[148:151]
  ds_read_b64 v[114:115], v12 offset:27200
  v_mfma_f32_16x16x32_bf16 v[164:167], a[36:39], v[72:75], v[164:167]
  buffer_load_dwordx4 a[32:35], v4, s[12:15], s29 offen offset:0
  ds_read_b64 v[116:117], v13 offset:26112
  v_mfma_f32_16x16x32_bf16 v[180:183], a[36:39], v[76:79], v[180:183]
  s_mov_b32 s33, 13888
  v_mfma_f32_16x16x32_bf16 v[196:199], a[36:39], v[80:83], v[196:199]
  ds_read_b64 v[118:119], v13 offset:27200
  buffer_load_dwordx4 v[56:59], v0, s[44:47], s33 offen
  v_mfma_f32_16x16x32_bf16 v[212:215], a[36:39], v[84:87], v[212:215]
  ds_read_b64 v[120:121], v14 offset:26112
  v_mfma_f32_16x16x32_bf16 v[228:231], a[36:39], v[88:91], v[228:231]
  ds_read_b64 v[122:123], v14 offset:27200
  ds_read_b64 v[124:125], v15 offset:26112
  v_mfma_f32_16x16x32_bf16 v[244:247], a[36:39], v[92:95], v[244:247]
  ds_read_b64 v[126:127], v15 offset:27200
  s_waitcnt vmcnt(27)
  v_mfma_f32_16x16x32_bf16 v[136:139], a[40:43], v[64:67], v[136:139]
  s_mov_b32 s33, 6976
  v_mfma_f32_16x16x32_bf16 v[152:155], a[40:43], v[68:71], v[152:155]
  buffer_load_dwordx4 v[44:47], v0, s[44:47], s33 offen
  v_mfma_f32_16x16x32_bf16 v[168:171], a[40:43], v[72:75], v[168:171]
  s_mov_b32 s33, 20800
  v_mfma_f32_16x16x32_bf16 v[184:187], a[40:43], v[76:79], v[184:187]
  buffer_load_dwordx4 v[60:63], v0, s[44:47], s33 offen
  v_mfma_f32_16x16x32_bf16 v[200:203], a[40:43], v[80:83], v[200:203]
  v_mfma_f32_16x16x32_bf16 v[216:219], a[40:43], v[84:87], v[216:219]
  v_mfma_f32_16x16x32_bf16 v[232:235], a[40:43], v[88:91], v[232:235]
  v_mfma_f32_16x16x32_bf16 v[248:251], a[40:43], v[92:95], v[248:251]
  v_mfma_f32_16x16x32_bf16 v[140:143], a[44:47], v[64:67], v[140:143]
  buffer_load_dwordx4 a[36:39], v4, s[12:15], s29 offen offset:1024
  v_mfma_f32_16x16x32_bf16 v[156:159], a[44:47], v[68:71], v[156:159]
  buffer_load_dwordx4 a[40:43], v4, s[12:15], s29 offen offset:2048
  v_mfma_f32_16x16x32_bf16 v[172:175], a[44:47], v[72:75], v[172:175]
  v_mfma_f32_16x16x32_bf16 v[188:191], a[44:47], v[76:79], v[188:191]
  v_mfma_f32_16x16x32_bf16 v[204:207], a[44:47], v[80:83], v[204:207]
  v_mfma_f32_16x16x32_bf16 v[220:223], a[44:47], v[84:87], v[220:223]
  v_mfma_f32_16x16x32_bf16 v[236:239], a[44:47], v[88:91], v[236:239]
  v_mfma_f32_16x16x32_bf16 v[252:255], a[44:47], v[92:95], v[252:255]
  s_waitcnt lgkmcnt(0)
  s_waitcnt vmcnt(40)
  s_barrier
  s_waitcnt vmcnt(27)
  v_mfma_f32_16x16x32_bf16 v[128:131], a[48:51], v[96:99], v[128:131]
  ds_read_b64 v[64:65], v8 offset:34816
  buffer_load_dwordx4 a[44:47], v4, s[12:15], s29 offen offset:3072
  v_mfma_f32_16x16x32_bf16 v[144:147], a[48:51], v[100:103], v[144:147]
  ds_read_b64 v[66:67], v8 offset:35904
  v_mfma_f32_16x16x32_bf16 v[160:163], a[48:51], v[104:107], v[160:163]
  s_add_u32 s63, s65, 221184
  ds_read_b64 v[68:69], v9 offset:34816
  v_mfma_f32_16x16x32_bf16 v[176:179], a[48:51], v[108:111], v[176:179]
  buffer_load_dwordx4 a[80:83], v2, s[56:59], s63 offen
  v_mfma_f32_16x16x32_bf16 v[192:195], a[48:51], v[112:115], v[192:195]
  ds_read_b64 v[70:71], v9 offset:35904
  v_mfma_f32_16x16x32_bf16 v[208:211], a[48:51], v[116:119], v[208:211]
  ds_read_b64 v[72:73], v10 offset:34816
  ds_read_b64 v[74:75], v10 offset:35904
  v_mfma_f32_16x16x32_bf16 v[224:227], a[48:51], v[120:123], v[224:227]
  ds_read_b64 v[76:77], v11 offset:34816
  v_mfma_f32_16x16x32_bf16 v[240:243], a[48:51], v[124:127], v[240:243]
  ds_read_b64 v[78:79], v11 offset:35904
  v_mfma_f32_16x16x32_bf16 v[132:135], a[52:55], v[96:99], v[132:135]
  ds_read_b64 v[80:81], v12 offset:34816
  s_mov_b32 s29, 77824
  v_mfma_f32_16x16x32_bf16 v[148:151], a[52:55], v[100:103], v[148:151]
  ds_read_b64 v[82:83], v12 offset:35904
  v_mfma_f32_16x16x32_bf16 v[164:167], a[52:55], v[104:107], v[164:167]
  buffer_load_dwordx4 a[48:51], v4, s[12:15], s29 offen offset:0
  ds_read_b64 v[84:85], v13 offset:34816
  v_mfma_f32_16x16x32_bf16 v[180:183], a[52:55], v[108:111], v[180:183]
  s_add_u32 s63, s65, 1024
  v_mfma_f32_16x16x32_bf16 v[196:199], a[52:55], v[112:115], v[196:199]
  ds_read_b64 v[86:87], v13 offset:35904
  buffer_load_dwordx4 a[84:87], v2, s[56:59], s63 offen
  v_mfma_f32_16x16x32_bf16 v[212:215], a[52:55], v[116:119], v[212:215]
  ds_read_b64 v[88:89], v14 offset:34816
  v_mfma_f32_16x16x32_bf16 v[228:231], a[52:55], v[120:123], v[228:231]
  ds_read_b64 v[90:91], v14 offset:35904
  ds_read_b64 v[92:93], v15 offset:34816
  v_mfma_f32_16x16x32_bf16 v[244:247], a[52:55], v[124:127], v[244:247]
  ds_read_b64 v[94:95], v15 offset:35904
  s_waitcnt vmcnt(27)
  v_mfma_f32_16x16x32_bf16 v[136:139], a[56:59], v[96:99], v[136:139]
  buffer_load_dwordx4 a[52:55], v4, s[12:15], s29 offen offset:1024
  v_mfma_f32_16x16x32_bf16 v[152:155], a[56:59], v[100:103], v[152:155]
  s_add_u32 s63, s65, 56320
  v_mfma_f32_16x16x32_bf16 v[168:171], a[56:59], v[104:107], v[168:171]
  buffer_load_dwordx4 a[88:91], v2, s[56:59], s63 offen
  v_mfma_f32_16x16x32_bf16 v[184:187], a[56:59], v[108:111], v[184:187]
  v_mfma_f32_16x16x32_bf16 v[200:203], a[56:59], v[112:115], v[200:203]
  v_mfma_f32_16x16x32_bf16 v[216:219], a[56:59], v[116:119], v[216:219]
  v_mfma_f32_16x16x32_bf16 v[232:235], a[56:59], v[120:123], v[232:235]
  v_mfma_f32_16x16x32_bf16 v[248:251], a[56:59], v[124:127], v[248:251]
  v_mfma_f32_16x16x32_bf16 v[140:143], a[60:63], v[96:99], v[140:143]
  buffer_load_dwordx4 a[56:59], v4, s[12:15], s29 offen offset:2048
  v_mfma_f32_16x16x32_bf16 v[156:159], a[60:63], v[100:103], v[156:159]
  s_add_u32 s63, s65, 111616
  v_mfma_f32_16x16x32_bf16 v[172:175], a[60:63], v[104:107], v[172:175]
  buffer_load_dwordx4 a[92:95], v2, s[56:59], s63 offen
  v_mfma_f32_16x16x32_bf16 v[188:191], a[60:63], v[108:111], v[188:191]
  v_mfma_f32_16x16x32_bf16 v[204:207], a[60:63], v[112:115], v[204:207]
  v_mfma_f32_16x16x32_bf16 v[220:223], a[60:63], v[116:119], v[220:223]
  v_mfma_f32_16x16x32_bf16 v[236:239], a[60:63], v[120:123], v[236:239]
  v_mfma_f32_16x16x32_bf16 v[252:255], a[60:63], v[124:127], v[252:255]
  s_waitcnt lgkmcnt(0)
  s_waitcnt vmcnt(25)
  v_mfma_f32_16x16x32_bf16 v[128:131], a[0:3], v[64:67], v[128:131]
  ds_read_b64 v[96:97], v8 offset:43520
  buffer_load_dwordx4 a[60:63], v4, s[12:15], s29 offen offset:3072
  v_mfma_f32_16x16x32_bf16 v[144:147], a[0:3], v[68:71], v[144:147]
  ds_read_b64 v[98:99], v8 offset:44608
  v_mfma_f32_16x16x32_bf16 v[160:163], a[0:3], v[72:75], v[160:163]
  s_add_u32 s63, s65, 166912
  ds_read_b64 v[100:101], v9 offset:43520
  v_mfma_f32_16x16x32_bf16 v[176:179], a[0:3], v[76:79], v[176:179]
  buffer_load_dwordx4 a[96:99], v2, s[56:59], s63 offen
  v_mfma_f32_16x16x32_bf16 v[192:195], a[0:3], v[80:83], v[192:195]
  ds_read_b64 v[102:103], v9 offset:44608
  v_mfma_f32_16x16x32_bf16 v[208:211], a[0:3], v[84:87], v[208:211]
  ds_read_b64 v[104:105], v10 offset:43520
  ds_read_b64 v[106:107], v10 offset:44608
  v_mfma_f32_16x16x32_bf16 v[224:227], a[0:3], v[88:91], v[224:227]
  ds_read_b64 v[108:109], v11 offset:43520
  v_mfma_f32_16x16x32_bf16 v[240:243], a[0:3], v[92:95], v[240:243]
  ds_read_b64 v[110:111], v11 offset:44608
  v_mfma_f32_16x16x32_bf16 v[132:135], a[4:7], v[64:67], v[132:135]
  ds_read_b64 v[112:113], v12 offset:43520
  s_add_u32 s63, s65, 222208
  v_mfma_f32_16x16x32_bf16 v[148:151], a[4:7], v[68:71], v[148:151]
  ds_read_b64 v[114:115], v12 offset:44608
  v_mfma_f32_16x16x32_bf16 v[164:167], a[4:7], v[72:75], v[164:167]
  buffer_load_dwordx4 a[100:103], v2, s[56:59], s63 offen
  ds_read_b64 v[116:117], v13 offset:43520
  v_mfma_f32_16x16x32_bf16 v[180:183], a[4:7], v[76:79], v[180:183]
  s_add_u32 s63, s65, 2048
  v_mfma_f32_16x16x32_bf16 v[196:199], a[4:7], v[80:83], v[196:199]
  ds_read_b64 v[118:119], v13 offset:44608
  buffer_load_dwordx4 a[104:107], v2, s[56:59], s63 offen
  v_mfma_f32_16x16x32_bf16 v[212:215], a[4:7], v[84:87], v[212:215]
  ds_read_b64 v[120:121], v14 offset:43520
  v_mfma_f32_16x16x32_bf16 v[228:231], a[4:7], v[88:91], v[228:231]
  ds_read_b64 v[122:123], v14 offset:44608
  ds_read_b64 v[124:125], v15 offset:43520
  v_mfma_f32_16x16x32_bf16 v[244:247], a[4:7], v[92:95], v[244:247]
  ds_read_b64 v[126:127], v15 offset:44608
  s_waitcnt vmcnt(27)
  v_mfma_f32_16x16x32_bf16 v[136:139], a[8:11], v[64:67], v[136:139]
  s_add_u32 s63, s65, 57344
  v_mfma_f32_16x16x32_bf16 v[152:155], a[8:11], v[68:71], v[152:155]
  buffer_load_dwordx4 a[108:111], v2, s[56:59], s63 offen
  v_mfma_f32_16x16x32_bf16 v[168:171], a[8:11], v[72:75], v[168:171]
  s_add_u32 s63, s65, 112640
  v_mfma_f32_16x16x32_bf16 v[184:187], a[8:11], v[76:79], v[184:187]
  buffer_load_dwordx4 a[112:115], v2, s[56:59], s63 offen
  v_mfma_f32_16x16x32_bf16 v[200:203], a[8:11], v[80:83], v[200:203]
  v_mfma_f32_16x16x32_bf16 v[216:219], a[8:11], v[84:87], v[216:219]
  v_mfma_f32_16x16x32_bf16 v[232:235], a[8:11], v[88:91], v[232:235]
  v_mfma_f32_16x16x32_bf16 v[248:251], a[8:11], v[92:95], v[248:251]
  v_mfma_f32_16x16x32_bf16 v[140:143], a[12:15], v[64:67], v[140:143]
  s_add_u32 s63, s65, 167936
  v_mfma_f32_16x16x32_bf16 v[156:159], a[12:15], v[68:71], v[156:159]
  buffer_load_dwordx4 a[116:119], v2, s[56:59], s63 offen
  v_mfma_f32_16x16x32_bf16 v[172:175], a[12:15], v[72:75], v[172:175]
  s_add_u32 s63, s65, 223232
  v_mfma_f32_16x16x32_bf16 v[188:191], a[12:15], v[76:79], v[188:191]
  buffer_load_dwordx4 a[120:123], v2, s[56:59], s63 offen
  v_mfma_f32_16x16x32_bf16 v[204:207], a[12:15], v[80:83], v[204:207]
  v_mfma_f32_16x16x32_bf16 v[220:223], a[12:15], v[84:87], v[220:223]
  v_mfma_f32_16x16x32_bf16 v[236:239], a[12:15], v[88:91], v[236:239]
  v_mfma_f32_16x16x32_bf16 v[252:255], a[12:15], v[92:95], v[252:255]
  s_waitcnt lgkmcnt(0)
  s_waitcnt vmcnt(27)
  v_mfma_f32_16x16x32_bf16 v[128:131], a[16:19], v[96:99], v[128:131]
  ds_read_b64 v[64:65], v8 offset:52224
  s_add_u32 s63, s65, 3072
  v_mfma_f32_16x16x32_bf16 v[144:147], a[16:19], v[100:103], v[144:147]
  ds_read_b64 v[66:67], v8 offset:53312
  v_mfma_f32_16x16x32_bf16 v[160:163], a[16:19], v[104:107], v[160:163]
  buffer_load_dwordx4 a[124:127], v2, s[56:59], s63 offen
  ds_read_b64 v[68:69], v9 offset:52224
  v_mfma_f32_16x16x32_bf16 v[176:179], a[16:19], v[108:111], v[176:179]
  s_add_u32 s63, s65, 58368
  v_mfma_f32_16x16x32_bf16 v[192:195], a[16:19], v[112:115], v[192:195]
  ds_read_b64 v[70:71], v9 offset:53312
  buffer_load_dwordx4 a[128:131], v2, s[56:59], s63 offen
  v_mfma_f32_16x16x32_bf16 v[208:211], a[16:19], v[116:119], v[208:211]
  ds_read_b64 v[72:73], v10 offset:52224
  v_mfma_f32_16x16x32_bf16 v[224:227], a[16:19], v[120:123], v[224:227]
  ds_read_b64 v[74:75], v10 offset:53312
  ds_read_b64 v[76:77], v11 offset:52224
  v_mfma_f32_16x16x32_bf16 v[240:243], a[16:19], v[124:127], v[240:243]
  ds_read_b64 v[78:79], v11 offset:53312
  v_mfma_f32_16x16x32_bf16 v[132:135], a[20:23], v[96:99], v[132:135]
  ds_read_b64 v[80:81], v12 offset:52224
  s_add_u32 s63, s65, 113664
  v_mfma_f32_16x16x32_bf16 v[148:151], a[20:23], v[100:103], v[148:151]
  ds_read_b64 v[82:83], v12 offset:53312
  v_mfma_f32_16x16x32_bf16 v[164:167], a[20:23], v[104:107], v[164:167]
  buffer_load_dwordx4 a[132:135], v2, s[56:59], s63 offen
  ds_read_b64 v[84:85], v13 offset:52224
  v_mfma_f32_16x16x32_bf16 v[180:183], a[20:23], v[108:111], v[180:183]
  s_add_u32 s63, s65, 168960
  v_mfma_f32_16x16x32_bf16 v[196:199], a[20:23], v[112:115], v[196:199]
  ds_read_b64 v[86:87], v13 offset:53312
  buffer_load_dwordx4 a[136:139], v2, s[56:59], s63 offen
  v_mfma_f32_16x16x32_bf16 v[212:215], a[20:23], v[116:119], v[212:215]
  ds_read_b64 v[88:89], v14 offset:52224
  v_mfma_f32_16x16x32_bf16 v[228:231], a[20:23], v[120:123], v[228:231]
  ds_read_b64 v[90:91], v14 offset:53312
  ds_read_b64 v[92:93], v15 offset:52224
  v_mfma_f32_16x16x32_bf16 v[244:247], a[20:23], v[124:127], v[244:247]
  ds_read_b64 v[94:95], v15 offset:53312
  s_waitcnt vmcnt(27)
  v_mfma_f32_16x16x32_bf16 v[136:139], a[24:27], v[96:99], v[136:139]
  s_add_u32 s63, s65, 224256
  v_mfma_f32_16x16x32_bf16 v[152:155], a[24:27], v[100:103], v[152:155]
  buffer_load_dwordx4 a[140:143], v2, s[56:59], s63 offen
  v_mfma_f32_16x16x32_bf16 v[168:171], a[24:27], v[104:107], v[168:171]
  s_add_u32 s63, s65, 4096
  v_mfma_f32_16x16x32_bf16 v[184:187], a[24:27], v[108:111], v[184:187]
  buffer_load_dwordx4 a[144:147], v2, s[56:59], s63 offen
  v_mfma_f32_16x16x32_bf16 v[200:203], a[24:27], v[112:115], v[200:203]
  v_mfma_f32_16x16x32_bf16 v[216:219], a[24:27], v[116:119], v[216:219]
  v_mfma_f32_16x16x32_bf16 v[232:235], a[24:27], v[120:123], v[232:235]
  v_mfma_f32_16x16x32_bf16 v[248:251], a[24:27], v[124:127], v[248:251]
  v_mfma_f32_16x16x32_bf16 v[140:143], a[28:31], v[96:99], v[140:143]
  s_add_u32 s63, s65, 59392
  v_mfma_f32_16x16x32_bf16 v[156:159], a[28:31], v[100:103], v[156:159]
  buffer_load_dwordx4 a[148:151], v2, s[56:59], s63 offen
  v_mfma_f32_16x16x32_bf16 v[172:175], a[28:31], v[104:107], v[172:175]
  s_add_u32 s63, s65, 114688
  v_mfma_f32_16x16x32_bf16 v[188:191], a[28:31], v[108:111], v[188:191]
  buffer_load_dwordx4 a[152:155], v2, s[56:59], s63 offen
  v_mfma_f32_16x16x32_bf16 v[204:207], a[28:31], v[112:115], v[204:207]
  v_mfma_f32_16x16x32_bf16 v[220:223], a[28:31], v[116:119], v[220:223]
  v_mfma_f32_16x16x32_bf16 v[236:239], a[28:31], v[120:123], v[236:239]
  v_mfma_f32_16x16x32_bf16 v[252:255], a[28:31], v[124:127], v[252:255]
  s_waitcnt lgkmcnt(0)
  s_waitcnt vmcnt(25)
  v_mfma_f32_16x16x32_bf16 v[128:131], a[32:35], v[64:67], v[128:131]
  ds_read_b64 v[96:97], v8 offset:60928
  s_add_u32 s63, s65, 169984
  v_mfma_f32_16x16x32_bf16 v[144:147], a[32:35], v[68:71], v[144:147]
  ds_read_b64 v[98:99], v8 offset:62016
  v_mfma_f32_16x16x32_bf16 v[160:163], a[32:35], v[72:75], v[160:163]
  buffer_load_dwordx4 a[156:159], v2, s[56:59], s63 offen
  ds_read_b64 v[100:101], v9 offset:60928
  v_mfma_f32_16x16x32_bf16 v[176:179], a[32:35], v[76:79], v[176:179]
  s_add_u32 s63, s65, 225280
  v_mfma_f32_16x16x32_bf16 v[192:195], a[32:35], v[80:83], v[192:195]
  ds_read_b64 v[102:103], v9 offset:62016
  buffer_load_dwordx4 a[160:163], v2, s[56:59], s63 offen
  v_mfma_f32_16x16x32_bf16 v[208:211], a[32:35], v[84:87], v[208:211]
  ds_read_b64 v[104:105], v10 offset:60928
  v_mfma_f32_16x16x32_bf16 v[224:227], a[32:35], v[88:91], v[224:227]
  ds_read_b64 v[106:107], v10 offset:62016
  ds_read_b64 v[108:109], v11 offset:60928
  v_mfma_f32_16x16x32_bf16 v[240:243], a[32:35], v[92:95], v[240:243]
  ds_read_b64 v[110:111], v11 offset:62016
  v_mfma_f32_16x16x32_bf16 v[132:135], a[36:39], v[64:67], v[132:135]
  ds_read_b64 v[112:113], v12 offset:60928
  s_add_u32 s63, s65, 5120
  v_mfma_f32_16x16x32_bf16 v[148:151], a[36:39], v[68:71], v[148:151]
  ds_read_b64 v[114:115], v12 offset:62016
  v_mfma_f32_16x16x32_bf16 v[164:167], a[36:39], v[72:75], v[164:167]
  buffer_load_dwordx4 a[164:167], v2, s[56:59], s63 offen
  ds_read_b64 v[116:117], v13 offset:60928
  v_mfma_f32_16x16x32_bf16 v[180:183], a[36:39], v[76:79], v[180:183]
  s_add_u32 s63, s65, 60416
  v_mfma_f32_16x16x32_bf16 v[196:199], a[36:39], v[80:83], v[196:199]
  ds_read_b64 v[118:119], v13 offset:62016
  buffer_load_dwordx4 a[168:171], v2, s[56:59], s63 offen
  v_mfma_f32_16x16x32_bf16 v[212:215], a[36:39], v[84:87], v[212:215]
  ds_read_b64 v[120:121], v14 offset:60928
  v_mfma_f32_16x16x32_bf16 v[228:231], a[36:39], v[88:91], v[228:231]
  ds_read_b64 v[122:123], v14 offset:62016
  ds_read_b64 v[124:125], v15 offset:60928
  v_mfma_f32_16x16x32_bf16 v[244:247], a[36:39], v[92:95], v[244:247]
  ds_read_b64 v[126:127], v15 offset:62016
  s_waitcnt vmcnt(27)
  v_mfma_f32_16x16x32_bf16 v[136:139], a[40:43], v[64:67], v[136:139]
  s_add_u32 s63, s65, 115712
  v_mfma_f32_16x16x32_bf16 v[152:155], a[40:43], v[68:71], v[152:155]
  buffer_load_dwordx4 a[172:175], v2, s[56:59], s63 offen
  v_mfma_f32_16x16x32_bf16 v[168:171], a[40:43], v[72:75], v[168:171]
  s_add_u32 s63, s65, 171008
  v_mfma_f32_16x16x32_bf16 v[184:187], a[40:43], v[76:79], v[184:187]
  buffer_load_dwordx4 a[176:179], v2, s[56:59], s63 offen
  v_mfma_f32_16x16x32_bf16 v[200:203], a[40:43], v[80:83], v[200:203]
  v_mfma_f32_16x16x32_bf16 v[216:219], a[40:43], v[84:87], v[216:219]
  v_mfma_f32_16x16x32_bf16 v[232:235], a[40:43], v[88:91], v[232:235]
  v_mfma_f32_16x16x32_bf16 v[248:251], a[40:43], v[92:95], v[248:251]
  v_mfma_f32_16x16x32_bf16 v[140:143], a[44:47], v[64:67], v[140:143]
  s_add_u32 s63, s65, 226304
  v_mfma_f32_16x16x32_bf16 v[156:159], a[44:47], v[68:71], v[156:159]
  buffer_load_dwordx4 a[180:183], v2, s[56:59], s63 offen
  v_mfma_f32_16x16x32_bf16 v[172:175], a[44:47], v[72:75], v[172:175]
  s_add_u32 s63, s65, 6144
  v_mfma_f32_16x16x32_bf16 v[188:191], a[44:47], v[76:79], v[188:191]
  buffer_load_dwordx4 a[184:187], v2, s[56:59], s63 offen
  v_mfma_f32_16x16x32_bf16 v[204:207], a[44:47], v[80:83], v[204:207]
  v_mfma_f32_16x16x32_bf16 v[220:223], a[44:47], v[84:87], v[220:223]
  v_mfma_f32_16x16x32_bf16 v[236:239], a[44:47], v[88:91], v[236:239]
  v_mfma_f32_16x16x32_bf16 v[252:255], a[44:47], v[92:95], v[252:255]
  s_waitcnt lgkmcnt(0)
  s_waitcnt vmcnt(27)
  v_mfma_f32_16x16x32_bf16 v[128:131], a[48:51], v[96:99], v[128:131]
  v_mfma_f32_16x16x32_bf16 v[144:147], a[48:51], v[100:103], v[144:147]
  v_mfma_f32_16x16x32_bf16 v[160:163], a[48:51], v[104:107], v[160:163]
  v_mfma_f32_16x16x32_bf16 v[176:179], a[48:51], v[108:111], v[176:179]
  v_mfma_f32_16x16x32_bf16 v[192:195], a[48:51], v[112:115], v[192:195]
  v_mfma_f32_16x16x32_bf16 v[208:211], a[48:51], v[116:119], v[208:211]
  v_mfma_f32_16x16x32_bf16 v[224:227], a[48:51], v[120:123], v[224:227]
  v_mfma_f32_16x16x32_bf16 v[240:243], a[48:51], v[124:127], v[240:243]
  v_mfma_f32_16x16x32_bf16 v[132:135], a[52:55], v[96:99], v[132:135]
  v_mfma_f32_16x16x32_bf16 v[148:151], a[52:55], v[100:103], v[148:151]
  v_mfma_f32_16x16x32_bf16 v[164:167], a[52:55], v[104:107], v[164:167]
  v_mfma_f32_16x16x32_bf16 v[180:183], a[52:55], v[108:111], v[180:183]
  v_mfma_f32_16x16x32_bf16 v[196:199], a[52:55], v[112:115], v[196:199]
  v_mfma_f32_16x16x32_bf16 v[212:215], a[52:55], v[116:119], v[212:215]
  v_mfma_f32_16x16x32_bf16 v[228:231], a[52:55], v[120:123], v[228:231]
  v_mfma_f32_16x16x32_bf16 v[244:247], a[52:55], v[124:127], v[244:247]
  s_waitcnt vmcnt(23)
  v_mfma_f32_16x16x32_bf16 v[136:139], a[56:59], v[96:99], v[136:139]
  v_mfma_f32_16x16x32_bf16 v[152:155], a[56:59], v[100:103], v[152:155]
  v_mfma_f32_16x16x32_bf16 v[168:171], a[56:59], v[104:107], v[168:171]
  v_mfma_f32_16x16x32_bf16 v[184:187], a[56:59], v[108:111], v[184:187]
  v_mfma_f32_16x16x32_bf16 v[200:203], a[56:59], v[112:115], v[200:203]
  v_mfma_f32_16x16x32_bf16 v[216:219], a[56:59], v[116:119], v[216:219]
  v_mfma_f32_16x16x32_bf16 v[232:235], a[56:59], v[120:123], v[232:235]
  v_mfma_f32_16x16x32_bf16 v[248:251], a[56:59], v[124:127], v[248:251]
  v_mfma_f32_16x16x32_bf16 v[140:143], a[60:63], v[96:99], v[140:143]
  v_mfma_f32_16x16x32_bf16 v[156:159], a[60:63], v[100:103], v[156:159]
  v_mfma_f32_16x16x32_bf16 v[172:175], a[60:63], v[104:107], v[172:175]
  v_mfma_f32_16x16x32_bf16 v[188:191], a[60:63], v[108:111], v[188:191]
  v_mfma_f32_16x16x32_bf16 v[204:207], a[60:63], v[112:115], v[204:207]
  v_mfma_f32_16x16x32_bf16 v[220:223], a[60:63], v[116:119], v[220:223]
  v_mfma_f32_16x16x32_bf16 v[236:239], a[60:63], v[120:123], v[236:239]
  v_mfma_f32_16x16x32_bf16 v[252:255], a[60:63], v[124:127], v[252:255]
  s_lshl_b32 s24, s22, 3
  s_mul_i32 s24, s24, 55296
  s_lshl_b32 s25, s23, 10
  s_add_u32 s24, s24, s25
  s_cmp_lt_u32 s23, 54
  s_cselect_b32 s24, s24, 2146435072
  v_add_u32 v82, s24, v2
  v_mul_u32_u24 v83, 2176, v6
  v_lshl_add_u32 v83, v5, 3, v83
  s_mov_b32 s30, 0xbdd2d3e8
  s_mov_b32 s31, 0xbdd2d3e8
  v_mov_b32 v80, 0xc0135761
  v_mov_b32 v81, 0xc0135761
  v_sub_u32 v8, v8, v83
  v_mul_u32_u24 v8, 432, v8
  v_add_u32 v8, v82, v8
  v_sub_u32 v9, v9, v83
  v_mul_u32_u24 v9, 432, v9
  v_add_u32 v9, v82, v9
  v_sub_u32 v10, v10, v83
  v_mul_u32_u24 v10, 432, v10
  v_add_u32 v10, v82, v10
  v_sub_u32 v11, v11, v83
  v_mul_u32_u24 v11, 432, v11
  v_add_u32 v11, v82, v11
  v_sub_u32 v12, v12, v83
  v_mul_u32_u24 v12, 432, v12
  v_add_u32 v12, v82, v12
  v_sub_u32 v13, v13, v83
  v_mul_u32_u24 v13, 432, v13
  v_add_u32 v13, v82, v13
  v_sub_u32 v14, v14, v83
  v_mul_u32_u24 v14, 432, v14
  v_add_u32 v14, v82, v14
  v_sub_u32 v15, v15, v83
  v_mul_u32_u24 v15, 432, v15
  v_add_u32 v15, v82, v15
  s_waitcnt vmcnt(0)
  v_pk_fma_f32 v[64:65], v[32:33], v[16:17], v[48:49] op_sel:[0,1,0] op_sel_hi:[1,1,1] neg_lo:[0,1,0] neg_hi:[0,1,0]
  v_pk_fma_f32 v[68:69], v[34:35], v[16:17], v[50:51] op_sel:[0,1,0] op_sel_hi:[1,1,1] neg_lo:[0,1,0] neg_hi:[0,1,0]
  v_pk_fma_f32 v[66:67], v[36:37], v[16:17], v[52:53] op_sel:[0,1,0] op_sel_hi:[1,1,1] neg_lo:[0,1,0] neg_hi:[0,1,0]
  v_pk_fma_f32 v[70:71], v[38:39], v[16:17], v[54:55] op_sel:[0,1,0] op_sel_hi:[1,1,1] neg_lo:[0,1,0] neg_hi:[0,1,0]
  v_pk_fma_f32 v[128:129], v[128:129], v[16:17], v[64:65] op_sel:[0,0,0] op_sel_hi:[1,0,1]
  s_add_u32 s63, s65, 61440
  buffer_load_dwordx4 a[188:191], v2, s[56:59], s63 offen
  v_pk_fma_f32 v[130:131], v[130:131], v[16:17], v[68:69] op_sel:[0,0,0] op_sel_hi:[1,0,1]
  v_pk_fma_f32 v[132:133], v[132:133], v[16:17], v[66:67] op_sel:[0,0,0] op_sel_hi:[1,0,1]
  v_pk_fma_f32 v[134:135], v[134:135], v[16:17], v[70:71] op_sel:[0,0,0] op_sel_hi:[1,0,1]
  v_pk_mul_f32 v[64:65], v[128:129], v[128:129]
  v_pk_mul_f32 v[68:69], v[130:131], v[130:131]
  v_pk_fma_f32 v[64:65], v[64:65], s[30:31], v[80:81]
  v_pk_fma_f32 v[68:69], v[68:69], s[30:31], v[80:81]
  v_pk_mul_f32 v[64:65], v[64:65], v[128:129]
  v_pk_mul_f32 v[68:69], v[68:69], v[130:131]
  v_exp_f32 v64, v64
  s_add_u32 s63, s65, 116736
  buffer_load_dwordx4 a[192:195], v2, s[56:59], s63 offen
  v_exp_f32 v68, v68
  v_pk_mul_f32 v[128:129], v[128:129], v[132:133]
  v_pk_mul_f32 v[130:131], v[130:131], v[134:135]
  v_exp_f32 v65, v65
  v_exp_f32 v69, v69
  v_pk_add_f32 v[64:65], v[64:65], 1.0 op_sel_hi:[1,0]
  v_pk_add_f32 v[68:69], v[68:69], 1.0 op_sel_hi:[1,0]
  v_rcp_f32 v64, v64
  v_rcp_f32 v68, v68
  v_rcp_f32 v65, v65
  s_add_u32 s63, s65, 172032
  buffer_load_dwordx4 a[196:199], v2, s[56:59], s63 offen
  v_rcp_f32 v69, v69
  v_pk_mul_f32 v[128:129], v[128:129], v[64:65]
  v_pk_mul_f32 v[130:131], v[130:131], v[68:69]
  v_cvt_pk_bf16_f32 v84, v128, v129
  v_cvt_pk_bf16_f32 v85, v130, v131
  v_pk_fma_f32 v[72:73], v[40:41], v[16:17], v[56:57] op_sel:[0,1,0] op_sel_hi:[1,1,1] neg_lo:[0,1,0] neg_hi:[0,1,0]
  v_pk_fma_f32 v[76:77], v[42:43], v[16:17], v[58:59] op_sel:[0,1,0] op_sel_hi:[1,1,1] neg_lo:[0,1,0] neg_hi:[0,1,0]
  v_pk_fma_f32 v[74:75], v[44:45], v[16:17], v[60:61] op_sel:[0,1,0] op_sel_hi:[1,1,1] neg_lo:[0,1,0] neg_hi:[0,1,0]
  v_pk_fma_f32 v[78:79], v[46:47], v[16:17], v[62:63] op_sel:[0,1,0] op_sel_hi:[1,1,1] neg_lo:[0,1,0] neg_hi:[0,1,0]
  v_pk_fma_f32 v[136:137], v[136:137], v[16:17], v[72:73] op_sel:[0,0,0] op_sel_hi:[1,0,1]
  s_add_u32 s63, s65, 227328
  buffer_load_dwordx4 a[200:203], v2, s[56:59], s63 offen
  v_pk_fma_f32 v[138:139], v[138:139], v[16:17], v[76:77] op_sel:[0,0,0] op_sel_hi:[1,0,1]
  v_pk_fma_f32 v[140:141], v[140:141], v[16:17], v[74:75] op_sel:[0,0,0] op_sel_hi:[1,0,1]
  v_pk_fma_f32 v[142:143], v[142:143], v[16:17], v[78:79] op_sel:[0,0,0] op_sel_hi:[1,0,1]
  v_pk_mul_f32 v[72:73], v[136:137], v[136:137]
  v_pk_mul_f32 v[76:77], v[138:139], v[138:139]
  v_pk_fma_f32 v[72:73], v[72:73], s[30:31], v[80:81]
  v_pk_fma_f32 v[76:77], v[76:77], s[30:31], v[80:81]
  v_pk_mul_f32 v[72:73], v[72:73], v[136:137]
  v_pk_mul_f32 v[76:77], v[76:77], v[138:139]
  v_exp_f32 v72, v72
  s_add_u32 s63, s65, 7168
  buffer_load_dwordx4 a[204:207], v2, s[56:59], s63 offen
  v_exp_f32 v76, v76
  v_pk_mul_f32 v[136:137], v[136:137], v[140:141]
  v_pk_mul_f32 v[138:139], v[138:139], v[142:143]
  v_exp_f32 v73, v73
  v_exp_f32 v77, v77
  v_pk_add_f32 v[72:73], v[72:73], 1.0 op_sel_hi:[1,0]
  v_pk_add_f32 v[76:77], v[76:77], 1.0 op_sel_hi:[1,0]
  v_rcp_f32 v72, v72
  v_rcp_f32 v76, v76
  v_rcp_f32 v73, v73
  s_add_u32 s63, s65, 62464
  buffer_load_dwordx4 a[208:211], v2, s[56:59], s63 offen
  v_rcp_f32 v77, v77
  v_pk_mul_f32 v[136:137], v[136:137], v[72:73]
  v_pk_mul_f32 v[138:139], v[138:139], v[76:77]
  v_cvt_pk_bf16_f32 v86, v136, v137
  v_cvt_pk_bf16_f32 v87, v138, v139
  buffer_store_dwordx4 v[84:87], v8, s[40:43], 0 offen sc1
  v_pk_fma_f32 v[64:65], v[32:33], v[18:19], v[48:49] op_sel:[0,1,0] op_sel_hi:[1,1,1] neg_lo:[0,1,0] neg_hi:[0,1,0]
  v_pk_fma_f32 v[68:69], v[34:35], v[18:19], v[50:51] op_sel:[0,1,0] op_sel_hi:[1,1,1] neg_lo:[0,1,0] neg_hi:[0,1,0]
  v_pk_fma_f32 v[66:67], v[36:37], v[18:19], v[52:53] op_sel:[0,1,0] op_sel_hi:[1,1,1] neg_lo:[0,1,0] neg_hi:[0,1,0]
  v_pk_fma_f32 v[70:71], v[38:39], v[18:19], v[54:55] op_sel:[0,1,0] op_sel_hi:[1,1,1] neg_lo:[0,1,0] neg_hi:[0,1,0]
  v_pk_fma_f32 v[144:145], v[144:145], v[18:19], v[64:65] op_sel:[0,0,0] op_sel_hi:[1,0,1]
  s_add_u32 s63, s65, 117760
  buffer_load_dwordx4 a[212:215], v2, s[56:59], s63 offen
  v_pk_fma_f32 v[146:147], v[146:147], v[18:19], v[68:69] op_sel:[0,0,0] op_sel_hi:[1,0,1]
  v_pk_fma_f32 v[148:149], v[148:149], v[18:19], v[66:67] op_sel:[0,0,0] op_sel_hi:[1,0,1]
  v_pk_fma_f32 v[150:151], v[150:151], v[18:19], v[70:71] op_sel:[0,0,0] op_sel_hi:[1,0,1]
  v_pk_mul_f32 v[64:65], v[144:145], v[144:145]
  v_pk_mul_f32 v[68:69], v[146:147], v[146:147]
  v_pk_fma_f32 v[64:65], v[64:65], s[30:31], v[80:81]
  v_pk_fma_f32 v[68:69], v[68:69], s[30:31], v[80:81]
  v_pk_mul_f32 v[64:65], v[64:65], v[144:145]
  v_pk_mul_f32 v[68:69], v[68:69], v[146:147]
  v_exp_f32 v64, v64
  s_add_u32 s63, s65, 173056
  buffer_load_dwordx4 a[216:219], v2, s[56:59], s63 offen
  v_exp_f32 v68, v68
  v_pk_mul_f32 v[144:145], v[144:145], v[148:149]
  v_pk_mul_f32 v[146:147], v[146:147], v[150:151]
  v_exp_f32 v65, v65
  v_exp_f32 v69, v69
  v_pk_add_f32 v[64:65], v[64:65], 1.0 op_sel_hi:[1,0]
  v_pk_add_f32 v[68:69], v[68:69], 1.0 op_sel_hi:[1,0]
  v_rcp_f32 v64, v64
  v_rcp_f32 v68, v68
  v_rcp_f32 v65, v65
  s_add_u32 s63, s65, 228352
  buffer_load_dwordx4 a[220:223], v2, s[56:59], s63 offen
  v_rcp_f32 v69, v69
  v_pk_mul_f32 v[144:145], v[144:145], v[64:65]
  v_pk_mul_f32 v[146:147], v[146:147], v[68:69]
  v_cvt_pk_bf16_f32 v88, v144, v145
  v_cvt_pk_bf16_f32 v89, v146, v147
  v_pk_fma_f32 v[72:73], v[40:41], v[18:19], v[56:57] op_sel:[0,1,0] op_sel_hi:[1,1,1] neg_lo:[0,1,0] neg_hi:[0,1,0]
  v_pk_fma_f32 v[76:77], v[42:43], v[18:19], v[58:59] op_sel:[0,1,0] op_sel_hi:[1,1,1] neg_lo:[0,1,0] neg_hi:[0,1,0]
  v_pk_fma_f32 v[74:75], v[44:45], v[18:19], v[60:61] op_sel:[0,1,0] op_sel_hi:[1,1,1] neg_lo:[0,1,0] neg_hi:[0,1,0]
  v_pk_fma_f32 v[78:79], v[46:47], v[18:19], v[62:63] op_sel:[0,1,0] op_sel_hi:[1,1,1] neg_lo:[0,1,0] neg_hi:[0,1,0]
  v_pk_fma_f32 v[152:153], v[152:153], v[18:19], v[72:73] op_sel:[0,0,0] op_sel_hi:[1,0,1]
  s_add_u32 s63, s65, 8192
  buffer_load_dwordx4 a[224:227], v2, s[56:59], s63 offen
  v_pk_fma_f32 v[154:155], v[154:155], v[18:19], v[76:77] op_sel:[0,0,0] op_sel_hi:[1,0,1]
  v_pk_fma_f32 v[156:157], v[156:157], v[18:19], v[74:75] op_sel:[0,0,0] op_sel_hi:[1,0,1]
  v_pk_fma_f32 v[158:159], v[158:159], v[18:19], v[78:79] op_sel:[0,0,0] op_sel_hi:[1,0,1]
  v_pk_mul_f32 v[72:73], v[152:153], v[152:153]
  v_pk_mul_f32 v[76:77], v[154:155], v[154:155]
  v_pk_fma_f32 v[72:73], v[72:73], s[30:31], v[80:81]
  v_pk_fma_f32 v[76:77], v[76:77], s[30:31], v[80:81]
  v_pk_mul_f32 v[72:73], v[72:73], v[152:153]
  v_pk_mul_f32 v[76:77], v[76:77], v[154:155]
  v_exp_f32 v72, v72
  s_add_u32 s63, s65, 63488
  buffer_load_dwordx4 a[228:231], v2, s[56:59], s63 offen
  v_exp_f32 v76, v76
  v_pk_mul_f32 v[152:153], v[152:153], v[156:157]
  v_pk_mul_f32 v[154:155], v[154:155], v[158:159]
  v_exp_f32 v73, v73
  v_exp_f32 v77, v77
  v_pk_add_f32 v[72:73], v[72:73], 1.0 op_sel_hi:[1,0]
  v_pk_add_f32 v[76:77], v[76:77], 1.0 op_sel_hi:[1,0]
  v_rcp_f32 v72, v72
  v_rcp_f32 v76, v76
  v_rcp_f32 v73, v73
  s_add_u32 s63, s65, 118784
  buffer_load_dwordx4 a[232:235], v2, s[56:59], s63 offen
  v_rcp_f32 v77, v77
  v_pk_mul_f32 v[152:153], v[152:153], v[72:73]
  v_pk_mul_f32 v[154:155], v[154:155], v[76:77]
  v_cvt_pk_bf16_f32 v90, v152, v153
  v_cvt_pk_bf16_f32 v91, v154, v155
  buffer_store_dwordx4 v[88:91], v9, s[40:43], 0 offen sc1
  v_pk_fma_f32 v[64:65], v[32:33], v[20:21], v[48:49] op_sel:[0,1,0] op_sel_hi:[1,1,1] neg_lo:[0,1,0] neg_hi:[0,1,0]
  v_pk_fma_f32 v[68:69], v[34:35], v[20:21], v[50:51] op_sel:[0,1,0] op_sel_hi:[1,1,1] neg_lo:[0,1,0] neg_hi:[0,1,0]
  v_pk_fma_f32 v[66:67], v[36:37], v[20:21], v[52:53] op_sel:[0,1,0] op_sel_hi:[1,1,1] neg_lo:[0,1,0] neg_hi:[0,1,0]
  v_pk_fma_f32 v[70:71], v[38:39], v[20:21], v[54:55] op_sel:[0,1,0] op_sel_hi:[1,1,1] neg_lo:[0,1,0] neg_hi:[0,1,0]
  v_pk_fma_f32 v[160:161], v[160:161], v[20:21], v[64:65] op_sel:[0,0,0] op_sel_hi:[1,0,1]
  s_add_u32 s63, s65, 174080
  buffer_load_dwordx4 a[236:239], v2, s[56:59], s63 offen
  v_pk_fma_f32 v[162:163], v[162:163], v[20:21], v[68:69] op_sel:[0,0,0] op_sel_hi:[1,0,1]
  v_pk_fma_f32 v[164:165], v[164:165], v[20:21], v[66:67] op_sel:[0,0,0] op_sel_hi:[1,0,1]
  v_pk_fma_f32 v[166:167], v[166:167], v[20:21], v[70:71] op_sel:[0,0,0] op_sel_hi:[1,0,1]
  v_pk_mul_f32 v[64:65], v[160:161], v[160:161]
  v_pk_mul_f32 v[68:69], v[162:163], v[162:163]
  v_pk_fma_f32 v[64:65], v[64:65], s[30:31], v[80:81]
  v_pk_fma_f32 v[68:69], v[68:69], s[30:31], v[80:81]
  v_pk_mul_f32 v[64:65], v[64:65], v[160:161]
  v_pk_mul_f32 v[68:69], v[68:69], v[162:163]
  v_exp_f32 v64, v64
  s_add_u32 s63, s65, 229376
  buffer_load_dwordx4 a[240:243], v2, s[56:59], s63 offen
  v_exp_f32 v68, v68
  v_pk_mul_f32 v[160:161], v[160:161], v[164:165]
  v_pk_mul_f32 v[162:163], v[162:163], v[166:167]
  v_exp_f32 v65, v65
  v_exp_f32 v69, v69
  v_pk_add_f32 v[64:65], v[64:65], 1.0 op_sel_hi:[1,0]
  v_pk_add_f32 v[68:69], v[68:69], 1.0 op_sel_hi:[1,0]
  v_rcp_f32 v64, v64
  v_rcp_f32 v68, v68
  v_rcp_f32 v65, v65
  s_add_u32 s63, s65, 9216
  buffer_load_dwordx4 a[0:3], v2, s[56:59], s63 offen
  v_rcp_f32 v69, v69
  v_pk_mul_f32 v[160:161], v[160:161], v[64:65]
  v_pk_mul_f32 v[162:163], v[162:163], v[68:69]
  v_cvt_pk_bf16_f32 v84, v160, v161
  v_cvt_pk_bf16_f32 v85, v162, v163
  v_pk_fma_f32 v[72:73], v[40:41], v[20:21], v[56:57] op_sel:[0,1,0] op_sel_hi:[1,1,1] neg_lo:[0,1,0] neg_hi:[0,1,0]
  v_pk_fma_f32 v[76:77], v[42:43], v[20:21], v[58:59] op_sel:[0,1,0] op_sel_hi:[1,1,1] neg_lo:[0,1,0] neg_hi:[0,1,0]
  v_pk_fma_f32 v[74:75], v[44:45], v[20:21], v[60:61] op_sel:[0,1,0] op_sel_hi:[1,1,1] neg_lo:[0,1,0] neg_hi:[0,1,0]
  v_pk_fma_f32 v[78:79], v[46:47], v[20:21], v[62:63] op_sel:[0,1,0] op_sel_hi:[1,1,1] neg_lo:[0,1,0] neg_hi:[0,1,0]
  v_pk_fma_f32 v[168:169], v[168:169], v[20:21], v[72:73] op_sel:[0,0,0] op_sel_hi:[1,0,1]
  s_add_u32 s63, s65, 64512
  buffer_load_dwordx4 a[4:7], v2, s[56:59], s63 offen
  v_pk_fma_f32 v[170:171], v[170:171], v[20:21], v[76:77] op_sel:[0,0,0] op_sel_hi:[1,0,1]
  v_pk_fma_f32 v[172:173], v[172:173], v[20:21], v[74:75] op_sel:[0,0,0] op_sel_hi:[1,0,1]
  v_pk_fma_f32 v[174:175], v[174:175], v[20:21], v[78:79] op_sel:[0,0,0] op_sel_hi:[1,0,1]
  v_pk_mul_f32 v[72:73], v[168:169], v[168:169]
  v_pk_mul_f32 v[76:77], v[170:171], v[170:171]
  v_pk_fma_f32 v[72:73], v[72:73], s[30:31], v[80:81]
  v_pk_fma_f32 v[76:77], v[76:77], s[30:31], v[80:81]
  v_pk_mul_f32 v[72:73], v[72:73], v[168:169]
  v_pk_mul_f32 v[76:77], v[76:77], v[170:171]
  v_exp_f32 v72, v72
  s_add_u32 s63, s65, 119808
  buffer_load_dwordx4 a[8:11], v2, s[56:59], s63 offen
  v_exp_f32 v76, v76
  v_pk_mul_f32 v[168:169], v[168:169], v[172:173]
  v_pk_mul_f32 v[170:171], v[170:171], v[174:175]
  v_exp_f32 v73, v73
  v_exp_f32 v77, v77
  v_pk_add_f32 v[72:73], v[72:73], 1.0 op_sel_hi:[1,0]
  v_pk_add_f32 v[76:77], v[76:77], 1.0 op_sel_hi:[1,0]
  v_rcp_f32 v72, v72
  v_rcp_f32 v76, v76
  v_rcp_f32 v73, v73
  v_rcp_f32 v77, v77
  v_pk_mul_f32 v[168:169], v[168:169], v[72:73]
  v_pk_mul_f32 v[170:171], v[170:171], v[76:77]
  v_cvt_pk_bf16_f32 v86, v168, v169
  v_cvt_pk_bf16_f32 v87, v170, v171
  buffer_store_dwordx4 v[84:87], v10, s[40:43], 0 offen sc1
  v_pk_fma_f32 v[64:65], v[32:33], v[22:23], v[48:49] op_sel:[0,1,0] op_sel_hi:[1,1,1] neg_lo:[0,1,0] neg_hi:[0,1,0]
  v_pk_fma_f32 v[68:69], v[34:35], v[22:23], v[50:51] op_sel:[0,1,0] op_sel_hi:[1,1,1] neg_lo:[0,1,0] neg_hi:[0,1,0]
  v_pk_fma_f32 v[66:67], v[36:37], v[22:23], v[52:53] op_sel:[0,1,0] op_sel_hi:[1,1,1] neg_lo:[0,1,0] neg_hi:[0,1,0]
  v_pk_fma_f32 v[70:71], v[38:39], v[22:23], v[54:55] op_sel:[0,1,0] op_sel_hi:[1,1,1] neg_lo:[0,1,0] neg_hi:[0,1,0]
  v_pk_fma_f32 v[176:177], v[176:177], v[22:23], v[64:65] op_sel:[0,0,0] op_sel_hi:[1,0,1]
  v_pk_fma_f32 v[178:179], v[178:179], v[22:23], v[68:69] op_sel:[0,0,0] op_sel_hi:[1,0,1]
  v_pk_fma_f32 v[180:181], v[180:181], v[22:23], v[66:67] op_sel:[0,0,0] op_sel_hi:[1,0,1]
  v_pk_fma_f32 v[182:183], v[182:183], v[22:23], v[70:71] op_sel:[0,0,0] op_sel_hi:[1,0,1]
  v_pk_mul_f32 v[64:65], v[176:177], v[176:177]
  v_pk_mul_f32 v[68:69], v[178:179], v[178:179]
  v_pk_fma_f32 v[64:65], v[64:65], s[30:31], v[80:81]
  v_pk_fma_f32 v[68:69], v[68:69], s[30:31], v[80:81]
  v_pk_mul_f32 v[64:65], v[64:65], v[176:177]
  v_pk_mul_f32 v[68:69], v[68:69], v[178:179]
  v_exp_f32 v64, v64
  v_exp_f32 v68, v68
  v_pk_mul_f32 v[176:177], v[176:177], v[180:181]
  v_pk_mul_f32 v[178:179], v[178:179], v[182:183]
  v_exp_f32 v65, v65
  v_exp_f32 v69, v69
  v_pk_add_f32 v[64:65], v[64:65], 1.0 op_sel_hi:[1,0]
  v_pk_add_f32 v[68:69], v[68:69], 1.0 op_sel_hi:[1,0]
  v_rcp_f32 v64, v64
  v_rcp_f32 v68, v68
  v_rcp_f32 v65, v65
  v_rcp_f32 v69, v69
  v_pk_mul_f32 v[176:177], v[176:177], v[64:65]
  v_pk_mul_f32 v[178:179], v[178:179], v[68:69]
  v_cvt_pk_bf16_f32 v88, v176, v177
  v_cvt_pk_bf16_f32 v89, v178, v179
  v_pk_fma_f32 v[72:73], v[40:41], v[22:23], v[56:57] op_sel:[0,1,0] op_sel_hi:[1,1,1] neg_lo:[0,1,0] neg_hi:[0,1,0]
  v_pk_fma_f32 v[76:77], v[42:43], v[22:23], v[58:59] op_sel:[0,1,0] op_sel_hi:[1,1,1] neg_lo:[0,1,0] neg_hi:[0,1,0]
  v_pk_fma_f32 v[74:75], v[44:45], v[22:23], v[60:61] op_sel:[0,1,0] op_sel_hi:[1,1,1] neg_lo:[0,1,0] neg_hi:[0,1,0]
  v_pk_fma_f32 v[78:79], v[46:47], v[22:23], v[62:63] op_sel:[0,1,0] op_sel_hi:[1,1,1] neg_lo:[0,1,0] neg_hi:[0,1,0]
  v_pk_fma_f32 v[184:185], v[184:185], v[22:23], v[72:73] op_sel:[0,0,0] op_sel_hi:[1,0,1]
  v_pk_fma_f32 v[186:187], v[186:187], v[22:23], v[76:77] op_sel:[0,0,0] op_sel_hi:[1,0,1]
  v_pk_fma_f32 v[188:189], v[188:189], v[22:23], v[74:75] op_sel:[0,0,0] op_sel_hi:[1,0,1]
  v_pk_fma_f32 v[190:191], v[190:191], v[22:23], v[78:79] op_sel:[0,0,0] op_sel_hi:[1,0,1]
  v_pk_mul_f32 v[72:73], v[184:185], v[184:185]
  v_pk_mul_f32 v[76:77], v[186:187], v[186:187]
  v_pk_fma_f32 v[72:73], v[72:73], s[30:31], v[80:81]
  v_pk_fma_f32 v[76:77], v[76:77], s[30:31], v[80:81]
  v_pk_mul_f32 v[72:73], v[72:73], v[184:185]
  v_pk_mul_f32 v[76:77], v[76:77], v[186:187]
  v_exp_f32 v72, v72
  v_exp_f32 v76, v76
  v_pk_mul_f32 v[184:185], v[184:185], v[188:189]
  v_pk_mul_f32 v[186:187], v[186:187], v[190:191]
  v_exp_f32 v73, v73
  v_exp_f32 v77, v77
  v_pk_add_f32 v[72:73], v[72:73], 1.0 op_sel_hi:[1,0]
  v_pk_add_f32 v[76:77], v[76:77], 1.0 op_sel_hi:[1,0]
  v_rcp_f32 v72, v72
  v_rcp_f32 v76, v76
  v_rcp_f32 v73, v73
  v_rcp_f32 v77, v77
  v_pk_mul_f32 v[184:185], v[184:185], v[72:73]
  v_pk_mul_f32 v[186:187], v[186:187], v[76:77]
  v_cvt_pk_bf16_f32 v90, v184, v185
  v_cvt_pk_bf16_f32 v91, v186, v187
  buffer_store_dwordx4 v[88:91], v11, s[40:43], 0 offen sc1
  v_pk_fma_f32 v[64:65], v[32:33], v[24:25], v[48:49] op_sel:[0,1,0] op_sel_hi:[1,1,1] neg_lo:[0,1,0] neg_hi:[0,1,0]
  v_pk_fma_f32 v[68:69], v[34:35], v[24:25], v[50:51] op_sel:[0,1,0] op_sel_hi:[1,1,1] neg_lo:[0,1,0] neg_hi:[0,1,0]
  v_pk_fma_f32 v[66:67], v[36:37], v[24:25], v[52:53] op_sel:[0,1,0] op_sel_hi:[1,1,1] neg_lo:[0,1,0] neg_hi:[0,1,0]
  v_pk_fma_f32 v[70:71], v[38:39], v[24:25], v[54:55] op_sel:[0,1,0] op_sel_hi:[1,1,1] neg_lo:[0,1,0] neg_hi:[0,1,0]
  v_pk_fma_f32 v[192:193], v[192:193], v[24:25], v[64:65] op_sel:[0,0,0] op_sel_hi:[1,0,1]
  v_pk_fma_f32 v[194:195], v[194:195], v[24:25], v[68:69] op_sel:[0,0,0] op_sel_hi:[1,0,1]
  v_pk_fma_f32 v[196:197], v[196:197], v[24:25], v[66:67] op_sel:[0,0,0] op_sel_hi:[1,0,1]
  v_pk_fma_f32 v[198:199], v[198:199], v[24:25], v[70:71] op_sel:[0,0,0] op_sel_hi:[1,0,1]
  v_pk_mul_f32 v[64:65], v[192:193], v[192:193]
  v_pk_mul_f32 v[68:69], v[194:195], v[194:195]
  v_pk_fma_f32 v[64:65], v[64:65], s[30:31], v[80:81]
  v_pk_fma_f32 v[68:69], v[68:69], s[30:31], v[80:81]
  v_pk_mul_f32 v[64:65], v[64:65], v[192:193]
  v_pk_mul_f32 v[68:69], v[68:69], v[194:195]
  v_exp_f32 v64, v64
  v_exp_f32 v68, v68
  v_pk_mul_f32 v[192:193], v[192:193], v[196:197]
  v_pk_mul_f32 v[194:195], v[194:195], v[198:199]
  v_exp_f32 v65, v65
  v_exp_f32 v69, v69
  v_pk_add_f32 v[64:65], v[64:65], 1.0 op_sel_hi:[1,0]
  v_pk_add_f32 v[68:69], v[68:69], 1.0 op_sel_hi:[1,0]
  v_rcp_f32 v64, v64
  v_rcp_f32 v68, v68
  v_rcp_f32 v65, v65
  v_rcp_f32 v69, v69
  v_pk_mul_f32 v[192:193], v[192:193], v[64:65]
  v_pk_mul_f32 v[194:195], v[194:195], v[68:69]
  v_cvt_pk_bf16_f32 v84, v192, v193
  v_cvt_pk_bf16_f32 v85, v194, v195
  v_pk_fma_f32 v[72:73], v[40:41], v[24:25], v[56:57] op_sel:[0,1,0] op_sel_hi:[1,1,1] neg_lo:[0,1,0] neg_hi:[0,1,0]
  v_pk_fma_f32 v[76:77], v[42:43], v[24:25], v[58:59] op_sel:[0,1,0] op_sel_hi:[1,1,1] neg_lo:[0,1,0] neg_hi:[0,1,0]
  v_pk_fma_f32 v[74:75], v[44:45], v[24:25], v[60:61] op_sel:[0,1,0] op_sel_hi:[1,1,1] neg_lo:[0,1,0] neg_hi:[0,1,0]
  v_pk_fma_f32 v[78:79], v[46:47], v[24:25], v[62:63] op_sel:[0,1,0] op_sel_hi:[1,1,1] neg_lo:[0,1,0] neg_hi:[0,1,0]
  v_pk_fma_f32 v[200:201], v[200:201], v[24:25], v[72:73] op_sel:[0,0,0] op_sel_hi:[1,0,1]
  v_pk_fma_f32 v[202:203], v[202:203], v[24:25], v[76:77] op_sel:[0,0,0] op_sel_hi:[1,0,1]
  v_pk_fma_f32 v[204:205], v[204:205], v[24:25], v[74:75] op_sel:[0,0,0] op_sel_hi:[1,0,1]
  v_pk_fma_f32 v[206:207], v[206:207], v[24:25], v[78:79] op_sel:[0,0,0] op_sel_hi:[1,0,1]
  v_pk_mul_f32 v[72:73], v[200:201], v[200:201]
  v_pk_mul_f32 v[76:77], v[202:203], v[202:203]
  v_pk_fma_f32 v[72:73], v[72:73], s[30:31], v[80:81]
  v_pk_fma_f32 v[76:77], v[76:77], s[30:31], v[80:81]
  v_pk_mul_f32 v[72:73], v[72:73], v[200:201]
  v_pk_mul_f32 v[76:77], v[76:77], v[202:203]
  v_exp_f32 v72, v72
  v_exp_f32 v76, v76
  v_pk_mul_f32 v[200:201], v[200:201], v[204:205]
  v_pk_mul_f32 v[202:203], v[202:203], v[206:207]
  v_exp_f32 v73, v73
  v_exp_f32 v77, v77
  v_pk_add_f32 v[72:73], v[72:73], 1.0 op_sel_hi:[1,0]
  v_pk_add_f32 v[76:77], v[76:77], 1.0 op_sel_hi:[1,0]
  v_rcp_f32 v72, v72
  v_rcp_f32 v76, v76
  v_rcp_f32 v73, v73
  v_rcp_f32 v77, v77
  v_pk_mul_f32 v[200:201], v[200:201], v[72:73]
  v_pk_mul_f32 v[202:203], v[202:203], v[76:77]
  v_cvt_pk_bf16_f32 v86, v200, v201
  v_cvt_pk_bf16_f32 v87, v202, v203
  buffer_store_dwordx4 v[84:87], v12, s[40:43], 0 offen sc1
  v_pk_fma_f32 v[64:65], v[32:33], v[26:27], v[48:49] op_sel:[0,1,0] op_sel_hi:[1,1,1] neg_lo:[0,1,0] neg_hi:[0,1,0]
  v_pk_fma_f32 v[68:69], v[34:35], v[26:27], v[50:51] op_sel:[0,1,0] op_sel_hi:[1,1,1] neg_lo:[0,1,0] neg_hi:[0,1,0]
  v_pk_fma_f32 v[66:67], v[36:37], v[26:27], v[52:53] op_sel:[0,1,0] op_sel_hi:[1,1,1] neg_lo:[0,1,0] neg_hi:[0,1,0]
  v_pk_fma_f32 v[70:71], v[38:39], v[26:27], v[54:55] op_sel:[0,1,0] op_sel_hi:[1,1,1] neg_lo:[0,1,0] neg_hi:[0,1,0]
  v_pk_fma_f32 v[208:209], v[208:209], v[26:27], v[64:65] op_sel:[0,0,0] op_sel_hi:[1,0,1]
  v_pk_fma_f32 v[210:211], v[210:211], v[26:27], v[68:69] op_sel:[0,0,0] op_sel_hi:[1,0,1]
  v_pk_fma_f32 v[212:213], v[212:213], v[26:27], v[66:67] op_sel:[0,0,0] op_sel_hi:[1,0,1]
  v_pk_fma_f32 v[214:215], v[214:215], v[26:27], v[70:71] op_sel:[0,0,0] op_sel_hi:[1,0,1]
  v_pk_mul_f32 v[64:65], v[208:209], v[208:209]
  v_pk_mul_f32 v[68:69], v[210:211], v[210:211]
  v_pk_fma_f32 v[64:65], v[64:65], s[30:31], v[80:81]
  v_pk_fma_f32 v[68:69], v[68:69], s[30:31], v[80:81]
  v_pk_mul_f32 v[64:65], v[64:65], v[208:209]
  v_pk_mul_f32 v[68:69], v[68:69], v[210:211]
  v_exp_f32 v64, v64
  v_exp_f32 v68, v68
  v_pk_mul_f32 v[208:209], v[208:209], v[212:213]
  v_pk_mul_f32 v[210:211], v[210:211], v[214:215]
  v_exp_f32 v65, v65
  v_exp_f32 v69, v69
  v_pk_add_f32 v[64:65], v[64:65], 1.0 op_sel_hi:[1,0]
  v_pk_add_f32 v[68:69], v[68:69], 1.0 op_sel_hi:[1,0]
  v_rcp_f32 v64, v64
  v_rcp_f32 v68, v68
  v_rcp_f32 v65, v65
  v_rcp_f32 v69, v69
  v_pk_mul_f32 v[208:209], v[208:209], v[64:65]
  v_pk_mul_f32 v[210:211], v[210:211], v[68:69]
  v_cvt_pk_bf16_f32 v88, v208, v209
  v_cvt_pk_bf16_f32 v89, v210, v211
  v_pk_fma_f32 v[72:73], v[40:41], v[26:27], v[56:57] op_sel:[0,1,0] op_sel_hi:[1,1,1] neg_lo:[0,1,0] neg_hi:[0,1,0]
  v_pk_fma_f32 v[76:77], v[42:43], v[26:27], v[58:59] op_sel:[0,1,0] op_sel_hi:[1,1,1] neg_lo:[0,1,0] neg_hi:[0,1,0]
  v_pk_fma_f32 v[74:75], v[44:45], v[26:27], v[60:61] op_sel:[0,1,0] op_sel_hi:[1,1,1] neg_lo:[0,1,0] neg_hi:[0,1,0]
  v_pk_fma_f32 v[78:79], v[46:47], v[26:27], v[62:63] op_sel:[0,1,0] op_sel_hi:[1,1,1] neg_lo:[0,1,0] neg_hi:[0,1,0]
  v_pk_fma_f32 v[216:217], v[216:217], v[26:27], v[72:73] op_sel:[0,0,0] op_sel_hi:[1,0,1]
  v_pk_fma_f32 v[218:219], v[218:219], v[26:27], v[76:77] op_sel:[0,0,0] op_sel_hi:[1,0,1]
  v_pk_fma_f32 v[220:221], v[220:221], v[26:27], v[74:75] op_sel:[0,0,0] op_sel_hi:[1,0,1]
  v_pk_fma_f32 v[222:223], v[222:223], v[26:27], v[78:79] op_sel:[0,0,0] op_sel_hi:[1,0,1]
  v_pk_mul_f32 v[72:73], v[216:217], v[216:217]
  v_pk_mul_f32 v[76:77], v[218:219], v[218:219]
  v_pk_fma_f32 v[72:73], v[72:73], s[30:31], v[80:81]
  v_pk_fma_f32 v[76:77], v[76:77], s[30:31], v[80:81]
  v_pk_mul_f32 v[72:73], v[72:73], v[216:217]
  v_pk_mul_f32 v[76:77], v[76:77], v[218:219]
  v_exp_f32 v72, v72
  v_exp_f32 v76, v76
  v_pk_mul_f32 v[216:217], v[216:217], v[220:221]
  v_pk_mul_f32 v[218:219], v[218:219], v[222:223]
  v_exp_f32 v73, v73
  v_exp_f32 v77, v77
  v_pk_add_f32 v[72:73], v[72:73], 1.0 op_sel_hi:[1,0]
  v_pk_add_f32 v[76:77], v[76:77], 1.0 op_sel_hi:[1,0]
  v_rcp_f32 v72, v72
  v_rcp_f32 v76, v76
  v_rcp_f32 v73, v73
  v_rcp_f32 v77, v77
  v_pk_mul_f32 v[216:217], v[216:217], v[72:73]
  v_pk_mul_f32 v[218:219], v[218:219], v[76:77]
  v_cvt_pk_bf16_f32 v90, v216, v217
  v_cvt_pk_bf16_f32 v91, v218, v219
  buffer_store_dwordx4 v[88:91], v13, s[40:43], 0 offen sc1
  v_pk_fma_f32 v[64:65], v[32:33], v[28:29], v[48:49] op_sel:[0,1,0] op_sel_hi:[1,1,1] neg_lo:[0,1,0] neg_hi:[0,1,0]
  v_pk_fma_f32 v[68:69], v[34:35], v[28:29], v[50:51] op_sel:[0,1,0] op_sel_hi:[1,1,1] neg_lo:[0,1,0] neg_hi:[0,1,0]
  v_pk_fma_f32 v[66:67], v[36:37], v[28:29], v[52:53] op_sel:[0,1,0] op_sel_hi:[1,1,1] neg_lo:[0,1,0] neg_hi:[0,1,0]
  v_pk_fma_f32 v[70:71], v[38:39], v[28:29], v[54:55] op_sel:[0,1,0] op_sel_hi:[1,1,1] neg_lo:[0,1,0] neg_hi:[0,1,0]
  v_pk_fma_f32 v[224:225], v[224:225], v[28:29], v[64:65] op_sel:[0,0,0] op_sel_hi:[1,0,1]
  v_pk_fma_f32 v[226:227], v[226:227], v[28:29], v[68:69] op_sel:[0,0,0] op_sel_hi:[1,0,1]
  v_pk_fma_f32 v[228:229], v[228:229], v[28:29], v[66:67] op_sel:[0,0,0] op_sel_hi:[1,0,1]
  v_pk_fma_f32 v[230:231], v[230:231], v[28:29], v[70:71] op_sel:[0,0,0] op_sel_hi:[1,0,1]
  v_pk_mul_f32 v[64:65], v[224:225], v[224:225]
  v_pk_mul_f32 v[68:69], v[226:227], v[226:227]
  v_pk_fma_f32 v[64:65], v[64:65], s[30:31], v[80:81]
  v_pk_fma_f32 v[68:69], v[68:69], s[30:31], v[80:81]
  v_pk_mul_f32 v[64:65], v[64:65], v[224:225]
  v_pk_mul_f32 v[68:69], v[68:69], v[226:227]
  v_exp_f32 v64, v64
  v_exp_f32 v68, v68
  v_pk_mul_f32 v[224:225], v[224:225], v[228:229]
  v_pk_mul_f32 v[226:227], v[226:227], v[230:231]
  v_exp_f32 v65, v65
  v_exp_f32 v69, v69
  v_pk_add_f32 v[64:65], v[64:65], 1.0 op_sel_hi:[1,0]
  v_pk_add_f32 v[68:69], v[68:69], 1.0 op_sel_hi:[1,0]
  v_rcp_f32 v64, v64
  v_rcp_f32 v68, v68
  v_rcp_f32 v65, v65
  v_rcp_f32 v69, v69
  v_pk_mul_f32 v[224:225], v[224:225], v[64:65]
  v_pk_mul_f32 v[226:227], v[226:227], v[68:69]
  v_cvt_pk_bf16_f32 v84, v224, v225
  v_cvt_pk_bf16_f32 v85, v226, v227
  v_pk_fma_f32 v[72:73], v[40:41], v[28:29], v[56:57] op_sel:[0,1,0] op_sel_hi:[1,1,1] neg_lo:[0,1,0] neg_hi:[0,1,0]
  v_pk_fma_f32 v[76:77], v[42:43], v[28:29], v[58:59] op_sel:[0,1,0] op_sel_hi:[1,1,1] neg_lo:[0,1,0] neg_hi:[0,1,0]
  v_pk_fma_f32 v[74:75], v[44:45], v[28:29], v[60:61] op_sel:[0,1,0] op_sel_hi:[1,1,1] neg_lo:[0,1,0] neg_hi:[0,1,0]
  v_pk_fma_f32 v[78:79], v[46:47], v[28:29], v[62:63] op_sel:[0,1,0] op_sel_hi:[1,1,1] neg_lo:[0,1,0] neg_hi:[0,1,0]
  v_pk_fma_f32 v[232:233], v[232:233], v[28:29], v[72:73] op_sel:[0,0,0] op_sel_hi:[1,0,1]
  v_pk_fma_f32 v[234:235], v[234:235], v[28:29], v[76:77] op_sel:[0,0,0] op_sel_hi:[1,0,1]
  v_pk_fma_f32 v[236:237], v[236:237], v[28:29], v[74:75] op_sel:[0,0,0] op_sel_hi:[1,0,1]
  v_pk_fma_f32 v[238:239], v[238:239], v[28:29], v[78:79] op_sel:[0,0,0] op_sel_hi:[1,0,1]
  v_pk_mul_f32 v[72:73], v[232:233], v[232:233]
  v_pk_mul_f32 v[76:77], v[234:235], v[234:235]
  v_pk_fma_f32 v[72:73], v[72:73], s[30:31], v[80:81]
  v_pk_fma_f32 v[76:77], v[76:77], s[30:31], v[80:81]
  v_pk_mul_f32 v[72:73], v[72:73], v[232:233]
  v_pk_mul_f32 v[76:77], v[76:77], v[234:235]
  v_exp_f32 v72, v72
  v_exp_f32 v76, v76
  v_pk_mul_f32 v[232:233], v[232:233], v[236:237]
  v_pk_mul_f32 v[234:235], v[234:235], v[238:239]
  v_exp_f32 v73, v73
  v_exp_f32 v77, v77
  v_pk_add_f32 v[72:73], v[72:73], 1.0 op_sel_hi:[1,0]
  v_pk_add_f32 v[76:77], v[76:77], 1.0 op_sel_hi:[1,0]
  v_rcp_f32 v72, v72
  v_rcp_f32 v76, v76
  v_rcp_f32 v73, v73
  v_rcp_f32 v77, v77
  v_pk_mul_f32 v[232:233], v[232:233], v[72:73]
  v_pk_mul_f32 v[234:235], v[234:235], v[76:77]
  v_cvt_pk_bf16_f32 v86, v232, v233
  v_cvt_pk_bf16_f32 v87, v234, v235
  buffer_store_dwordx4 v[84:87], v14, s[40:43], 0 offen sc1
  v_pk_fma_f32 v[64:65], v[32:33], v[30:31], v[48:49] op_sel:[0,1,0] op_sel_hi:[1,1,1] neg_lo:[0,1,0] neg_hi:[0,1,0]
  v_pk_fma_f32 v[68:69], v[34:35], v[30:31], v[50:51] op_sel:[0,1,0] op_sel_hi:[1,1,1] neg_lo:[0,1,0] neg_hi:[0,1,0]
  v_pk_fma_f32 v[66:67], v[36:37], v[30:31], v[52:53] op_sel:[0,1,0] op_sel_hi:[1,1,1] neg_lo:[0,1,0] neg_hi:[0,1,0]
  v_pk_fma_f32 v[70:71], v[38:39], v[30:31], v[54:55] op_sel:[0,1,0] op_sel_hi:[1,1,1] neg_lo:[0,1,0] neg_hi:[0,1,0]
  v_pk_fma_f32 v[240:241], v[240:241], v[30:31], v[64:65] op_sel:[0,0,0] op_sel_hi:[1,0,1]
  v_pk_fma_f32 v[242:243], v[242:243], v[30:31], v[68:69] op_sel:[0,0,0] op_sel_hi:[1,0,1]
  v_pk_fma_f32 v[244:245], v[244:245], v[30:31], v[66:67] op_sel:[0,0,0] op_sel_hi:[1,0,1]
  v_pk_fma_f32 v[246:247], v[246:247], v[30:31], v[70:71] op_sel:[0,0,0] op_sel_hi:[1,0,1]
  v_pk_mul_f32 v[64:65], v[240:241], v[240:241]
  v_pk_mul_f32 v[68:69], v[242:243], v[242:243]
  v_pk_fma_f32 v[64:65], v[64:65], s[30:31], v[80:81]
  v_pk_fma_f32 v[68:69], v[68:69], s[30:31], v[80:81]
  v_pk_mul_f32 v[64:65], v[64:65], v[240:241]
  v_pk_mul_f32 v[68:69], v[68:69], v[242:243]
  v_exp_f32 v64, v64
  v_exp_f32 v68, v68
  v_pk_mul_f32 v[240:241], v[240:241], v[244:245]
  v_pk_mul_f32 v[242:243], v[242:243], v[246:247]
  v_exp_f32 v65, v65
  v_exp_f32 v69, v69
  v_pk_add_f32 v[64:65], v[64:65], 1.0 op_sel_hi:[1,0]
  v_pk_add_f32 v[68:69], v[68:69], 1.0 op_sel_hi:[1,0]
  v_rcp_f32 v64, v64
  v_rcp_f32 v68, v68
  v_rcp_f32 v65, v65
  v_rcp_f32 v69, v69
  v_pk_mul_f32 v[240:241], v[240:241], v[64:65]
  v_pk_mul_f32 v[242:243], v[242:243], v[68:69]
  v_cvt_pk_bf16_f32 v88, v240, v241
  v_cvt_pk_bf16_f32 v89, v242, v243
  v_pk_fma_f32 v[72:73], v[40:41], v[30:31], v[56:57] op_sel:[0,1,0] op_sel_hi:[1,1,1] neg_lo:[0,1,0] neg_hi:[0,1,0]
  v_pk_fma_f32 v[76:77], v[42:43], v[30:31], v[58:59] op_sel:[0,1,0] op_sel_hi:[1,1,1] neg_lo:[0,1,0] neg_hi:[0,1,0]
  v_pk_fma_f32 v[74:75], v[44:45], v[30:31], v[60:61] op_sel:[0,1,0] op_sel_hi:[1,1,1] neg_lo:[0,1,0] neg_hi:[0,1,0]
  v_pk_fma_f32 v[78:79], v[46:47], v[30:31], v[62:63] op_sel:[0,1,0] op_sel_hi:[1,1,1] neg_lo:[0,1,0] neg_hi:[0,1,0]
  v_pk_fma_f32 v[248:249], v[248:249], v[30:31], v[72:73] op_sel:[0,0,0] op_sel_hi:[1,0,1]
  v_pk_fma_f32 v[250:251], v[250:251], v[30:31], v[76:77] op_sel:[0,0,0] op_sel_hi:[1,0,1]
  v_pk_fma_f32 v[252:253], v[252:253], v[30:31], v[74:75] op_sel:[0,0,0] op_sel_hi:[1,0,1]
  v_pk_fma_f32 v[254:255], v[254:255], v[30:31], v[78:79] op_sel:[0,0,0] op_sel_hi:[1,0,1]
  v_pk_mul_f32 v[72:73], v[248:249], v[248:249]
  v_pk_mul_f32 v[76:77], v[250:251], v[250:251]
  v_pk_fma_f32 v[72:73], v[72:73], s[30:31], v[80:81]
  v_pk_fma_f32 v[76:77], v[76:77], s[30:31], v[80:81]
  v_pk_mul_f32 v[72:73], v[72:73], v[248:249]
  v_pk_mul_f32 v[76:77], v[76:77], v[250:251]
  v_exp_f32 v72, v72
  v_exp_f32 v76, v76
  v_pk_mul_f32 v[248:249], v[248:249], v[252:253]
  v_pk_mul_f32 v[250:251], v[250:251], v[254:255]
  v_exp_f32 v73, v73
  v_exp_f32 v77, v77
  v_pk_add_f32 v[72:73], v[72:73], 1.0 op_sel_hi:[1,0]
  v_pk_add_f32 v[76:77], v[76:77], 1.0 op_sel_hi:[1,0]
  v_rcp_f32 v72, v72
  v_rcp_f32 v76, v76
  v_rcp_f32 v73, v73
  v_rcp_f32 v77, v77
  v_pk_mul_f32 v[248:249], v[248:249], v[72:73]
  v_pk_mul_f32 v[250:251], v[250:251], v[76:77]
  v_cvt_pk_bf16_f32 v90, v248, v249
  v_cvt_pk_bf16_f32 v91, v250, v251
  buffer_store_dwordx4 v[88:91], v15, s[40:43], 0 offen sc1
  s_waitcnt vmcnt(0)
  s_barrier
  s_cmp_lg_u32 s19, 0
  s_cbranch_scc1 L_k3_kernel_noarr_3
  s_lshr_b32 s24, s23, 2
  s_lshl_b32 s24, s24, 2
  s_lshl_b32 s25, s22, 7
  s_add_u32 s24, s24, s25
  v_mov_b32 v8, 1
  v_mov_b32 v9, s24
  s_mov_b64 exec, 1
  buffer_store_dword v8, v9, s[80:83], 0 offen sc1
  s_mov_b64 exec, -1
L_k3_kernel_noarr_3:
  s_branch k3_kernel_post
k3_kernel_stats:
  v_and_b32 v1, 63, v0
  v_lshrrev_b32 v2, 3, v1
  v_and_b32 v3, 7, v1
  v_mul_u32_u24 v4, 16640, v2
  v_lshl_add_u32 v4, v3, 4, v4
  s_lshl_b32 s21, s2, 6
  s_lshl_b32 s22, s19, 4
  s_add_u32 s21, s21, s22
  s_lshl_b32 s22, s21, 3
  v_add_u32 v4, s22, v4
  s_waitcnt lgkmcnt(0)
  s_add_u32 s8, s4, 10485760
  s_addc_u32 s9, s5, 0
  s_mov_b32 s10, 2662400
  s_mov_b32 s11, 0x20000
  s_mov_b32 s23, 0
  buffer_load_dwordx4 v[16:19], v4, s[8:11], s23 offen
  s_mov_b32 s23, 133120
  buffer_load_dwordx4 v[20:23], v4, s[8:11], s23 offen
  s_mov_b32 s23, 266240
  buffer_load_dwordx4 v[24:27], v4, s[8:11], s23 offen
  s_mov_b32 s23, 399360
  buffer_load_dwordx4 v[28:31], v4, s[8:11], s23 offen
  s_mov_b32 s23, 532480
  buffer_load_dwordx4 v[32:35], v4, s[8:11], s23 offen
  s_mov_b32 s23, 665600
  buffer_load_dwordx4 v[36:39], v4, s[8:11], s23 offen
  s_mov_b32 s23, 798720
  buffer_load_dwordx4 v[40:43], v4, s[8:11], s23 offen
  s_mov_b32 s23, 931840
  buffer_load_dwordx4 v[44:47], v4, s[8:11], s23 offen
  s_mov_b32 s23, 1064960
  buffer_load_dwordx4 v[48:51], v4, s[8:11], s23 offen
  s_mov_b32 s23, 1198080
  buffer_load_dwordx4 v[52:55], v4, s[8:11], s23 offen
  s_mov_b32 s23, 1331200
  buffer_load_dwordx4 v[56:59], v4, s[8:11], s23 offen
  s_mov_b32 s23, 1464320
  buffer_load_dwordx4 v[60:63], v4, s[8:11], s23 offen
  s_mov_b32 s23, 1597440
  buffer_load_dwordx4 v[64:67], v4, s[8:11], s23 offen
  s_mov_b32 s23, 1730560
  buffer_load_dwordx4 v[68:71], v4, s[8:11], s23 offen
  s_mov_b32 s23, 1863680
  buffer_load_dwordx4 v[72:75], v4, s[8:11], s23 offen
  s_mov_b32 s23, 1996800
  buffer_load_dwordx4 v[76:79], v4, s[8:11], s23 offen
  s_mov_b32 s23, 2129920
  buffer_load_dwordx4 v[80:83], v4, s[8:11], s23 offen
  s_mov_b32 s23, 2263040
  buffer_load_dwordx4 v[84:87], v4, s[8:11], s23 offen
  s_mov_b32 s23, 2396160
  buffer_load_dwordx4 v[88:91], v4, s[8:11], s23 offen
  s_mov_b32 s23, 2529280
  buffer_load_dwordx4 v[92:95], v4, s[8:11], s23 offen
  s_add_u32 s12, s4, 98304
  s_addc_u32 s13, s5, 0
  s_mov_b32 s14, 16384
  s_mov_b32 s15, 0x20000
  s_mov_b32 s48, s38
  s_mov_b32 s49, s39
  s_mov_b32 s50, 256
  s_mov_b32 s51, 0x20000
  s_mov_b32 s24, 0x3f803f80
  v_mov_b32 v8, 0
  v_mov_b32 v9, 0
  v_mov_b32 v10, 0
  v_mov_b32 v11, 0
  s_waitcnt vmcnt(19)
  v_dot2_f32_bf16 v8, v16, s24, v8
  v_dot2_f32_bf16 v9, v16, v16, v9
  v_dot2_f32_bf16 v10, v18, s24, v10
  v_dot2_f32_bf16 v11, v18, v18, v11
  v_dot2_f32_bf16 v8, v17, s24, v8
  v_dot2_f32_bf16 v9, v17, v17, v9
  v_dot2_f32_bf16 v10, v19, s24, v10
  v_dot2_f32_bf16 v11, v19, v19, v11
  s_waitcnt vmcnt(18)
  v_dot2_f32_bf16 v8, v20, s24, v8
  v_dot2_f32_bf16 v9, v20, v20, v9
  v_dot2_f32_bf16 v10, v22, s24, v10
  v_dot2_f32_bf16 v11, v22, v22, v11
  v_dot2_f32_bf16 v8, v21, s24, v8
  v_dot2_f32_bf16 v9, v21, v21, v9
  v_dot2_f32_bf16 v10, v23, s24, v10
  v_dot2_f32_bf16 v11, v23, v23, v11
  s_waitcnt vmcnt(17)
  v_dot2_f32_bf16 v8, v24, s24, v8
  v_dot2_f32_bf16 v9, v24, v24, v9
  v_dot2_f32_bf16 v10, v26, s24, v10
  v_dot2_f32_bf16 v11, v26, v26, v11
  v_dot2_f32_bf16 v8, v25, s24, v8
  v_dot2_f32_bf16 v9, v25, v25, v9
  v_dot2_f32_bf16 v10, v27, s24, v10
  v_dot2_f32_bf16 v11, v27, v27, v11
  s_waitcnt vmcnt(16)
  v_dot2_f32_bf16 v8, v28, s24, v8
  v_dot2_f32_bf16 v9, v28, v28, v9
  v_dot2_f32_bf16 v10, v30, s24, v10
  v_dot2_f32_bf16 v11, v30, v30, v11
  v_dot2_f32_bf16 v8, v29, s24, v8
  v_dot2_f32_bf16 v9, v29, v29, v9
  v_dot2_f32_bf16 v10, v31, s24, v10
  v_dot2_f32_bf16 v11, v31, v31, v11
  s_waitcnt vmcnt(15)
  v_dot2_f32_bf16 v8, v32, s24, v8
  v_dot2_f32_bf16 v9, v32, v32, v9
  v_dot2_f32_bf16 v10, v34, s24, v10
  v_dot2_f32_bf16 v11, v34, v34, v11
  v_dot2_f32_bf16 v8, v33, s24, v8
  v_dot2_f32_bf16 v9, v33, v33, v9
  v_dot2_f32_bf16 v10, v35, s24, v10
  v_dot2_f32_bf16 v11, v35, v35, v11
  s_waitcnt vmcnt(14)
  v_dot2_f32_bf16 v8, v36, s24, v8
  v_dot2_f32_bf16 v9, v36, v36, v9
  v_dot2_f32_bf16 v10, v38, s24, v10
  v_dot2_f32_bf16 v11, v38, v38, v11
  v_dot2_f32_bf16 v8, v37, s24, v8
  v_dot2_f32_bf16 v9, v37, v37, v9
  v_dot2_f32_bf16 v10, v39, s24, v10
  v_dot2_f32_bf16 v11, v39, v39, v11
  s_waitcnt vmcnt(13)
  v_dot2_f32_bf16 v8, v40, s24, v8
  v_dot2_f32_bf16 v9, v40, v40, v9
  v_dot2_f32_bf16 v10, v42, s24, v10
  v_dot2_f32_bf16 v11, v42, v42, v11
  v_dot2_f32_bf16 v8, v41, s24, v8
  v_dot2_f32_bf16 v9, v41, v41, v9
  v_dot2_f32_bf16 v10, v43, s24, v10
  v_dot2_f32_bf16 v11, v43, v43, v11
  s_waitcnt vmcnt(12)
  v_dot2_f32_bf16 v8, v44, s24, v8
  v_dot2_f32_bf16 v9, v44, v44, v9
  v_dot2_f32_bf16 v10, v46, s24, v10
  v_dot2_f32_bf16 v11, v46, v46, v11
  v_dot2_f32_bf16 v8, v45, s24, v8
  v_dot2_f32_bf16 v9, v45, v45, v9
  v_dot2_f32_bf16 v10, v47, s24, v10
  v_dot2_f32_bf16 v11, v47, v47, v11
  s_waitcnt vmcnt(11)
  v_dot2_f32_bf16 v8, v48, s24, v8
  v_dot2_f32_bf16 v9, v48, v48, v9
  v_dot2_f32_bf16 v10, v50, s24, v10
  v_dot2_f32_bf16 v11, v50, v50, v11
  v_dot2_f32_bf16 v8, v49, s24, v8
  v_dot2_f32_bf16 v9, v49, v49, v9
  v_dot2_f32_bf16 v10, v51, s24, v10
  v_dot2_f32_bf16 v11, v51, v51, v11
  s_waitcnt vmcnt(10)
  v_dot2_f32_bf16 v8, v52, s24, v8
  v_dot2_f32_bf16 v9, v52, v52, v9
  v_dot2_f32_bf16 v10, v54, s24, v10
  v_dot2_f32_bf16 v11, v54, v54, v11
  v_dot2_f32_bf16 v8, v53, s24, v8
  v_dot2_f32_bf16 v9, v53, v53, v9
  v_dot2_f32_bf16 v10, v55, s24, v10
  v_dot2_f32_bf16 v11, v55, v55, v11
  s_waitcnt vmcnt(9)
  v_dot2_f32_bf16 v8, v56, s24, v8
  v_dot2_f32_bf16 v9, v56, v56, v9
  v_dot2_f32_bf16 v10, v58, s24, v10
  v_dot2_f32_bf16 v11, v58, v58, v11
  v_dot2_f32_bf16 v8, v57, s24, v8
  v_dot2_f32_bf16 v9, v57, v57, v9
  v_dot2_f32_bf16 v10, v59, s24, v10
  v_dot2_f32_bf16 v11, v59, v59, v11
  s_waitcnt vmcnt(8)
  v_dot2_f32_bf16 v8, v60, s24, v8
  v_dot2_f32_bf16 v9, v60, v60, v9
  v_dot2_f32_bf16 v10, v62, s24, v10
  v_dot2_f32_bf16 v11, v62, v62, v11
  v_dot2_f32_bf16 v8, v61, s24, v8
  v_dot2_f32_bf16 v9, v61, v61, v9
  v_dot2_f32_bf16 v10, v63, s24, v10
  v_dot2_f32_bf16 v11, v63, v63, v11
  s_waitcnt vmcnt(7)
  v_dot2_f32_bf16 v8, v64, s24, v8
  v_dot2_f32_bf16 v9, v64, v64, v9
  v_dot2_f32_bf16 v10, v66, s24, v10
  v_dot2_f32_bf16 v11, v66, v66, v11
  v_dot2_f32_bf16 v8, v65, s24, v8
  v_dot2_f32_bf16 v9, v65, v65, v9
  v_dot2_f32_bf16 v10, v67, s24, v10
  v_dot2_f32_bf16 v11, v67, v67, v11
  s_waitcnt vmcnt(6)
  v_dot2_f32_bf16 v8, v68, s24, v8
  v_dot2_f32_bf16 v9, v68, v68, v9
  v_dot2_f32_bf16 v10, v70, s24, v10
  v_dot2_f32_bf16 v11, v70, v70, v11
  v_dot2_f32_bf16 v8, v69, s24, v8
  v_dot2_f32_bf16 v9, v69, v69, v9
  v_dot2_f32_bf16 v10, v71, s24, v10
  v_dot2_f32_bf16 v11, v71, v71, v11
  s_waitcnt vmcnt(5)
  v_dot2_f32_bf16 v8, v72, s24, v8
  v_dot2_f32_bf16 v9, v72, v72, v9
  v_dot2_f32_bf16 v10, v74, s24, v10
  v_dot2_f32_bf16 v11, v74, v74, v11
  v_dot2_f32_bf16 v8, v73, s24, v8
  v_dot2_f32_bf16 v9, v73, v73, v9
  v_dot2_f32_bf16 v10, v75, s24, v10
  v_dot2_f32_bf16 v11, v75, v75, v11
  s_waitcnt vmcnt(4)
  v_dot2_f32_bf16 v8, v76, s24, v8
  v_dot2_f32_bf16 v9, v76, v76, v9
  v_dot2_f32_bf16 v10, v78, s24, v10
  v_dot2_f32_bf16 v11, v78, v78, v11
  v_dot2_f32_bf16 v8, v77, s24, v8
  v_dot2_f32_bf16 v9, v77, v77, v9
  v_dot2_f32_bf16 v10, v79, s24, v10
  v_dot2_f32_bf16 v11, v79, v79, v11
  s_waitcnt vmcnt(3)
  v_dot2_f32_bf16 v8, v80, s24, v8
  v_dot2_f32_bf16 v9, v80, v80, v9
  v_dot2_f32_bf16 v10, v82, s24, v10
  v_dot2_f32_bf16 v11, v82, v82, v11
  v_dot2_f32_bf16 v8, v81, s24, v8
  v_dot2_f32_bf16 v9, v81, v81, v9
  v_dot2_f32_bf16 v10, v83, s24, v10
  v_dot2_f32_bf16 v11, v83, v83, v11
  s_waitcnt vmcnt(2)
  v_dot2_f32_bf16 v8, v84, s24, v8
  v_dot2_f32_bf16 v9, v84, v84, v9
  v_dot2_f32_bf16 v10, v86, s24, v10
  v_dot2_f32_bf16 v11, v86, v86, v11
  v_dot2_f32_bf16 v8, v85, s24, v8
  v_dot2_f32_bf16 v9, v85, v85, v9
  v_dot2_f32_bf16 v10, v87, s24, v10
  v_dot2_f32_bf16 v11, v87, v87, v11
  s_waitcnt vmcnt(1)
  v_dot2_f32_bf16 v8, v88, s24, v8
  v_dot2_f32_bf16 v9, v88, v88, v9
  v_dot2_f32_bf16 v10, v90, s24, v10
  v_dot2_f32_bf16 v11, v90, v90, v11
  v_dot2_f32_bf16 v8, v89, s24, v8
  v_dot2_f32_bf16 v9, v89, v89, v9
  v_dot2_f32_bf16 v10, v91, s24, v10
  v_dot2_f32_bf16 v11, v91, v91, v11
  s_waitcnt vmcnt(0)
  v_dot2_f32_bf16 v8, v92, s24, v8
  v_dot2_f32_bf16 v9, v92, v92, v9
  v_dot2_f32_bf16 v10, v94, s24, v10
  v_dot2_f32_bf16 v11, v94, v94, v11
  v_dot2_f32_bf16 v8, v93, s24, v8
  v_dot2_f32_bf16 v9, v93, v93, v9
  v_dot2_f32_bf16 v10, v95, s24, v10
  v_dot2_f32_bf16 v11, v95, v95, v11
  v_add_f32_dpp v8, v8, v8 row_ror:8 row_mask:0xf bank_mask:0xf
  v_add_f32_dpp v9, v9, v9 row_ror:8 row_mask:0xf bank_mask:0xf
  v_add_f32_dpp v10, v10, v10 row_ror:8 row_mask:0xf bank_mask:0xf
  v_add_f32_dpp v11, v11, v11 row_ror:8 row_mask:0xf bank_mask:0xf
  v_mov_b32 v12, v8
  v_mov_b32 v13, v9
  v_mov_b32 v14, v10
  v_mov_b32 v15, v11
  v_permlane16_swap_b32 v8, v12
  v_permlane16_swap_b32 v9, v13
  v_permlane16_swap_b32 v10, v14
  v_permlane16_swap_b32 v11, v15
  v_add_f32 v8, v8, v12
  v_add_f32 v9, v9, v13
  v_add_f32 v10, v10, v14
  v_add_f32 v11, v11, v15
  v_mov_b32 v12, v8
  v_mov_b32 v13, v9
  v_mov_b32 v14, v10
  v_mov_b32 v15, v11
  v_permlane32_swap_b32 v8, v12
  v_permlane32_swap_b32 v9, v13
  v_permlane32_swap_b32 v10, v14
  v_permlane32_swap_b32 v11, v15
  v_add_f32 v8, v8, v12
  v_add_f32 v9, v9, v13
  v_add_f32 v10, v10, v14
  v_add_f32 v11, v11, v15
  v_mul_f32 v8, 0x3acccccd, v8
  v_mul_f32 v9, 0x3acccccd, v9
  v_fma_f32 v9, -v8, v8, v9
  v_max_f32 v9, 0, v9
  v_cvt_pk_bf16_f32 v9, v9, v9
  v_and_b32 v9, 0xffff0000, v9
  v_add_f32 v9, 0x3727c5ac, v9
  v_cvt_pk_bf16_f32 v9, v9, v9
  v_and_b32 v9, 0xffff0000, v9
  v_sqrt_f32 v9, v9
  s_nop 0
  v_cvt_pk_bf16_f32 v9, v9, v9
  v_and_b32 v9, 0xffff0000, v9
  v_cvt_pk_bf16_f32 v8, v8, v8
  v_and_b32 v8, 0xffff0000, v8
  v_rcp_f32 v9, v9
  v_mul_f32 v10, 0x3acccccd, v10
  v_mul_f32 v11, 0x3acccccd, v11
  v_fma_f32 v11, -v10, v10, v11
  v_max_f32 v11, 0, v11
  v_cvt_pk_bf16_f32 v11, v11, v11
  v_and_b32 v11, 0xffff0000, v11
  v_add_f32 v11, 0x3727c5ac, v11
  v_cvt_pk_bf16_f32 v11, v11, v11
  v_and_b32 v11, 0xffff0000, v11
  v_sqrt_f32 v11, v11
  s_nop 0
  v_cvt_pk_bf16_f32 v11, v11, v11
  v_and_b32 v11, 0xffff0000, v11
  v_cvt_pk_bf16_f32 v10, v10, v10
  v_and_b32 v10, 0xffff0000, v10
  v_rcp_f32 v11, v11
  v_mov_b32 v12, v9
  v_mul_f32 v13, v9, v8
  v_mov_b32 v14, v11
  v_mul_f32 v15, v11, v10
  v_lshlrev_b32 v5, 4, v3
  v_add_u32 v5, s22, v5
  v_cmp_gt_u32 vcc, 8, v1
  s_nop 2
  s_and_saveexec_b64 s[26:27], vcc
  buffer_store_dwordx4 v[12:15], v5, s[12:15], 0 offen sc1
  s_mov_b64 exec, s[26:27]
  s_waitcnt vmcnt(0)
  s_barrier
  s_cmp_lg_u32 s19, 0
  s_cbranch_scc1 k3_kernel_statsdone
  v_mov_b32 v6, 1
  s_lshl_b32 s25, s2, 2
  v_mov_b32 v7, s25
  s_mov_b64 exec, 1
  buffer_store_dword v6, v7, s[48:51], 0 offen sc1
  s_waitcnt vmcnt(0)
  s_branch k3_kernel_statsdone
k3_kernel_statsdone:
  s_mov_b64 exec, -1
  v_and_b32 v1, 63, v0
  v_lshlrev_b32 v2, 4, v1
  s_add_u32 s40, s4, 22020096
  s_addc_u32 s41, s5, 0
  s_mov_b32 s42, 7077888
  s_mov_b32 s43, 0x20000
  s_mov_b32 s48, s38
  s_mov_b32 s49, s39
  s_mov_b32 s50, 256
  s_mov_b32 s51, 0x20000
  s_add_u32 s56, s4, 18874368
  s_addc_u32 s57, s5, 0
  s_mov_b32 s58, 2211840
  s_mov_b32 s59, 0x20000
  s_add_u32 s72, s4, 32768
  s_addc_u32 s73, s5, 0
  s_mov_b32 s74, 2560
  s_mov_b32 s75, 0x20000
  s_mov_b32 s76, s36
  s_mov_b32 s77, s37
  s_mov_b32 s78, 2621440
  s_mov_b32 s79, 0x20000
  s_add_u32 s80, s4, 163840
  s_addc_u32 s81, s5, 0
  s_mov_b32 s82, 2048
  s_mov_b32 s83, 0x20000
  s_and_b32 s24, s2, 7
  s_lshr_b32 s25, s2, 3
  s_add_u32 s61, s24, 1
  s_and_b32 s61, s61, 3
  s_lshl_b32 s61, s61, 1
  s_lshr_b32 s26, s24, 2
  s_add_u32 s61, s61, s26
  s_lshl_b32 s61, s61, 2
  s_and_b32 s26, s25, 3
  s_add_u32 s61, s61, s26
  s_lshr_b32 s62, s25, 2
  s_mul_i32 s60, s19, 14336
  s_mul_i32 s65, s62, 276480
  s_add_u32 s65, s65, s60
  s_mul_i32 s66, s61, 221184
  s_add_u32 s66, s66, s60
  s_add_u32 s63, s65, 0
  buffer_load_dwordx4 a[64:67], v2, s[56:59], s63 offen
  s_add_u32 s63, s65, 55296
  buffer_load_dwordx4 a[68:71], v2, s[56:59], s63 offen
  s_add_u32 s63, s65, 110592
  buffer_load_dwordx4 a[72:75], v2, s[56:59], s63 offen
  s_add_u32 s63, s65, 165888
  buffer_load_dwordx4 a[76:79], v2, s[56:59], s63 offen
  s_add_u32 s63, s65, 221184
  buffer_load_dwordx4 a[80:83], v2, s[56:59], s63 offen
  s_waitcnt vmcnt(30)
  s_add_u32 s63, s65, 1024
  buffer_load_dwordx4 a[84:87], v2, s[56:59], s63 offen
  s_add_u32 s63, s65, 56320
  buffer_load_dwordx4 a[88:91], v2, s[56:59], s63 offen
  s_add_u32 s63, s65, 111616
  buffer_load_dwordx4 a[92:95], v2, s[56:59], s63 offen
  s_add_u32 s63, s65, 166912
  buffer_load_dwordx4 a[96:99], v2, s[56:59], s63 offen
  s_add_u32 s63, s65, 222208
  buffer_load_dwordx4 a[100:103], v2, s[56:59], s63 offen
  s_waitcnt vmcnt(30)
  s_add_u32 s63, s65, 2048
  buffer_load_dwordx4 a[104:107], v2, s[56:59], s63 offen
  s_add_u32 s63, s65, 57344
  buffer_load_dwordx4 a[108:111], v2, s[56:59], s63 offen
  s_add_u32 s63, s65, 112640
  buffer_load_dwordx4 a[112:115], v2, s[56:59], s63 offen
  s_add_u32 s63, s65, 167936
  buffer_load_dwordx4 a[116:119], v2, s[56:59], s63 offen
  s_add_u32 s63, s65, 223232
  buffer_load_dwordx4 a[120:123], v2, s[56:59], s63 offen
  s_waitcnt vmcnt(30)
  s_add_u32 s63, s65, 3072
  buffer_load_dwordx4 a[124:127], v2, s[56:59], s63 offen
  s_add_u32 s63, s65, 58368
  buffer_load_dwordx4 a[128:131], v2, s[56:59], s63 offen
  s_add_u32 s63, s65, 113664
  buffer_load_dwordx4 a[132:135], v2, s[56:59], s63 offen
  s_add_u32 s63, s65, 168960
  buffer_load_dwordx4 a[136:139], v2, s[56:59], s63 offen
  s_add_u32 s63, s65, 224256
  buffer_load_dwordx4 a[140:143], v2, s[56:59], s63 offen
  s_waitcnt vmcnt(30)
  s_add_u32 s63, s65, 4096
  buffer_load_dwordx4 a[144:147], v2, s[56:59], s63 offen
  s_add_u32 s63, s65, 59392
  buffer_load_dwordx4 a[148:151], v2, s[56:59], s63 offen
  s_add_u32 s63, s65, 114688
  buffer_load_dwordx4 a[152:155], v2, s[56:59], s63 offen
  s_add_u32 s63, s65, 169984
  buffer_load_dwordx4 a[156:159], v2, s[56:59], s63 offen
  s_add_u32 s63, s65, 225280
  buffer_load_dwordx4 a[160:163], v2, s[56:59], s63 offen
  s_waitcnt vmcnt(30)
  s_add_u32 s63, s65, 5120
  buffer_load_dwordx4 a[164:167], v2, s[56:59], s63 offen
  s_add_u32 s63, s65, 60416
  buffer_load_dwordx4 a[168:171], v2, s[56:59], s63 offen
  s_add_u32 s63, s65, 115712
  buffer_load_dwordx4 a[172:175], v2, s[56:59], s63 offen
  s_add_u32 s63, s65, 171008
  buffer_load_dwordx4 a[176:179], v2, s[56:59], s63 offen
  s_add_u32 s63, s65, 226304
  buffer_load_dwordx4 a[180:183], v2, s[56:59], s63 offen
  s_waitcnt vmcnt(30)
  s_add_u32 s63, s65, 6144
  buffer_load_dwordx4 a[184:187], v2, s[56:59], s63 offen
  s_add_u32 s63, s65, 61440
  buffer_load_dwordx4 a[188:191], v2, s[56:59], s63 offen
  s_add_u32 s63, s65, 116736
  buffer_load_dwordx4 a[192:195], v2, s[56:59], s63 offen
  s_add_u32 s63, s65, 172032
  buffer_load_dwordx4 a[196:199], v2, s[56:59], s63 offen
  s_add_u32 s63, s65, 227328
  buffer_load_dwordx4 a[200:203], v2, s[56:59], s63 offen
  s_waitcnt vmcnt(30)
  s_add_u32 s63, s65, 7168
  buffer_load_dwordx4 a[204:207], v2, s[56:59], s63 offen
  s_add_u32 s63, s65, 62464
  buffer_load_dwordx4 a[208:211], v2, s[56:59], s63 offen
  s_add_u32 s63, s65, 117760
  buffer_load_dwordx4 a[212:215], v2, s[56:59], s63 offen
  s_add_u32 s63, s65, 173056
  buffer_load_dwordx4 a[216:219], v2, s[56:59], s63 offen
  s_add_u32 s63, s65, 228352
  buffer_load_dwordx4 a[220:223], v2, s[56:59], s63 offen
  s_waitcnt vmcnt(30)
  s_add_u32 s63, s65, 8192
  buffer_load_dwordx4 a[224:227], v2, s[56:59], s63 offen
  s_add_u32 s63, s65, 63488
  buffer_load_dwordx4 a[228:231], v2, s[56:59], s63 offen
  s_add_u32 s63, s65, 118784
  buffer_load_dwordx4 a[232:235], v2, s[56:59], s63 offen
  s_add_u32 s63, s65, 174080
  buffer_load_dwordx4 a[236:239], v2, s[56:59], s63 offen
  s_add_u32 s63, s65, 229376
  buffer_load_dwordx4 a[240:243], v2, s[56:59], s63 offen
  s_waitcnt vmcnt(30)
  s_add_u32 s63, s65, 9216
  buffer_load_dwordx4 a[0:3], v2, s[56:59], s63 offen
  s_add_u32 s63, s65, 64512
  buffer_load_dwordx4 a[4:7], v2, s[56:59], s63 offen
  s_add_u32 s63, s65, 119808
  buffer_load_dwordx4 a[8:11], v2, s[56:59], s63 offen
  s_add_u32 s63, s65, 175104
  buffer_load_dwordx4 a[12:15], v2, s[56:59], s63 offen
  s_add_u32 s63, s65, 230400
  buffer_load_dwordx4 a[16:19], v2, s[56:59], s63 offen
  s_waitcnt vmcnt(30)
  s_add_u32 s63, s65, 10240
  buffer_load_dwordx4 a[20:23], v2, s[56:59], s63 offen
  s_add_u32 s63, s65, 65536
  buffer_load_dwordx4 a[24:27], v2, s[56:59], s63 offen
  s_add_u32 s63, s65, 120832
  buffer_load_dwordx4 a[28:31], v2, s[56:59], s63 offen
  s_add_u32 s63, s65, 176128
  buffer_load_dwordx4 a[32:35], v2, s[56:59], s63 offen
  s_add_u32 s63, s65, 231424
  buffer_load_dwordx4 a[36:39], v2, s[56:59], s63 offen
  s_waitcnt vmcnt(30)
  s_add_u32 s63, s65, 11264
  buffer_load_dwordx4 a[40:43], v2, s[56:59], s63 offen
  s_add_u32 s63, s65, 66560
  buffer_load_dwordx4 a[44:47], v2, s[56:59], s63 offen
  s_add_u32 s63, s65, 121856
  buffer_load_dwordx4 a[48:51], v2, s[56:59], s63 offen
  s_add_u32 s63, s65, 177152
  buffer_load_dwordx4 a[52:55], v2, s[56:59], s63 offen
  s_add_u32 s63, s65, 232448
  buffer_load_dwordx4 a[56:59], v2, s[56:59], s63 offen
  s_waitcnt vmcnt(30)
  s_waitcnt vmcnt(0)
k3_kernel_post:
  v_lshrrev_b32 v21, 4, v2
  v_and_b32 v19, 3, v21
  s_mul_i32 s24, s19, 7
  s_lshr_b32 s24, s24, 1
  v_add_u32 v19, s24, v19
  v_lshlrev_b32 v19, 2, v19
  s_lshr_b32 s24, s61, 1
  s_lshl_b32 s24, s24, 7
  v_add_u32 v19, s24, v19
  s_add_u32 s63, s65, 175104
  buffer_load_dwordx4 a[12:15], v2, s[56:59], s63 offen
  s_add_u32 s63, s65, 230400
  buffer_load_dwordx4 a[16:19], v2, s[56:59], s63 offen
  s_add_u32 s63, s65, 10240
  buffer_load_dwordx4 a[20:23], v2, s[56:59], s63 offen
  s_add_u32 s63, s65, 65536
  buffer_load_dwordx4 a[24:27], v2, s[56:59], s63 offen
  s_add_u32 s63, s65, 120832
  buffer_load_dwordx4 a[28:31], v2, s[56:59], s63 offen
  s_add_u32 s63, s65, 176128
  buffer_load_dwordx4 a[32:35], v2, s[56:59], s63 offen
  s_add_u32 s63, s65, 231424
  buffer_load_dwordx4 a[36:39], v2, s[56:59], s63 offen
  s_add_u32 s63, s65, 11264
  buffer_load_dwordx4 a[40:43], v2, s[56:59], s63 offen
  s_add_u32 s63, s65, 66560
  buffer_load_dwordx4 a[44:47], v2, s[56:59], s63 offen
  s_add_u32 s63, s65, 121856
  buffer_load_dwordx4 a[48:51], v2, s[56:59], s63 offen
  s_add_u32 s63, s65, 177152
  buffer_load_dwordx4 a[52:55], v2, s[56:59], s63 offen
  s_add_u32 s63, s65, 232448
  buffer_load_dwordx4 a[56:59], v2, s[56:59], s63 offen
  buffer_load_dword v20, v19, s[80:83], 0 offen sc1
  v_and_b32 v22, 15, v21
  v_lshrrev_b32 v23, 4, v21
  s_lshl_b32 s24, s61, 6
  s_lshl_b32 s25, s19, 4
  s_add_u32 s24, s24, s25
  v_add_u32 v24, s24, v22
  v_lshlrev_b32 v16, 3, v24
  v_mul_u32_u24 v17, 16640, v23
  v_add_u32 v16, v16, v17
  s_mul_i32 s25, s62, 332800
  v_add_u32 v16, s25, v16
  s_mul_i32 s25, s62, 320
  v_lshlrev_b32 v17, 4, v23
  v_add_u32 v17, s25, v17
  v_mul_u32_u24 v18, 1280, v24
  v_lshrrev_b32 v25, 1, v17
  v_add_u32 v18, v18, v25
  v_mov_b32 v128, 0
  v_mov_b32 v129, 0
  v_mov_b32 v130, 0
  v_mov_b32 v131, 0
  v_mov_b32 v132, 0
  v_mov_b32 v133, 0
  v_mov_b32 v134, 0
  v_mov_b32 v135, 0
  v_mov_b32 v136, 0
  v_mov_b32 v137, 0
  v_mov_b32 v138, 0
  v_mov_b32 v139, 0
  v_mov_b32 v140, 0
  v_mov_b32 v141, 0
  v_mov_b32 v142, 0
  v_mov_b32 v143, 0
  v_mov_b32 v144, 0
  v_mov_b32 v145, 0
  v_mov_b32 v146, 0
  v_mov_b32 v147, 0
  v_mov_b32 v148, 0
  v_mov_b32 v149, 0
  v_mov_b32 v150, 0
  v_mov_b32 v151, 0
  v_mov_b32 v152, 0
  v_mov_b32 v153, 0
  v_mov_b32 v154, 0
  v_mov_b32 v155, 0
  v_mov_b32 v156, 0
  v_mov_b32 v157, 0
  v_mov_b32 v158, 0
  v_mov_b32 v159, 0
  v_mov_b32 v160, 0
  v_mov_b32 v161, 0
  v_mov_b32 v162, 0
  v_mov_b32 v163, 0
  v_mov_b32 v164, 0
  v_mov_b32 v165, 0
  v_mov_b32 v166, 0
  v_mov_b32 v167, 0
  v_mov_b32 v168, 0
  v_mov_b32 v169, 0
  v_mov_b32 v170, 0
  v_mov_b32 v171, 0
  v_mov_b32 v172, 0
  v_mov_b32 v173, 0
  v_mov_b32 v174, 0
  v_mov_b32 v175, 0
  v_mov_b32 v176, 0
  v_mov_b32 v177, 0
  v_mov_b32 v178, 0
  v_mov_b32 v179, 0
  v_mov_b32 v180, 0
  v_mov_b32 v181, 0
  v_mov_b32 v182, 0
  v_mov_b32 v183, 0
  v_mov_b32 v184, 0
  v_mov_b32 v185, 0
  v_mov_b32 v186, 0
  v_mov_b32 v187, 0
  v_mov_b32 v188, 0
  v_mov_b32 v189, 0
  v_mov_b32 v190, 0
  v_mov_b32 v191, 0
  v_mov_b32 v192, 0
  v_mov_b32 v193, 0
  v_mov_b32 v194, 0
  v_mov_b32 v195, 0
  v_mov_b32 v196, 0
  v_mov_b32 v197, 0
  v_mov_b32 v198, 0
  v_mov_b32 v199, 0
  v_mov_b32 v200, 0
  v_mov_b32 v201, 0
  v_mov_b32 v202, 0
  v_mov_b32 v203, 0
  v_mov_b32 v204, 0
  v_mov_b32 v205, 0
  v_mov_b32 v206, 0
  v_mov_b32 v207, 0
  s_mov_b32 s34, 100000
  buffer_load_dword v27, v19, s[80:83], 0 offen sc1
  s_waitcnt vmcnt(1)
  v_cmp_eq_u32 vcc, 0, v20
  s_nop 2
  s_cmp_eq_u64 vcc, 0
  s_cbranch_scc1 L_k3_kernel_hok_5
L_k3_kernel_hspin_4:
  s_sleep 6
  buffer_load_dword v20, v19, s[80:83], 0 offen sc1
  s_waitcnt vmcnt(1)
  v_cmp_eq_u32 vcc, 0, v27
  s_nop 2
  s_cmp_eq_u64 vcc, 0
  s_cbranch_scc1 L_k3_kernel_hok_5
  s_sleep 6
  buffer_load_dword v27, v19, s[80:83], 0 offen sc1
  s_waitcnt vmcnt(1)
  v_cmp_eq_u32 vcc, 0, v20
  s_sub_u32 s34, s34, 1
  s_cmp_eq_u32 s34, 0
  s_cbranch_scc1 L_k3_kernel_hok_5
  s_cmp_eq_u64 vcc, 0
  s_cbranch_scc0 L_k3_kernel_hspin_4
L_k3_kernel_hok_5:
  s_add_u32 s64, s66, 0
  buffer_load_dwordx4 v[32:35], v2, s[40:43], s64 offen sc1
  s_add_u32 s64, s66, 55296
  buffer_load_dwordx4 v[36:39], v2, s[40:43], s64 offen sc1
  s_add_u32 s64, s66, 110592
  buffer_load_dwordx4 v[40:43], v2, s[40:43], s64 offen sc1
  s_add_u32 s64, s66, 165888
  buffer_load_dwordx4 v[44:47], v2, s[40:43], s64 offen sc1
  s_add_u32 s64, s66, 1024
  buffer_load_dwordx4 v[48:51], v2, s[40:43], s64 offen sc1
  s_add_u32 s64, s66, 56320
  buffer_load_dwordx4 v[52:55], v2, s[40:43], s64 offen sc1
  s_add_u32 s64, s66, 111616
  buffer_load_dwordx4 v[56:59], v2, s[40:43], s64 offen sc1
  s_add_u32 s64, s66, 166912
  buffer_load_dwordx4 v[60:63], v2, s[40:43], s64 offen sc1
  s_add_u32 s64, s66, 2048
  buffer_load_dwordx4 v[64:67], v2, s[40:43], s64 offen sc1
  s_add_u32 s64, s66, 57344
  buffer_load_dwordx4 v[68:71], v2, s[40:43], s64 offen sc1
  s_add_u32 s64, s66, 112640
  buffer_load_dwordx4 v[72:75], v2, s[40:43], s64 offen sc1
  s_add_u32 s64, s66, 167936
  buffer_load_dwordx4 v[76:79], v2, s[40:43], s64 offen sc1
  s_waitcnt vmcnt(8)
  v_mfma_f32_16x16x32_bf16 v[128:131], a[64:67], v[32:35], v[128:131]
  v_mfma_f32_16x16x32_bf16 v[132:135], a[68:71], v[32:35], v[132:135]
  s_add_u32 s64, s66, 3072
  buffer_load_dwordx4 v[80:83], v2, s[40:43], s64 offen sc1
  v_mfma_f32_16x16x32_bf16 v[136:139], a[72:75], v[32:35], v[136:139]
  v_mfma_f32_16x16x32_bf16 v[140:143], a[76:79], v[32:35], v[140:143]
  s_add_u32 s64, s66, 58368
  buffer_load_dwordx4 v[84:87], v2, s[40:43], s64 offen sc1
  v_mfma_f32_16x16x32_bf16 v[144:147], a[80:83], v[32:35], v[144:147]
  v_mfma_f32_16x16x32_bf16 v[148:151], a[64:67], v[36:39], v[148:151]
  v_mfma_f32_16x16x32_bf16 v[152:155], a[68:71], v[36:39], v[152:155]
  s_add_u32 s64, s66, 113664
  buffer_load_dwordx4 v[88:91], v2, s[40:43], s64 offen sc1
  v_mfma_f32_16x16x32_bf16 v[156:159], a[72:75], v[36:39], v[156:159]
  v_mfma_f32_16x16x32_bf16 v[160:163], a[76:79], v[36:39], v[160:163]
  s_add_u32 s64, s66, 168960
  buffer_load_dwordx4 v[92:95], v2, s[40:43], s64 offen sc1
  v_mfma_f32_16x16x32_bf16 v[164:167], a[80:83], v[36:39], v[164:167]
  v_mfma_f32_16x16x32_bf16 v[168:171], a[64:67], v[40:43], v[168:171]
  v_mfma_f32_16x16x32_bf16 v[172:175], a[68:71], v[40:43], v[172:175]
  s_add_u32 s64, s66, 4096
  buffer_load_dwordx4 v[96:99], v2, s[40:43], s64 offen sc1
  v_mfma_f32_16x16x32_bf16 v[176:179], a[72:75], v[40:43], v[176:179]
  v_mfma_f32_16x16x32_bf16 v[180:183], a[76:79], v[40:43], v[180:183]
  s_add_u32 s64, s66, 59392
  buffer_load_dwordx4 v[100:103], v2, s[40:43], s64 offen sc1
  v_mfma_f32_16x16x32_bf16 v[184:187], a[80:83], v[40:43], v[184:187]
  v_mfma_f32_16x16x32_bf16 v[188:191], a[64:67], v[44:47], v[188:191]
  v_mfma_f32_16x16x32_bf16 v[192:195], a[68:71], v[44:47], v[192:195]
  s_add_u32 s64, s66, 114688
  buffer_load_dwordx4 v[104:107], v2, s[40:43], s64 offen sc1
  v_mfma_f32_16x16x32_bf16 v[196:199], a[72:75], v[44:47], v[196:199]
  v_mfma_f32_16x16x32_bf16 v[200:203], a[76:79], v[44:47], v[200:203]
  s_add_u32 s64, s66, 169984
  buffer_load_dwordx4 v[108:111], v2, s[40:43], s64 offen sc1
  v_mfma_f32_16x16x32_bf16 v[204:207], a[80:83], v[44:47], v[204:207]
  s_waitcnt vmcnt(12)
  v_mfma_f32_16x16x32_bf16 v[128:131], a[84:87], v[48:51], v[128:131]
  v_mfma_f32_16x16x32_bf16 v[132:135], a[88:91], v[48:51], v[132:135]
  s_add_u32 s64, s66, 5120
  buffer_load_dwordx4 v[112:115], v2, s[40:43], s64 offen sc1
  v_mfma_f32_16x16x32_bf16 v[136:139], a[92:95], v[48:51], v[136:139]
  v_mfma_f32_16x16x32_bf16 v[140:143], a[96:99], v[48:51], v[140:143]
  s_add_u32 s64, s66, 60416
  buffer_load_dwordx4 v[116:119], v2, s[40:43], s64 offen sc1
  v_mfma_f32_16x16x32_bf16 v[144:147], a[100:103], v[48:51], v[144:147]
  v_mfma_f32_16x16x32_bf16 v[148:151], a[84:87], v[52:55], v[148:151]
  v_mfma_f32_16x16x32_bf16 v[152:155], a[88:91], v[52:55], v[152:155]
  s_add_u32 s64, s66, 115712
  buffer_load_dwordx4 v[120:123], v2, s[40:43], s64 offen sc1
  v_mfma_f32_16x16x32_bf16 v[156:159], a[92:95], v[52:55], v[156:159]
  v_mfma_f32_16x16x32_bf16 v[160:163], a[96:99], v[52:55], v[160:163]
  s_add_u32 s64, s66, 171008
  buffer_load_dwordx4 v[124:127], v2, s[40:43], s64 offen sc1
  v_mfma_f32_16x16x32_bf16 v[164:167], a[100:103], v[52:55], v[164:167]
  v_mfma_f32_16x16x32_bf16 v[168:171], a[84:87], v[56:59], v[168:171]
  v_mfma_f32_16x16x32_bf16 v[172:175], a[88:91], v[56:59], v[172:175]
  s_add_u32 s64, s66, 6144
  buffer_load_dwordx4 v[208:211], v2, s[40:43], s64 offen sc1
  v_mfma_f32_16x16x32_bf16 v[176:179], a[92:95], v[56:59], v[176:179]
  v_mfma_f32_16x16x32_bf16 v[180:183], a[96:99], v[56:59], v[180:183]
  s_add_u32 s64, s66, 61440
  buffer_load_dwordx4 v[212:215], v2, s[40:43], s64 offen sc1
  v_mfma_f32_16x16x32_bf16 v[184:187], a[100:103], v[56:59], v[184:187]
  v_mfma_f32_16x16x32_bf16 v[188:191], a[84:87], v[60:63], v[188:191]
  v_mfma_f32_16x16x32_bf16 v[192:195], a[88:91], v[60:63], v[192:195]
  s_add_u32 s64, s66, 116736
  buffer_load_dwordx4 v[216:219], v2, s[40:43], s64 offen sc1
  v_mfma_f32_16x16x32_bf16 v[196:199], a[92:95], v[60:63], v[196:199]
  v_mfma_f32_16x16x32_bf16 v[200:203], a[96:99], v[60:63], v[200:203]
  s_add_u32 s64, s66, 172032
  buffer_load_dwordx4 v[220:223], v2, s[40:43], s64 offen sc1
  v_mfma_f32_16x16x32_bf16 v[204:207], a[100:103], v[60:63], v[204:207]
  s_waitcnt vmcnt(16)
  v_mfma_f32_16x16x32_bf16 v[128:131], a[104:107], v[64:67], v[128:131]
  v_mfma_f32_16x16x32_bf16 v[132:135], a[108:111], v[64:67], v[132:135]
  s_add_u32 s64, s66, 7168
  buffer_load_dwordx4 v[224:227], v2, s[40:43], s64 offen sc1
  v_mfma_f32_16x16x32_bf16 v[136:139], a[112:115], v[64:67], v[136:139]
  v_mfma_f32_16x16x32_bf16 v[140:143], a[116:119], v[64:67], v[140:143]
  s_add_u32 s64, s66, 62464
  buffer_load_dwordx4 v[228:231], v2, s[40:43], s64 offen sc1
  v_mfma_f32_16x16x32_bf16 v[144:147], a[120:123], v[64:67], v[144:147]
  v_mfma_f32_16x16x32_bf16 v[148:151], a[104:107], v[68:71], v[148:151]
  v_mfma_f32_16x16x32_bf16 v[152:155], a[108:111], v[68:71], v[152:155]
  s_add_u32 s64, s66, 117760
  buffer_load_dwordx4 v[232:235], v2, s[40:43], s64 offen sc1
  v_mfma_f32_16x16x32_bf16 v[156:159], a[112:115], v[68:71], v[156:159]
  v_mfma_f32_16x16x32_bf16 v[160:163], a[116:119], v[68:71], v[160:163]
  s_add_u32 s64, s66, 173056
  buffer_load_dwordx4 v[236:239], v2, s[40:43], s64 offen sc1
  v_mfma_f32_16x16x32_bf16 v[164:167], a[120:123], v[68:71], v[164:167]
  v_mfma_f32_16x16x32_bf16 v[168:171], a[104:107], v[72:75], v[168:171]
  v_mfma_f32_16x16x32_bf16 v[172:175], a[108:111], v[72:75], v[172:175]
  s_add_u32 s64, s66, 8192
  buffer_load_dwordx4 v[240:243], v2, s[40:43], s64 offen sc1
  v_mfma_f32_16x16x32_bf16 v[176:179], a[112:115], v[72:75], v[176:179]
  v_mfma_f32_16x16x32_bf16 v[180:183], a[116:119], v[72:75], v[180:183]
  s_add_u32 s64, s66, 63488
  buffer_load_dwordx4 v[244:247], v2, s[40:43], s64 offen sc1
  v_mfma_f32_16x16x32_bf16 v[184:187], a[120:123], v[72:75], v[184:187]
  v_mfma_f32_16x16x32_bf16 v[188:191], a[104:107], v[76:79], v[188:191]
  v_mfma_f32_16x16x32_bf16 v[192:195], a[108:111], v[76:79], v[192:195]
  s_add_u32 s64, s66, 118784
  buffer_load_dwordx4 v[248:251], v2, s[40:43], s64 offen sc1
  v_mfma_f32_16x16x32_bf16 v[196:199], a[112:115], v[76:79], v[196:199]
  v_mfma_f32_16x16x32_bf16 v[200:203], a[116:119], v[76:79], v[200:203]
  s_add_u32 s64, s66, 174080
  buffer_load_dwordx4 v[252:255], v2, s[40:43], s64 offen sc1
  v_mfma_f32_16x16x32_bf16 v[204:207], a[120:123], v[76:79], v[204:207]
  s_waitcnt vmcnt(20)
  v_mfma_f32_16x16x32_bf16 v[128:131], a[124:127], v[80:83], v[128:131]
  v_mfma_f32_16x16x32_bf16 v[132:135], a[128:131], v[80:83], v[132:135]
  s_add_u32 s64, s66, 9216
  buffer_load_dwordx4 v[32:35], v2, s[40:43], s64 offen sc1
  v_mfma_f32_16x16x32_bf16 v[136:139], a[132:135], v[80:83], v[136:139]
  v_mfma_f32_16x16x32_bf16 v[140:143], a[136:139], v[80:83], v[140:143]
  s_add_u32 s64, s66, 64512
  buffer_load_dwordx4 v[36:39], v2, s[40:43], s64 offen sc1
  v_mfma_f32_16x16x32_bf16 v[144:147], a[140:143], v[80:83], v[144:147]
  v_mfma_f32_16x16x32_bf16 v[148:151], a[124:127], v[84:87], v[148:151]
  v_mfma_f32_16x16x32_bf16 v[152:155], a[128:131], v[84:87], v[152:155]
  s_add_u32 s64, s66, 119808
  buffer_load_dwordx4 v[40:43], v2, s[40:43], s64 offen sc1
  v_mfma_f32_16x16x32_bf16 v[156:159], a[132:135], v[84:87], v[156:159]
  v_mfma_f32_16x16x32_bf16 v[160:163], a[136:139], v[84:87], v[160:163]
  s_add_u32 s64, s66, 175104
  buffer_load_dwordx4 v[44:47], v2, s[40:43], s64 offen sc1
  v_mfma_f32_16x16x32_bf16 v[164:167], a[140:143], v[84:87], v[164:167]
  v_mfma_f32_16x16x32_bf16 v[168:171], a[124:127], v[88:91], v[168:171]
  v_mfma_f32_16x16x32_bf16 v[172:175], a[128:131], v[88:91], v[172:175]
  s_add_u32 s63, s65, 12288
  s_cmp_eq_u32 s19, 3
  s_cselect_b32 s63, 2146435072, s63
  buffer_load_dwordx4 a[64:67], v2, s[56:59], s63 offen
  v_mfma_f32_16x16x32_bf16 v[176:179], a[132:135], v[88:91], v[176:179]
  v_mfma_f32_16x16x32_bf16 v[180:183], a[136:139], v[88:91], v[180:183]
  s_add_u32 s63, s65, 67584
  s_cmp_eq_u32 s19, 3
  s_cselect_b32 s63, 2146435072, s63
  buffer_load_dwordx4 a[68:71], v2, s[56:59], s63 offen
  v_mfma_f32_16x16x32_bf16 v[184:187], a[140:143], v[88:91], v[184:187]
  v_mfma_f32_16x16x32_bf16 v[188:191], a[124:127], v[92:95], v[188:191]
  v_mfma_f32_16x16x32_bf16 v[192:195], a[128:131], v[92:95], v[192:195]
  s_add_u32 s63, s65, 122880
  s_cmp_eq_u32 s19, 3
  s_cselect_b32 s63, 2146435072, s63
  buffer_load_dwordx4 a[72:75], v2, s[56:59], s63 offen
  v_mfma_f32_16x16x32_bf16 v[196:199], a[132:135], v[92:95], v[196:199]
  v_mfma_f32_16x16x32_bf16 v[200:203], a[136:139], v[92:95], v[200:203]
  s_add_u32 s63, s65, 178176
  s_cmp_eq_u32 s19, 3
  s_cselect_b32 s63, 2146435072, s63
  buffer_load_dwordx4 a[76:79], v2, s[56:59], s63 offen
  v_mfma_f32_16x16x32_bf16 v[204:207], a[140:143], v[92:95], v[204:207]
  s_waitcnt vmcnt(24)
  v_mfma_f32_16x16x32_bf16 v[128:131], a[144:147], v[96:99], v[128:131]
  v_mfma_f32_16x16x32_bf16 v[132:135], a[148:151], v[96:99], v[132:135]
  s_add_u32 s63, s65, 233472
  s_cmp_eq_u32 s19, 3
  s_cselect_b32 s63, 2146435072, s63
  buffer_load_dwordx4 a[80:83], v2, s[56:59], s63 offen
  v_mfma_f32_16x16x32_bf16 v[136:139], a[152:155], v[96:99], v[136:139]
  v_mfma_f32_16x16x32_bf16 v[140:143], a[156:159], v[96:99], v[140:143]
  s_add_u32 s64, s66, 10240
  buffer_load_dwordx4 v[48:51], v2, s[40:43], s64 offen sc1
  v_mfma_f32_16x16x32_bf16 v[144:147], a[160:163], v[96:99], v[144:147]
  v_mfma_f32_16x16x32_bf16 v[148:151], a[144:147], v[100:103], v[148:151]
  v_mfma_f32_16x16x32_bf16 v[152:155], a[148:151], v[100:103], v[152:155]
  s_add_u32 s64, s66, 65536
  buffer_load_dwordx4 v[52:55], v2, s[40:43], s64 offen sc1
  v_mfma_f32_16x16x32_bf16 v[156:159], a[152:155], v[100:103], v[156:159]
  v_mfma_f32_16x16x32_bf16 v[160:163], a[156:159], v[100:103], v[160:163]
  s_add_u32 s64, s66, 120832
  buffer_load_dwordx4 v[56:59], v2, s[40:43], s64 offen sc1
  v_mfma_f32_16x16x32_bf16 v[164:167], a[160:163], v[100:103], v[164:167]
  v_mfma_f32_16x16x32_bf16 v[168:171], a[144:147], v[104:107], v[168:171]
  v_mfma_f32_16x16x32_bf16 v[172:175], a[148:151], v[104:107], v[172:175]
  s_add_u32 s64, s66, 176128
  buffer_load_dwordx4 v[60:63], v2, s[40:43], s64 offen sc1
  v_mfma_f32_16x16x32_bf16 v[176:179], a[152:155], v[104:107], v[176:179]
  v_mfma_f32_16x16x32_bf16 v[180:183], a[156:159], v[104:107], v[180:183]
  s_add_u32 s63, s65, 13312
  s_cmp_eq_u32 s19, 3
  s_cselect_b32 s63, 2146435072, s63
  buffer_load_dwordx4 a[84:87], v2, s[56:59], s63 offen
  v_mfma_f32_16x16x32_bf16 v[184:187], a[160:163], v[104:107], v[184:187]
  v_mfma_f32_16x16x32_bf16 v[188:191], a[144:147], v[108:111], v[188:191]
  v_mfma_f32_16x16x32_bf16 v[192:195], a[148:151], v[108:111], v[192:195]
  s_add_u32 s63, s65, 68608
  s_cmp_eq_u32 s19, 3
  s_cselect_b32 s63, 2146435072, s63
  buffer_load_dwordx4 a[88:91], v2, s[56:59], s63 offen
  v_mfma_f32_16x16x32_bf16 v[196:199], a[152:155], v[108:111], v[196:199]
  v_mfma_f32_16x16x32_bf16 v[200:203], a[156:159], v[108:111], v[200:203]
  s_add_u32 s63, s65, 123904
  s_cmp_eq_u32 s19, 3
  s_cselect_b32 s63, 2146435072, s63
  buffer_load_dwordx4 a[92:95], v2, s[56:59], s63 offen
  v_mfma_f32_16x16x32_bf16 v[204:207], a[160:163], v[108:111], v[204:207]
  s_waitcnt vmcnt(28)
  v_mfma_f32_16x16x32_bf16 v[128:131], a[164:167], v[112:115], v[128:131]
  v_mfma_f32_16x16x32_bf16 v[132:135], a[168:171], v[112:115], v[132:135]
  s_add_u32 s63, s65, 179200
  s_cmp_eq_u32 s19, 3
  s_cselect_b32 s63, 2146435072, s63
  buffer_load_dwordx4 a[96:99], v2, s[56:59], s63 offen
  v_mfma_f32_16x16x32_bf16 v[136:139], a[172:175], v[112:115], v[136:139]
  v_mfma_f32_16x16x32_bf16 v[140:143], a[176:179], v[112:115], v[140:143]
  s_add_u32 s63, s65, 234496
  s_cmp_eq_u32 s19, 3
  s_cselect_b32 s63, 2146435072, s63
  buffer_load_dwordx4 a[100:103], v2, s[56:59], s63 offen
  v_mfma_f32_16x16x32_bf16 v[144:147], a[180:183], v[112:115], v[144:147]
  v_mfma_f32_16x16x32_bf16 v[148:151], a[164:167], v[116:119], v[148:151]
  v_mfma_f32_16x16x32_bf16 v[152:155], a[168:171], v[116:119], v[152:155]
  s_add_u32 s64, s66, 11264
  buffer_load_dwordx4 v[64:67], v2, s[40:43], s64 offen sc1
  v_mfma_f32_16x16x32_bf16 v[156:159], a[172:175], v[116:119], v[156:159]
  v_mfma_f32_16x16x32_bf16 v[160:163], a[176:179], v[116:119], v[160:163]
  s_add_u32 s64, s66, 66560
  buffer_load_dwordx4 v[68:71], v2, s[40:43], s64 offen sc1
  v_mfma_f32_16x16x32_bf16 v[164:167], a[180:183], v[116:119], v[164:167]
  v_mfma_f32_16x16x32_bf16 v[168:171], a[164:167], v[120:123], v[168:171]
  v_mfma_f32_16x16x32_bf16 v[172:175], a[168:171], v[120:123], v[172:175]
  s_add_u32 s64, s66, 121856
  buffer_load_dwordx4 v[72:75], v2, s[40:43], s64 offen sc1
  v_mfma_f32_16x16x32_bf16 v[176:179], a[172:175], v[120:123], v[176:179]
  v_mfma_f32_16x16x32_bf16 v[180:183], a[176:179], v[120:123], v[180:183]
  s_add_u32 s64, s66, 177152
  buffer_load_dwordx4 v[76:79], v2, s[40:43], s64 offen sc1
  v_mfma_f32_16x16x32_bf16 v[184:187], a[180:183], v[120:123], v[184:187]
  v_mfma_f32_16x16x32_bf16 v[188:191], a[164:167], v[124:127], v[188:191]
  v_mfma_f32_16x16x32_bf16 v[192:195], a[168:171], v[124:127], v[192:195]
  s_add_u32 s64, s66, 12288
  s_cmp_eq_u32 s19, 3
  s_cselect_b32 s64, 2146435072, s64
  buffer_load_dwordx4 v[80:83], v2, s[40:43], s64 offen sc1
  v_mfma_f32_16x16x32_bf16 v[196:199], a[172:175], v[124:127], v[196:199]
  v_mfma_f32_16x16x32_bf16 v[200:203], a[176:179], v[124:127], v[200:203]
  s_add_u32 s64, s66, 67584
  s_cmp_eq_u32 s19, 3
  s_cselect_b32 s64, 2146435072, s64
  buffer_load_dwordx4 v[84:87], v2, s[40:43], s64 offen sc1
  v_mfma_f32_16x16x32_bf16 v[204:207], a[180:183], v[124:127], v[204:207]
  s_waitcnt vmcnt(32)
  v_mfma_f32_16x16x32_bf16 v[128:131], a[184:187], v[208:211], v[128:131]
  v_mfma_f32_16x16x32_bf16 v[132:135], a[188:191], v[208:211], v[132:135]
  s_add_u32 s64, s66, 122880
  s_cmp_eq_u32 s19, 3
  s_cselect_b32 s64, 2146435072, s64
  buffer_load_dwordx4 v[88:91], v2, s[40:43], s64 offen sc1
  v_mfma_f32_16x16x32_bf16 v[136:139], a[192:195], v[208:211], v[136:139]
  v_mfma_f32_16x16x32_bf16 v[140:143], a[196:199], v[208:211], v[140:143]
  s_add_u32 s64, s66, 178176
  s_cmp_eq_u32 s19, 3
  s_cselect_b32 s64, 2146435072, s64
  buffer_load_dwordx4 v[92:95], v2, s[40:43], s64 offen sc1
  v_mfma_f32_16x16x32_bf16 v[144:147], a[200:203], v[208:211], v[144:147]
  v_mfma_f32_16x16x32_bf16 v[148:151], a[184:187], v[212:215], v[148:151]
  v_mfma_f32_16x16x32_bf16 v[152:155], a[188:191], v[212:215], v[152:155]
  s_add_u32 s64, s66, 13312
  s_cmp_eq_u32 s19, 3
  s_cselect_b32 s64, 2146435072, s64
  buffer_load_dwordx4 v[96:99], v2, s[40:43], s64 offen sc1
  v_mfma_f32_16x16x32_bf16 v[156:159], a[192:195], v[212:215], v[156:159]
  v_mfma_f32_16x16x32_bf16 v[160:163], a[196:199], v[212:215], v[160:163]
  s_add_u32 s64, s66, 68608
  s_cmp_eq_u32 s19, 3
  s_cselect_b32 s64, 2146435072, s64
  buffer_load_dwordx4 v[100:103], v2, s[40:43], s64 offen sc1
  v_mfma_f32_16x16x32_bf16 v[164:167], a[200:203], v[212:215], v[164:167]
  v_mfma_f32_16x16x32_bf16 v[168:171], a[184:187], v[216:219], v[168:171]
  v_mfma_f32_16x16x32_bf16 v[172:175], a[188:191], v[216:219], v[172:175]
  s_add_u32 s64, s66, 123904
  s_cmp_eq_u32 s19, 3
  s_cselect_b32 s64, 2146435072, s64
  buffer_load_dwordx4 v[104:107], v2, s[40:43], s64 offen sc1
  v_mfma_f32_16x16x32_bf16 v[176:179], a[192:195], v[216:219], v[176:179]
  v_mfma_f32_16x16x32_bf16 v[180:183], a[196:199], v[216:219], v[180:183]
  s_add_u32 s64, s66, 179200
  s_cmp_eq_u32 s19, 3
  s_cselect_b32 s64, 2146435072, s64
  buffer_load_dwordx4 v[108:111], v2, s[40:43], s64 offen sc1
  v_mfma_f32_16x16x32_bf16 v[184:187], a[200:203], v[216:219], v[184:187]
  v_mfma_f32_16x16x32_bf16 v[188:191], a[184:187], v[220:223], v[188:191]
  v_mfma_f32_16x16x32_bf16 v[192:195], a[188:191], v[220:223], v[192:195]
  v_mfma_f32_16x16x32_bf16 v[196:199], a[192:195], v[220:223], v[196:199]
  v_mfma_f32_16x16x32_bf16 v[200:203], a[196:199], v[220:223], v[200:203]
  v_mfma_f32_16x16x32_bf16 v[204:207], a[200:203], v[220:223], v[204:207]
  s_waitcnt vmcnt(34)
  v_mfma_f32_16x16x32_bf16 v[128:131], a[204:207], v[224:227], v[128:131]
  v_mfma_f32_16x16x32_bf16 v[132:135], a[208:211], v[224:227], v[132:135]
  v_mfma_f32_16x16x32_bf16 v[136:139], a[212:215], v[224:227], v[136:139]
  v_mfma_f32_16x16x32_bf16 v[140:143], a[216:219], v[224:227], v[140:143]
  v_mfma_f32_16x16x32_bf16 v[144:147], a[220:223], v[224:227], v[144:147]
  v_mfma_f32_16x16x32_bf16 v[148:151], a[204:207], v[228:231], v[148:151]
  v_mfma_f32_16x16x32_bf16 v[152:155], a[208:211], v[228:231], v[152:155]
  v_mfma_f32_16x16x32_bf16 v[156:159], a[212:215], v[228:231], v[156:159]
  v_mfma_f32_16x16x32_bf16 v[160:163], a[216:219], v[228:231], v[160:163]
  v_mfma_f32_16x16x32_bf16 v[164:167], a[220:223], v[228:231], v[164:167]
  v_mfma_f32_16x16x32_bf16 v[168:171], a[204:207], v[232:235], v[168:171]
  v_mfma_f32_16x16x32_bf16 v[172:175], a[208:211], v[232:235], v[172:175]
  v_mfma_f32_16x16x32_bf16 v[176:179], a[212:215], v[232:235], v[176:179]
  v_mfma_f32_16x16x32_bf16 v[180:183], a[216:219], v[232:235], v[180:183]
  v_mfma_f32_16x16x32_bf16 v[184:187], a[220:223], v[232:235], v[184:187]
  v_mfma_f32_16x16x32_bf16 v[188:191], a[204:207], v[236:239], v[188:191]
  v_mfma_f32_16x16x32_bf16 v[192:195], a[208:211], v[236:239], v[192:195]
  v_mfma_f32_16x16x32_bf16 v[196:199], a[212:215], v[236:239], v[196:199]
  v_mfma_f32_16x16x32_bf16 v[200:203], a[216:219], v[236:239], v[200:203]
  v_mfma_f32_16x16x32_bf16 v[204:207], a[220:223], v[236:239], v[204:207]
  s_waitcnt vmcnt(30)
  v_mfma_f32_16x16x32_bf16 v[128:131], a[224:227], v[240:243], v[128:131]
  v_mfma_f32_16x16x32_bf16 v[132:135], a[228:231], v[240:243], v[132:135]
  v_mfma_f32_16x16x32_bf16 v[136:139], a[232:235], v[240:243], v[136:139]
  v_mfma_f32_16x16x32_bf16 v[140:143], a[236:239], v[240:243], v[140:143]
  v_mfma_f32_16x16x32_bf16 v[144:147], a[240:243], v[240:243], v[144:147]
  v_mfma_f32_16x16x32_bf16 v[148:151], a[224:227], v[244:247], v[148:151]
  v_mfma_f32_16x16x32_bf16 v[152:155], a[228:231], v[244:247], v[152:155]
  v_mfma_f32_16x16x32_bf16 v[156:159], a[232:235], v[244:247], v[156:159]
  v_mfma_f32_16x16x32_bf16 v[160:163], a[236:239], v[244:247], v[160:163]
  v_mfma_f32_16x16x32_bf16 v[164:167], a[240:243], v[244:247], v[164:167]
  v_mfma_f32_16x16x32_bf16 v[168:171], a[224:227], v[248:251], v[168:171]
  v_mfma_f32_16x16x32_bf16 v[172:175], a[228:231], v[248:251], v[172:175]
  v_mfma_f32_16x16x32_bf16 v[176:179], a[232:235], v[248:251], v[176:179]
  v_mfma_f32_16x16x32_bf16 v[180:183], a[236:239], v[248:251], v[180:183]
  v_mfma_f32_16x16x32_bf16 v[184:187], a[240:243], v[248:251], v[184:187]
  v_mfma_f32_16x16x32_bf16 v[188:191], a[224:227], v[252:255], v[188:191]
  v_mfma_f32_16x16x32_bf16 v[192:195], a[228:231], v[252:255], v[192:195]
  v_mfma_f32_16x16x32_bf16 v[196:199], a[232:235], v[252:255], v[196:199]
  v_mfma_f32_16x16x32_bf16 v[200:203], a[236:239], v[252:255], v[200:203]
  v_mfma_f32_16x16x32_bf16 v[204:207], a[240:243], v[252:255], v[204:207]
  s_waitcnt vmcnt(26)
  v_mfma_f32_16x16x32_bf16 v[128:131], a[0:3], v[32:35], v[128:131]
  v_mfma_f32_16x16x32_bf16 v[132:135], a[4:7], v[32:35], v[132:135]
  s_mov_b32 s26, 0
  buffer_load_dwordx2 v[112:113], v16, s[8:11], s26 offen
  v_mfma_f32_16x16x32_bf16 v[136:139], a[8:11], v[32:35], v[136:139]
  v_mfma_f32_16x16x32_bf16 v[140:143], a[12:15], v[32:35], v[140:143]
  buffer_load_dwordx4 v[208:211], v17, s[72:75], 0 offen offset:0
  v_mfma_f32_16x16x32_bf16 v[144:147], a[16:19], v[32:35], v[144:147]
  v_mfma_f32_16x16x32_bf16 v[148:151], a[0:3], v[36:39], v[148:151]
  v_mfma_f32_16x16x32_bf16 v[152:155], a[4:7], v[36:39], v[152:155]
  s_mov_b32 s26, 66560
  buffer_load_dwordx2 v[114:115], v16, s[8:11], s26 offen
  v_mfma_f32_16x16x32_bf16 v[156:159], a[8:11], v[36:39], v[156:159]
  v_mfma_f32_16x16x32_bf16 v[160:163], a[12:15], v[36:39], v[160:163]
  buffer_load_dwordx4 v[212:215], v17, s[72:75], 0 offen offset:64
  v_mfma_f32_16x16x32_bf16 v[164:167], a[16:19], v[36:39], v[164:167]
  v_mfma_f32_16x16x32_bf16 v[168:171], a[0:3], v[40:43], v[168:171]
  v_mfma_f32_16x16x32_bf16 v[172:175], a[4:7], v[40:43], v[172:175]
  s_mov_b32 s26, 133120
  buffer_load_dwordx2 v[116:117], v16, s[8:11], s26 offen
  v_mfma_f32_16x16x32_bf16 v[176:179], a[8:11], v[40:43], v[176:179]
  v_mfma_f32_16x16x32_bf16 v[180:183], a[12:15], v[40:43], v[180:183]
  buffer_load_dwordx4 v[216:219], v17, s[72:75], 0 offen offset:128
  v_mfma_f32_16x16x32_bf16 v[184:187], a[16:19], v[40:43], v[184:187]
  v_mfma_f32_16x16x32_bf16 v[188:191], a[0:3], v[44:47], v[188:191]
  v_mfma_f32_16x16x32_bf16 v[192:195], a[4:7], v[44:47], v[192:195]
  s_mov_b32 s26, 199680
  buffer_load_dwordx2 v[118:119], v16, s[8:11], s26 offen
  v_mfma_f32_16x16x32_bf16 v[196:199], a[8:11], v[44:47], v[196:199]
  v_mfma_f32_16x16x32_bf16 v[200:203], a[12:15], v[44:47], v[200:203]
  buffer_load_dwordx4 v[220:223], v17, s[72:75], 0 offen offset:192
  v_mfma_f32_16x16x32_bf16 v[204:207], a[16:19], v[44:47], v[204:207]
  s_waitcnt vmcnt(25)
  v_mfma_f32_16x16x32_bf16 v[128:131], a[20:23], v[48:51], v[128:131]
  v_mfma_f32_16x16x32_bf16 v[132:135], a[24:27], v[48:51], v[132:135]
  s_mov_b32 s26, 266240
  buffer_load_dwordx2 v[120:121], v16, s[8:11], s26 offen
  v_mfma_f32_16x16x32_bf16 v[136:139], a[28:31], v[48:51], v[136:139]
  v_mfma_f32_16x16x32_bf16 v[140:143], a[32:35], v[48:51], v[140:143]
  buffer_load_dwordx4 v[224:227], v17, s[72:75], 0 offen offset:256
  v_mfma_f32_16x16x32_bf16 v[144:147], a[36:39], v[48:51], v[144:147]
  v_mfma_f32_16x16x32_bf16 v[148:151], a[20:23], v[52:55], v[148:151]
  v_mfma_f32_16x16x32_bf16 v[152:155], a[24:27], v[52:55], v[152:155]
  v_mfma_f32_16x16x32_bf16 v[156:159], a[28:31], v[52:55], v[156:159]
  v_mfma_f32_16x16x32_bf16 v[160:163], a[32:35], v[52:55], v[160:163]
  v_mfma_f32_16x16x32_bf16 v[164:167], a[36:39], v[52:55], v[164:167]
  v_mfma_f32_16x16x32_bf16 v[168:171], a[20:23], v[56:59], v[168:171]
  v_mfma_f32_16x16x32_bf16 v[172:175], a[24:27], v[56:59], v[172:175]
  v_mfma_f32_16x16x32_bf16 v[176:179], a[28:31], v[56:59], v[176:179]
  v_mfma_f32_16x16x32_bf16 v[180:183], a[32:35], v[56:59], v[180:183]
  v_mfma_f32_16x16x32_bf16 v[184:187], a[36:39], v[56:59], v[184:187]
  v_mfma_f32_16x16x32_bf16 v[188:191], a[20:23], v[60:63], v[188:191]
  v_mfma_f32_16x16x32_bf16 v[192:195], a[24:27], v[60:63], v[192:195]
  v_mfma_f32_16x16x32_bf16 v[196:199], a[28:31], v[60:63], v[196:199]
  v_mfma_f32_16x16x32_bf16 v[200:203], a[32:35], v[60:63], v[200:203]
  v_mfma_f32_16x16x32_bf16 v[204:207], a[36:39], v[60:63], v[204:207]
  s_waitcnt vmcnt(18)
  v_mfma_f32_16x16x32_bf16 v[128:131], a[40:43], v[64:67], v[128:131]
  v_mfma_f32_16x16x32_bf16 v[132:135], a[44:47], v[64:67], v[132:135]
  v_mfma_f32_16x16x32_bf16 v[136:139], a[48:51], v[64:67], v[136:139]
  v_mfma_f32_16x16x32_bf16 v[140:143], a[52:55], v[64:67], v[140:143]
  v_mfma_f32_16x16x32_bf16 v[144:147], a[56:59], v[64:67], v[144:147]
  v_mfma_f32_16x16x32_bf16 v[148:151], a[40:43], v[68:71], v[148:151]
  v_mfma_f32_16x16x32_bf16 v[152:155], a[44:47], v[68:71], v[152:155]
  v_mfma_f32_16x16x32_bf16 v[156:159], a[48:51], v[68:71], v[156:159]
  v_mfma_f32_16x16x32_bf16 v[160:163], a[52:55], v[68:71], v[160:163]
  v_mfma_f32_16x16x32_bf16 v[164:167], a[56:59], v[68:71], v[164:167]
  v_mfma_f32_16x16x32_bf16 v[168:171], a[40:43], v[72:75], v[168:171]
  v_mfma_f32_16x16x32_bf16 v[172:175], a[44:47], v[72:75], v[172:175]
  v_mfma_f32_16x16x32_bf16 v[176:179], a[48:51], v[72:75], v[176:179]
  v_mfma_f32_16x16x32_bf16 v[180:183], a[52:55], v[72:75], v[180:183]
  v_mfma_f32_16x16x32_bf16 v[184:187], a[56:59], v[72:75], v[184:187]
  v_mfma_f32_16x16x32_bf16 v[188:191], a[40:43], v[76:79], v[188:191]
  v_mfma_f32_16x16x32_bf16 v[192:195], a[44:47], v[76:79], v[192:195]
  v_mfma_f32_16x16x32_bf16 v[196:199], a[48:51], v[76:79], v[196:199]
  v_mfma_f32_16x16x32_bf16 v[200:203], a[52:55], v[76:79], v[200:203]
  v_mfma_f32_16x16x32_bf16 v[204:207], a[56:59], v[76:79], v[204:207]
  s_waitcnt vmcnt(14)
  v_mfma_f32_16x16x32_bf16 v[128:131], a[64:67], v[80:83], v[128:131]
  v_mfma_f32_16x16x32_bf16 v[132:135], a[68:71], v[80:83], v[132:135]
  v_mfma_f32_16x16x32_bf16 v[136:139], a[72:75], v[80:83], v[136:139]
  v_mfma_f32_16x16x32_bf16 v[140:143], a[76:79], v[80:83], v[140:143]
  v_mfma_f32_16x16x32_bf16 v[144:147], a[80:83], v[80:83], v[144:147]
  v_mfma_f32_16x16x32_bf16 v[148:151], a[64:67], v[84:87], v[148:151]
  v_mfma_f32_16x16x32_bf16 v[152:155], a[68:71], v[84:87], v[152:155]
  v_mfma_f32_16x16x32_bf16 v[156:159], a[72:75], v[84:87], v[156:159]
  v_mfma_f32_16x16x32_bf16 v[160:163], a[76:79], v[84:87], v[160:163]
  v_mfma_f32_16x16x32_bf16 v[164:167], a[80:83], v[84:87], v[164:167]
  v_mfma_f32_16x16x32_bf16 v[168:171], a[64:67], v[88:91], v[168:171]
  v_mfma_f32_16x16x32_bf16 v[172:175], a[68:71], v[88:91], v[172:175]
  v_mfma_f32_16x16x32_bf16 v[176:179], a[72:75], v[88:91], v[176:179]
  v_mfma_f32_16x16x32_bf16 v[180:183], a[76:79], v[88:91], v[180:183]
  v_mfma_f32_16x16x32_bf16 v[184:187], a[80:83], v[88:91], v[184:187]
  v_mfma_f32_16x16x32_bf16 v[188:191], a[64:67], v[92:95], v[188:191]
  v_mfma_f32_16x16x32_bf16 v[192:195], a[68:71], v[92:95], v[192:195]
  v_mfma_f32_16x16x32_bf16 v[196:199], a[72:75], v[92:95], v[196:199]
  v_mfma_f32_16x16x32_bf16 v[200:203], a[76:79], v[92:95], v[200:203]
  v_mfma_f32_16x16x32_bf16 v[204:207], a[80:83], v[92:95], v[204:207]
  s_waitcnt vmcnt(10)
  s_cmp_eq_u32 s19, 1
  s_cbranch_scc1 L_k3_kernel_w1_7
  s_cmp_eq_u32 s19, 2
  s_cbranch_scc1 L_k3_kernel_w2_8
  s_cmp_eq_u32 s19, 3
  s_cbranch_scc1 L_k3_kernel_w3_9
L_k3_kernel_w0_6:
  v_mfma_f32_16x16x32_bf16 v[148:151], a[84:87], v[100:103], v[148:151]
  v_mfma_f32_16x16x32_bf16 v[152:155], a[88:91], v[100:103], v[152:155]
  v_mfma_f32_16x16x32_bf16 v[156:159], a[92:95], v[100:103], v[156:159]
  v_mfma_f32_16x16x32_bf16 v[160:163], a[96:99], v[100:103], v[160:163]
  v_mfma_f32_16x16x32_bf16 v[164:167], a[100:103], v[100:103], v[164:167]
  v_mfma_f32_16x16x32_bf16 v[168:171], a[84:87], v[104:107], v[168:171]
  v_mfma_f32_16x16x32_bf16 v[172:175], a[88:91], v[104:107], v[172:175]
  v_mfma_f32_16x16x32_bf16 v[176:179], a[92:95], v[104:107], v[176:179]
  s_nop 0
  ds_write_b128 v2, v[148:151] offset:25600
  v_mfma_f32_16x16x32_bf16 v[180:183], a[96:99], v[104:107], v[180:183]
  ds_write_b128 v2, v[152:155] offset:26624
  v_mfma_f32_16x16x32_bf16 v[184:187], a[100:103], v[104:107], v[184:187]
  ds_write_b128 v2, v[156:159] offset:27648
  ds_write_b128 v2, v[160:163] offset:28672
  ds_write_b128 v2, v[164:167] offset:29696
  v_mfma_f32_16x16x32_bf16 v[188:191], a[84:87], v[108:111], v[188:191]
  v_mfma_f32_16x16x32_bf16 v[192:195], a[88:91], v[108:111], v[192:195]
  v_mfma_f32_16x16x32_bf16 v[196:199], a[92:95], v[108:111], v[196:199]
  ds_write_b128 v2, v[168:171] offset:35840
  v_mfma_f32_16x16x32_bf16 v[200:203], a[96:99], v[108:111], v[200:203]
  ds_write_b128 v2, v[172:175] offset:36864
  v_mfma_f32_16x16x32_bf16 v[204:207], a[100:103], v[108:111], v[204:207]
  ds_write_b128 v2, v[176:179] offset:37888
  ds_write_b128 v2, v[180:183] offset:38912
  ds_write_b128 v2, v[184:187] offset:39936
  v_mfma_f32_16x16x32_bf16 v[128:131], a[84:87], v[96:99], v[128:131]
  v_mfma_f32_16x16x32_bf16 v[132:135], a[88:91], v[96:99], v[132:135]
  v_mfma_f32_16x16x32_bf16 v[136:139], a[92:95], v[96:99], v[136:139]
  ds_write_b128 v2, v[188:191] offset:46080
  v_mfma_f32_16x16x32_bf16 v[140:143], a[96:99], v[96:99], v[140:143]
  ds_write_b128 v2, v[192:195] offset:47104
  v_mfma_f32_16x16x32_bf16 v[144:147], a[100:103], v[96:99], v[144:147]
  ds_write_b128 v2, v[196:199] offset:48128
  ds_write_b128 v2, v[200:203] offset:49152
  ds_write_b128 v2, v[204:207] offset:50176
  v_pk_mul_f32 v[32:33], v[128:129], 1.0 op_sel_hi:[1,0]
  v_pk_mul_f32 v[34:35], v[130:131], 1.0 op_sel_hi:[1,0]
  v_pk_mul_f32 v[36:37], v[132:133], 1.0 op_sel_hi:[1,0]
  v_pk_mul_f32 v[38:39], v[134:135], 1.0 op_sel_hi:[1,0]
  v_pk_mul_f32 v[40:41], v[136:137], 1.0 op_sel_hi:[1,0]
  v_pk_mul_f32 v[42:43], v[138:139], 1.0 op_sel_hi:[1,0]
  v_pk_mul_f32 v[44:45], v[140:141], 1.0 op_sel_hi:[1,0]
  v_pk_mul_f32 v[46:47], v[142:143], 1.0 op_sel_hi:[1,0]
  v_pk_mul_f32 v[48:49], v[144:145], 1.0 op_sel_hi:[1,0]
  v_pk_mul_f32 v[50:51], v[146:147], 1.0 op_sel_hi:[1,0]
  s_branch L_k3_kernel_join_10
L_k3_kernel_w1_7:
  v_mfma_f32_16x16x32_bf16 v[168:171], a[84:87], v[104:107], v[168:171]
  v_mfma_f32_16x16x32_bf16 v[172:175], a[88:91], v[104:107], v[172:175]
  v_mfma_f32_16x16x32_bf16 v[176:179], a[92:95], v[104:107], v[176:179]
  v_mfma_f32_16x16x32_bf16 v[180:183], a[96:99], v[104:107], v[180:183]
  v_mfma_f32_16x16x32_bf16 v[184:187], a[100:103], v[104:107], v[184:187]
  v_mfma_f32_16x16x32_bf16 v[188:191], a[84:87], v[108:111], v[188:191]
  v_mfma_f32_16x16x32_bf16 v[192:195], a[88:91], v[108:111], v[192:195]
  v_mfma_f32_16x16x32_bf16 v[196:199], a[92:95], v[108:111], v[196:199]
  s_nop 0
  ds_write_b128 v2, v[168:171] offset:40960
  v_mfma_f32_16x16x32_bf16 v[200:203], a[96:99], v[108:111], v[200:203]
  ds_write_b128 v2, v[172:175] offset:41984
  v_mfma_f32_16x16x32_bf16 v[204:207], a[100:103], v[108:111], v[204:207]
  ds_write_b128 v2, v[176:179] offset:43008
  ds_write_b128 v2, v[180:183] offset:44032
  ds_write_b128 v2, v[184:187] offset:45056
  v_mfma_f32_16x16x32_bf16 v[128:131], a[84:87], v[96:99], v[128:131]
  v_mfma_f32_16x16x32_bf16 v[132:135], a[88:91], v[96:99], v[132:135]
  v_mfma_f32_16x16x32_bf16 v[136:139], a[92:95], v[96:99], v[136:139]
  ds_write_b128 v2, v[188:191] offset:51200
  v_mfma_f32_16x16x32_bf16 v[140:143], a[96:99], v[96:99], v[140:143]
  ds_write_b128 v2, v[192:195] offset:52224
  v_mfma_f32_16x16x32_bf16 v[144:147], a[100:103], v[96:99], v[144:147]
  ds_write_b128 v2, v[196:199] offset:53248
  ds_write_b128 v2, v[200:203] offset:54272
  ds_write_b128 v2, v[204:207] offset:55296
  v_mfma_f32_16x16x32_bf16 v[148:151], a[84:87], v[100:103], v[148:151]
  v_mfma_f32_16x16x32_bf16 v[152:155], a[88:91], v[100:103], v[152:155]
  v_mfma_f32_16x16x32_bf16 v[156:159], a[92:95], v[100:103], v[156:159]
  ds_write_b128 v2, v[128:131] offset:0
  v_mfma_f32_16x16x32_bf16 v[160:163], a[96:99], v[100:103], v[160:163]
  ds_write_b128 v2, v[132:135] offset:1024
  v_mfma_f32_16x16x32_bf16 v[164:167], a[100:103], v[100:103], v[164:167]
  ds_write_b128 v2, v[136:139] offset:2048
  ds_write_b128 v2, v[140:143] offset:3072
  ds_write_b128 v2, v[144:147] offset:4096
  v_pk_mul_f32 v[32:33], v[148:149], 1.0 op_sel_hi:[1,0]
  v_pk_mul_f32 v[34:35], v[150:151], 1.0 op_sel_hi:[1,0]
  v_pk_mul_f32 v[36:37], v[152:153], 1.0 op_sel_hi:[1,0]
  v_pk_mul_f32 v[38:39], v[154:155], 1.0 op_sel_hi:[1,0]
  v_pk_mul_f32 v[40:41], v[156:157], 1.0 op_sel_hi:[1,0]
  v_pk_mul_f32 v[42:43], v[158:159], 1.0 op_sel_hi:[1,0]
  v_pk_mul_f32 v[44:45], v[160:161], 1.0 op_sel_hi:[1,0]
  v_pk_mul_f32 v[46:47], v[162:163], 1.0 op_sel_hi:[1,0]
  v_pk_mul_f32 v[48:49], v[164:165], 1.0 op_sel_hi:[1,0]
  v_pk_mul_f32 v[50:51], v[166:167], 1.0 op_sel_hi:[1,0]
  s_branch L_k3_kernel_join_10
L_k3_kernel_w2_8:
  v_mfma_f32_16x16x32_bf16 v[188:191], a[84:87], v[108:111], v[188:191]
  v_mfma_f32_16x16x32_bf16 v[192:195], a[88:91], v[108:111], v[192:195]
  v_mfma_f32_16x16x32_bf16 v[196:199], a[92:95], v[108:111], v[196:199]
  v_mfma_f32_16x16x32_bf16 v[200:203], a[96:99], v[108:111], v[200:203]
  v_mfma_f32_16x16x32_bf16 v[204:207], a[100:103], v[108:111], v[204:207]
  v_mfma_f32_16x16x32_bf16 v[128:131], a[84:87], v[96:99], v[128:131]
  v_mfma_f32_16x16x32_bf16 v[132:135], a[88:91], v[96:99], v[132:135]
  v_mfma_f32_16x16x32_bf16 v[136:139], a[92:95], v[96:99], v[136:139]
  s_nop 0
  ds_write_b128 v2, v[188:191] offset:56320
  v_mfma_f32_16x16x32_bf16 v[140:143], a[96:99], v[96:99], v[140:143]
  ds_write_b128 v2, v[192:195] offset:57344
  v_mfma_f32_16x16x32_bf16 v[144:147], a[100:103], v[96:99], v[144:147]
  ds_write_b128 v2, v[196:199] offset:58368
  ds_write_b128 v2, v[200:203] offset:59392
  ds_write_b128 v2, v[204:207] offset:60416
  v_mfma_f32_16x16x32_bf16 v[148:151], a[84:87], v[100:103], v[148:151]
  v_mfma_f32_16x16x32_bf16 v[152:155], a[88:91], v[100:103], v[152:155]
  v_mfma_f32_16x16x32_bf16 v[156:159], a[92:95], v[100:103], v[156:159]
  ds_write_b128 v2, v[128:131] offset:5120
  v_mfma_f32_16x16x32_bf16 v[160:163], a[96:99], v[100:103], v[160:163]
  ds_write_b128 v2, v[132:135] offset:6144
  v_mfma_f32_16x16x32_bf16 v[164:167], a[100:103], v[100:103], v[164:167]
  ds_write_b128 v2, v[136:139] offset:7168
  ds_write_b128 v2, v[140:143] offset:8192
  ds_write_b128 v2, v[144:147] offset:9216
  v_mfma_f32_16x16x32_bf16 v[168:171], a[84:87], v[104:107], v[168:171]
  v_mfma_f32_16x16x32_bf16 v[172:175], a[88:91], v[104:107], v[172:175]
  v_mfma_f32_16x16x32_bf16 v[176:179], a[92:95], v[104:107], v[176:179]
  ds_write_b128 v2, v[148:151] offset:15360
  v_mfma_f32_16x16x32_bf16 v[180:183], a[96:99], v[104:107], v[180:183]
  ds_write_b128 v2, v[152:155] offset:16384
  v_mfma_f32_16x16x32_bf16 v[184:187], a[100:103], v[104:107], v[184:187]
  ds_write_b128 v2, v[156:159] offset:17408
  ds_write_b128 v2, v[160:163] offset:18432
  ds_write_b128 v2, v[164:167] offset:19456
  v_pk_mul_f32 v[32:33], v[168:169], 1.0 op_sel_hi:[1,0]
  v_pk_mul_f32 v[34:35], v[170:171], 1.0 op_sel_hi:[1,0]
  v_pk_mul_f32 v[36:37], v[172:173], 1.0 op_sel_hi:[1,0]
  v_pk_mul_f32 v[38:39], v[174:175], 1.0 op_sel_hi:[1,0]
  v_pk_mul_f32 v[40:41], v[176:177], 1.0 op_sel_hi:[1,0]
  v_pk_mul_f32 v[42:43], v[178:179], 1.0 op_sel_hi:[1,0]
  v_pk_mul_f32 v[44:45], v[180:181], 1.0 op_sel_hi:[1,0]
  v_pk_mul_f32 v[46:47], v[182:183], 1.0 op_sel_hi:[1,0]
  v_pk_mul_f32 v[48:49], v[184:185], 1.0 op_sel_hi:[1,0]
  v_pk_mul_f32 v[50:51], v[186:187], 1.0 op_sel_hi:[1,0]
  s_branch L_k3_kernel_join_10
L_k3_kernel_w3_9:
  v_mfma_f32_16x16x32_bf16 v[128:131], a[84:87], v[96:99], v[128:131]
  v_mfma_f32_16x16x32_bf16 v[132:135], a[88:91], v[96:99], v[132:135]
  v_mfma_f32_16x16x32_bf16 v[136:139], a[92:95], v[96:99], v[136:139]
  v_mfma_f32_16x16x32_bf16 v[140:143], a[96:99], v[96:99], v[140:143]
  v_mfma_f32_16x16x32_bf16 v[144:147], a[100:103], v[96:99], v[144:147]
  v_mfma_f32_16x16x32_bf16 v[148:151], a[84:87], v[100:103], v[148:151]
  v_mfma_f32_16x16x32_bf16 v[152:155], a[88:91], v[100:103], v[152:155]
  v_mfma_f32_16x16x32_bf16 v[156:159], a[92:95], v[100:103], v[156:159]
  s_nop 0
  ds_write_b128 v2, v[128:131] offset:10240
  v_mfma_f32_16x16x32_bf16 v[160:163], a[96:99], v[100:103], v[160:163]
  ds_write_b128 v2, v[132:135] offset:11264
  v_mfma_f32_16x16x32_bf16 v[164:167], a[100:103], v[100:103], v[164:167]
  ds_write_b128 v2, v[136:139] offset:12288
  ds_write_b128 v2, v[140:143] offset:13312
  ds_write_b128 v2, v[144:147] offset:14336
  v_mfma_f32_16x16x32_bf16 v[168:171], a[84:87], v[104:107], v[168:171]
  v_mfma_f32_16x16x32_bf16 v[172:175], a[88:91], v[104:107], v[172:175]
  v_mfma_f32_16x16x32_bf16 v[176:179], a[92:95], v[104:107], v[176:179]
  ds_write_b128 v2, v[148:151] offset:20480
  v_mfma_f32_16x16x32_bf16 v[180:183], a[96:99], v[104:107], v[180:183]
  ds_write_b128 v2, v[152:155] offset:21504
  v_mfma_f32_16x16x32_bf16 v[184:187], a[100:103], v[104:107], v[184:187]
  ds_write_b128 v2, v[156:159] offset:22528
  ds_write_b128 v2, v[160:163] offset:23552
  ds_write_b128 v2, v[164:167] offset:24576
  v_mfma_f32_16x16x32_bf16 v[188:191], a[84:87], v[108:111], v[188:191]
  v_mfma_f32_16x16x32_bf16 v[192:195], a[88:91], v[108:111], v[192:195]
  v_mfma_f32_16x16x32_bf16 v[196:199], a[92:95], v[108:111], v[196:199]
  ds_write_b128 v2, v[168:171] offset:30720
  v_mfma_f32_16x16x32_bf16 v[200:203], a[96:99], v[108:111], v[200:203]
  ds_write_b128 v2, v[172:175] offset:31744
  v_mfma_f32_16x16x32_bf16 v[204:207], a[100:103], v[108:111], v[204:207]
  ds_write_b128 v2, v[176:179] offset:32768
  ds_write_b128 v2, v[180:183] offset:33792
  ds_write_b128 v2, v[184:187] offset:34816
  v_pk_mul_f32 v[32:33], v[188:189], 1.0 op_sel_hi:[1,0]
  v_pk_mul_f32 v[34:35], v[190:191], 1.0 op_sel_hi:[1,0]
  v_pk_mul_f32 v[36:37], v[192:193], 1.0 op_sel_hi:[1,0]
  v_pk_mul_f32 v[38:39], v[194:195], 1.0 op_sel_hi:[1,0]
  v_pk_mul_f32 v[40:41], v[196:197], 1.0 op_sel_hi:[1,0]
  v_pk_mul_f32 v[42:43], v[198:199], 1.0 op_sel_hi:[1,0]
  v_pk_mul_f32 v[44:45], v[200:201], 1.0 op_sel_hi:[1,0]
  v_pk_mul_f32 v[46:47], v[202:203], 1.0 op_sel_hi:[1,0]
  v_pk_mul_f32 v[48:49], v[204:205], 1.0 op_sel_hi:[1,0]
  v_pk_mul_f32 v[50:51], v[206:207], 1.0 op_sel_hi:[1,0]
  s_nop 0
L_k3_kernel_join_10:
  s_mul_i32 s24, s19, 15360
  v_add_u32 v26, s24, v2
  s_waitcnt lgkmcnt(0)
  s_barrier
  ds_read_b128 v[52:55], v26 offset:0
  ds_read_b128 v[56:59], v26 offset:5120
  ds_read_b128 v[60:63], v26 offset:10240
  ds_read_b128 v[64:67], v26 offset:1024
  ds_read_b128 v[68:71], v26 offset:6144
  ds_read_b128 v[72:75], v26 offset:11264
  ds_read_b128 v[76:79], v26 offset:2048
  ds_read_b128 v[80:83], v26 offset:7168
  ds_read_b128 v[84:87], v26 offset:12288
  ds_read_b128 v[88:91], v26 offset:3072
  ds_read_b128 v[92:95], v26 offset:8192
  ds_read_b128 v[96:99], v26 offset:13312
  ds_read_b128 v[100:103], v26 offset:4096
  ds_read_b128 v[104:107], v26 offset:9216
  ds_read_b128 v[108:111], v26 offset:14336
  v_and_b32 v27, 1, v23
  v_lshlrev_b32 v27, 5, v27
  v_lshrrev_b32 v28, 1, v23
  v_lshl_add_u32 v27, v28, 4, v27
  v_lshlrev_b32 v28, 3, v23
  v_sub_u32 v28, v18, v28
  v_add_u32 v27, v28, v27
  s_waitcnt vmcnt(0)
  s_waitcnt lgkmcnt(12)
  v_pk_add_f32 v[32:33], v[32:33], v[52:53]
  v_pk_add_f32 v[56:57], v[56:57], v[60:61]
  v_pk_add_f32 v[34:35], v[34:35], v[54:55]
  v_pk_add_f32 v[58:59], v[58:59], v[62:63]
  v_pk_add_f32 v[32:33], v[32:33], v[56:57]
  v_pk_add_f32 v[34:35], v[34:35], v[58:59]
  v_lshlrev_b32 v52, 16, v112
  v_and_b32 v53, 0xffff0000, v112
  v_lshlrev_b32 v54, 16, v113
  v_and_b32 v55, 0xffff0000, v113
  v_pk_fma_f32 v[52:53], v[32:33], v[208:209], v[52:53]
  v_pk_fma_f32 v[54:55], v[34:35], v[210:211], v[54:55]
  v_cvt_pk_bf16_f32 v240, v52, v53
  v_cvt_pk_bf16_f32 v241, v54, v55
  s_waitcnt lgkmcnt(9)
  v_pk_add_f32 v[36:37], v[36:37], v[64:65]
  v_pk_add_f32 v[68:69], v[68:69], v[72:73]
  v_pk_add_f32 v[38:39], v[38:39], v[66:67]
  v_pk_add_f32 v[70:71], v[70:71], v[74:75]
  v_pk_add_f32 v[36:37], v[36:37], v[68:69]
  v_pk_add_f32 v[38:39], v[38:39], v[70:71]
  v_lshlrev_b32 v64, 16, v114
  v_and_b32 v65, 0xffff0000, v114
  v_lshlrev_b32 v66, 16, v115
  v_and_b32 v67, 0xffff0000, v115
  v_pk_fma_f32 v[64:65], v[36:37], v[212:213], v[64:65]
  v_pk_fma_f32 v[66:67], v[38:39], v[214:215], v[66:67]
  v_cvt_pk_bf16_f32 v242, v64, v65
  v_cvt_pk_bf16_f32 v243, v66, v67
  s_nop 0
  v_permlane16_swap_b32 v240, v242
  v_permlane16_swap_b32 v241, v243
  buffer_store_dwordx4 v[240:243], v27, s[76:79], 0 offen offset:0
  s_waitcnt lgkmcnt(6)
  v_pk_add_f32 v[40:41], v[40:41], v[76:77]
  v_pk_add_f32 v[80:81], v[80:81], v[84:85]
  v_pk_add_f32 v[42:43], v[42:43], v[78:79]
  v_pk_add_f32 v[82:83], v[82:83], v[86:87]
  v_pk_add_f32 v[40:41], v[40:41], v[80:81]
  v_pk_add_f32 v[42:43], v[42:43], v[82:83]
  v_lshlrev_b32 v76, 16, v116
  v_and_b32 v77, 0xffff0000, v116
  v_lshlrev_b32 v78, 16, v117
  v_and_b32 v79, 0xffff0000, v117
  v_pk_fma_f32 v[76:77], v[40:41], v[216:217], v[76:77]
  v_pk_fma_f32 v[78:79], v[42:43], v[218:219], v[78:79]
  v_cvt_pk_bf16_f32 v244, v76, v77
  v_cvt_pk_bf16_f32 v245, v78, v79
  s_waitcnt lgkmcnt(3)
  v_pk_add_f32 v[44:45], v[44:45], v[88:89]
  v_pk_add_f32 v[92:93], v[92:93], v[96:97]
  v_pk_add_f32 v[46:47], v[46:47], v[90:91]
  v_pk_add_f32 v[94:95], v[94:95], v[98:99]
  v_pk_add_f32 v[44:45], v[44:45], v[92:93]
  v_pk_add_f32 v[46:47], v[46:47], v[94:95]
  v_lshlrev_b32 v88, 16, v118
  v_and_b32 v89, 0xffff0000, v118
  v_lshlrev_b32 v90, 16, v119
  v_and_b32 v91, 0xffff0000, v119
  v_pk_fma_f32 v[88:89], v[44:45], v[220:221], v[88:89]
  v_pk_fma_f32 v[90:91], v[46:47], v[222:223], v[90:91]
  v_cvt_pk_bf16_f32 v246, v88, v89
  v_cvt_pk_bf16_f32 v247, v90, v91
  s_nop 0
  v_permlane16_swap_b32 v244, v246
  v_permlane16_swap_b32 v245, v247
  buffer_store_dwordx4 v[244:247], v27, s[76:79], 0 offen offset:64
  s_waitcnt lgkmcnt(0)
  v_pk_add_f32 v[48:49], v[48:49], v[100:101]
  v_pk_add_f32 v[104:105], v[104:105], v[108:109]
  v_pk_add_f32 v[50:51], v[50:51], v[102:103]
  v_pk_add_f32 v[106:107], v[106:107], v[110:111]
  v_pk_add_f32 v[48:49], v[48:49], v[104:105]
  v_pk_add_f32 v[50:51], v[50:51], v[106:107]
  v_lshlrev_b32 v100, 16, v120
  v_and_b32 v101, 0xffff0000, v120
  v_lshlrev_b32 v102, 16, v121
  v_and_b32 v103, 0xffff0000, v121
  v_pk_fma_f32 v[100:101], v[48:49], v[224:225], v[100:101]
  v_pk_fma_f32 v[102:103], v[50:51], v[226:227], v[102:103]
  v_cvt_pk_bf16_f32 v248, v100, v101
  v_cvt_pk_bf16_f32 v249, v102, v103
  buffer_store_dwordx2 v[248:249], v18, s[76:79], 0 offen offset:128
k3_kernel_end:
k3_kernel_exit:
  s_endpgm
code_end:
  s_endpgm
.section .rodata,"a"
.p2align 6
.amdhsa_kernel k1_kernel
  .amdhsa_next_free_vgpr 128
  .amdhsa_next_free_sgpr 102
  .amdhsa_accum_offset 128
  .amdhsa_group_segment_fixed_size 0
  .amdhsa_kernarg_size 128
  .amdhsa_user_sgpr_count 2
  .amdhsa_user_sgpr_kernarg_segment_ptr 1
  .amdhsa_system_sgpr_workgroup_id_x 1
  .amdhsa_float_denorm_mode_32 3
.end_amdhsa_kernel
.p2align 6
.amdhsa_kernel k2_kernel
  .amdhsa_next_free_vgpr 256
  .amdhsa_next_free_sgpr 102
  .amdhsa_accum_offset 256
  .amdhsa_group_segment_fixed_size 0
  .amdhsa_kernarg_size 128
  .amdhsa_user_sgpr_count 2
  .amdhsa_user_sgpr_kernarg_segment_ptr 1
  .amdhsa_system_sgpr_workgroup_id_x 1
  .amdhsa_float_denorm_mode_32 3
.end_amdhsa_kernel
.p2align 6
.amdhsa_kernel k3_kernel
  .amdhsa_next_free_vgpr 512
  .amdhsa_next_free_sgpr 102
  .amdhsa_accum_offset 256
  .amdhsa_group_segment_fixed_size 0
  .amdhsa_kernarg_size 128
  .amdhsa_user_sgpr_count 2
  .amdhsa_user_sgpr_kernarg_segment_ptr 1
  .amdhsa_system_sgpr_workgroup_id_x 1
  .amdhsa_float_denorm_mode_32 3
.end_amdhsa_kernel
```
